```python
import torch

def _softmax(x, axis=-1):
    return torch.softmax(x, dim=axis)

def _gelu(x):
    return torch.nn.functional.gelu(x, approximate='tanh')

def _silu(x):
    return torch.nn.functional.silu(x)

def _sigmoid(x):
    return torch.sigmoid(x)

def _layernorm(x, axis=-1, eps=1e-05):
    m = x.mean(dim=axis, keepdim=True)
    v = x.var(dim=axis, keepdim=True, unbiased=False)
    return (x - m) / torch.sqrt(v + eps)

def _scatter_add(tgt, idx, src, axis=0):
    return tgt.clone().index_add_(axis, idx, src)

def _segment_sum(src, seg, n):
    out = torch.zeros((n,) + src.shape[1:], dtype=src.dtype)
    return out.index_add_(0, seg, src)

def _pad(x, pw):
    flat = tuple((v for pair in reversed(pw) for v in pair))
    return torch.nn.functional.pad(x, flat)
kernel_name = 'adaLN_cond__ssm_conv_s4__glu_gated_reglu__prompt'

def setup_inputs():

    _w = lambda a: (lambda t: t.to(torch.bfloat16) if t.is_floating_point() else t)(torch.as_tensor(a))

    def _A_setup():
        B, L, D, N = (1, 2048, 576, 128)
        A_re = -(lambda _x: torch.exp(torch.as_tensor(_x)))((lambda *s: torch.randn(*s, dtype=torch.bfloat16) * 3.2)(D, N))
        A_im = torch.pi * (lambda *s: torch.randn(*s, dtype=torch.bfloat16) * 0.05)(D, N)
        B_re = (lambda *s: torch.randn(*s, dtype=torch.bfloat16) * 0.1)(D, N)
        B_im = (lambda *s: torch.randn(*s, dtype=torch.bfloat16) * 0.1)(D, N)
        C_re = (lambda *s: torch.randn(*s, dtype=torch.bfloat16) * 0.1)(D, N)
        C_im = (lambda *s: torch.randn(*s, dtype=torch.bfloat16) * 0.1)(D, N)
        log_dt = (lambda *s: torch.randn(*s, dtype=torch.bfloat16) * 0.05)(D) * 0.5 - 4.0
        Dskip = (lambda *s: torch.randn(*s, dtype=torch.bfloat16) * 0.05)(D)
        return {'u': _w((lambda *s: torch.randn(*s, dtype=torch.bfloat16) * 0.05)(B, L, D)), 'A_re': _w(A_re), 'A_im': _w(A_im), 'B_re': _w(B_re), 'B_im': _w(B_im), 'C_re': _w(C_re), 'C_im': _w(C_im), 'log_dt': _w(log_dt), 'Dskip': _w(Dskip)}
    _A_in = _A_setup()

    def _B_setup():
        B, S, D, F = (1, 2048, 576, 4608)
        return {'x': _w((lambda *s: torch.randn(*s, dtype=torch.bfloat16) * 0.05)(B, S, D)), 'W_gate': _w((lambda *s: torch.randn(*s, dtype=torch.bfloat16) * 0.8)(D, F) * (2.0 / D) ** 0.5), 'W_up': _w((lambda *s: torch.randn(*s, dtype=torch.bfloat16) * 0.8)(D, F) * (2.0 / D) ** 0.5), 'W_down': _w((lambda *s: torch.randn(*s, dtype=torch.bfloat16) * 0.8)(F, D) * (1.0 / F) ** 0.5)}
    _B_in = _B_setup()
    return {'A_u': _A_in['u'], 'A_A_re': _A_in['A_re'], 'A_A_im': _A_in['A_im'], 'A_B_re': _A_in['B_re'], 'A_B_im': _A_in['B_im'], 'A_C_re': _A_in['C_re'], 'A_C_im': _A_in['C_im'], 'A_log_dt': _A_in['log_dt'], 'A_Dskip': _A_in['Dskip'], 'B_x': _B_in['x'], 'B_W_gate': _B_in['W_gate'], 'B_W_up': _B_in['W_up'], 'B_W_down': _B_in['W_down'], 'c': _w((lambda *s: torch.randn(*s, dtype=torch.bfloat16) * 0.2)(1, 576) * 8.0), 'w_mod': _w((lambda *s: torch.randn(*s, dtype=torch.bfloat16) * 0.2)(576, 6 * 576) * 576 ** (-0.5) * 8.0)}

def reference(A_u, A_A_re, A_A_im, A_B_re, A_B_im, A_C_re, A_C_im, A_log_dt, A_Dskip, B_x, B_W_gate, B_W_up, B_W_down, c, w_mod):

    def _A_ref(u, A_re, A_im, B_re, B_im, C_re, C_im, log_dt, Dskip):
        Bsz, L, D = u.shape
        dt = torch.exp(log_dt)[:, None]
        A = A_re + 1j * A_im
        Bc = B_re + 1j * B_im
        Cc = C_re + 1j * C_im
        logdA = dt * A
        dB = dt * Bc
        l = (lambda x, dt: x.to(dt))(torch.arange(L), A_re.dtype)
        P = torch.exp(logdA[:, :, None] * l[None, None, :])
        K = torch.einsum('dn,dnl,dn->dl', Cc, P, dB).real
        L2 = 2 * L
        Kp = _pad(K, ((0, 0), (0, L)))
        up = (lambda x, *d: x.permute(*d))(u, 0, 2, 1)
        up = _pad(up, ((0, 0), (0, 0), (0, L)))
        Kf = (lambda x, axes=(-2, -1): torch.fft.rfft2(x.float(), dim=axes))(Kp[:, None, :], axes=(-2, -1))
        Uf = (lambda x, axes=(-2, -1): torch.fft.rfft2(x.float(), dim=axes))(up[:, :, None, :], axes=(-2, -1))
        Yf = Uf * Kf[None, :, :, :]
        y = (lambda x, s, axes=(-2, -1): torch.fft.irfft2(x, s=s, dim=axes).to(torch.bfloat16))(Yf, (1, L2), axes=(-2, -1))[:, :, 0, :L]
        y = (lambda x, *d: x.permute(*d))(y, 0, 2, 1) + u * Dskip[None, None, :]
        return y

    def _B_ref(x, W_gate, W_up, W_down):
        gate = torch.einsum('bsd,df->bsf', x, W_gate)
        up = torch.einsum('bsd,df->bsf', x, W_up)
        gate = gate * (lambda x, dt: x.to(dt))(gate > 0, gate.dtype)
        h = gate * up
        return torch.einsum('bsf,fd->bsd', h, W_down)
    x = A_u
    mod = (_silu(c) @ w_mod).reshape(c.shape[0], 6, 1, -1)
    sa, ca, ga, sb, cb, gb = (mod[:, 0].clone(), mod[:, 1].clone(), mod[:, 2].clone(), mod[:, 3].clone(), mod[:, 4].clone(), mod[:, 5].clone())
    h = _layernorm(x, axis=-1) * (1 + ca) + sa
    x = x + ga * _A_ref(h, A_A_re, A_A_im, A_B_re, A_B_im, A_C_re, A_C_im, A_log_dt, A_Dskip)
    h = _layernorm(x, axis=-1) * (1 + cb) + sb
    x = x + gb * _B_ref(h, B_W_gate, B_W_up, B_W_down)
    return x
```

```asm
; @launch kernel=front_kernel grid=(1024,1,1) block=(256,1,1) lds=40960
; @launch kernel=ffn_kernel grid=(256,1,1) block=(256,1,1) lds=163840
.amdgcn_target "amdgcn-amd-amdhsa--gfx950"
.text
.globl front_kernel
.p2align 8
.type front_kernel,@function
front_kernel:
    s_load_dwordx16 s[44:59], s[0:1], 0
    s_load_dwordx16 s[60:75], s[0:1], 64
    s_load_dwordx4 s[76:79], s[0:1], 128
    s_and_b32 s3, s2, 255
    s_lshr_b32 s35, s2, 8
    s_sub_u32 s6, s2, 184
    s_cmp_ge_u32 s6, 8
    s_cbranch_scc1 L_f_nopf
    s_getpc_b64 s[6:7]
L_f_pc:
    v_lshlrev_b32 v1, 7, v0
    s_mov_b32 s8, L_code_end-L_f_pc-4
    v_min_u32 v2, s8, v1
    global_load_dword v4, v2, s[6:7]
    v_add_u32 v1, 32768, v1
    v_min_u32 v2, s8, v1
    global_load_dword v5, v2, s[6:7]
    s_waitcnt vmcnt(0) lgkmcnt(0)
    s_endpgm
L_f_nopf:
    v_lshrrev_b32 v1, 6, v0
    s_cmp_ge_u32 s3, 192
    v_readfirstlane_b32 s36, v1
    s_cbranch_scc1 L_f_bulk
    s_cmp_eq_u32 s35, 0
    s_cbranch_scc1 L_f_s0
    s_cmp_ge_u32 s35, 4
    s_cbranch_scc1 L_f_end
    s_and_b32 s24, s3, 7
    s_mul_i32 s24, s24, 24
    s_lshr_b32 s25, s3, 3
    s_add_u32 s24, s24, s25
    s_mul_i32 s24, s24, 3
    s_sub_u32 s35, s35, 1
    s_add_u32 s37, s24, s35
    v_and_b32 v1, 127, v0
    s_lshl_b32 s24, s37, 8
    v_lshl_add_u32 v4, v1, 1, s24
    s_lshr_b32 s24, s37, 1
    s_lshl_b32 s24, s24, 2
    s_cmp_lt_u32 s36, 2
    s_waitcnt lgkmcnt(0)
    global_load_ushort v10, v4, s[46:47] nt
    global_load_ushort v11, v4, s[48:49] nt
    s_load_dword s26, s[58:59], s24
    s_load_dword s27, s[60:61], s24
    s_cbranch_scc1 L_f_chan
    global_load_ushort v12, v4, s[50:51] nt
    global_load_ushort v13, v4, s[52:53] nt
    global_load_ushort v14, v4, s[54:55] nt
    global_load_ushort v15, v4, s[56:57] nt
    s_branch L_f_chan
L_f_s0:
    s_setprio 3
    s_mov_b32 s39, 1000
    s_cmp_ge_u32 s3, 128
    s_cbranch_scc1 L_f_aux
    s_and_b32 s37, s3, 1
    s_lshl_b32 s37, s37, 2
    s_bfe_u32 s11, s3, 0x20003
    s_add_u32 s37, s37, s11
    s_lshl_b32 s37, s37, 4
    s_and_b32 s11, s3, 6
    s_lshl_b32 s11, s11, 1
    s_add_u32 s37, s37, s11
    s_lshr_b32 s11, s3, 5
    s_add_u32 s37, s37, s11
    v_lshrrev_b32 v1, 5, v0
    v_bfe_u32 v6, v0, 4, 1
    v_and_b32 v2, 15, v0
    s_lshl_b32 s11, s37, 4
    v_lshl_add_u32 v3, v6, 3, v1
    v_add_u32 v3, s11, v3
    v_mul_u32_u24 v3, 1152, v3
    v_lshl_add_u32 v3, v2, 3, v3
    s_waitcnt lgkmcnt(0)
    global_load_dwordx2 v[8:9], v3, s[44:45] offset:0
    global_load_dwordx2 v[10:11], v3, s[44:45] offset:128
    global_load_dwordx2 v[12:13], v3, s[44:45] offset:256
    global_load_dwordx2 v[14:15], v3, s[44:45] offset:384
    global_load_dwordx2 v[16:17], v3, s[44:45] offset:512
    global_load_dwordx2 v[18:19], v3, s[44:45] offset:640
    global_load_dwordx2 v[20:21], v3, s[44:45] offset:768
    global_load_dwordx2 v[22:23], v3, s[44:45] offset:896
    global_load_dwordx2 v[24:25], v3, s[44:45] offset:1024
    s_branch L_f_ln
L_f_aux:
    s_cmp_ge_u32 s3, 182
    s_cbranch_scc1 L_f_misc
    s_sub_u32 s11, s3, 128
    s_mul_i32 s10, s11, 7282
    s_lshr_b32 s10, s10, 16
    s_mul_i32 s12, s10, 9
    s_sub_u32 s11, s11, s12
L_f_gv:
    s_mul_i32 s12, s10, 96
    v_lshrrev_b32 v1, 4, v0
    v_and_b32 v2, 15, v0
    v_add_u32 v3, s12, v1
    v_mul_u32_u24 v5, 6912, v3
    s_lshl_b32 s14, s11, 8
    v_lshl_add_u32 v5, v2, 4, v5
    v_add_u32 v5, s14, v5
    v_min_u32 v4, 5, v2
    v_lshl_add_u32 v4, v4, 4, v3
    v_lshlrev_b32 v4, 1, v4
    s_mov_b32 s13, 110592
    s_waitcnt lgkmcnt(0)
    global_load_ushort v44, v4, s[70:71]
    global_load_dwordx4 v[8:11], v5, s[72:73] nt
    v_add_u32 v5, s13, v5
    global_load_dwordx4 v[12:15], v5, s[72:73] nt
    v_add_u32 v5, s13, v5
    global_load_dwordx4 v[16:19], v5, s[72:73] nt
    v_add_u32 v5, s13, v5
    global_load_dwordx4 v[20:23], v5, s[72:73] nt
    v_add_u32 v5, s13, v5
    global_load_dwordx4 v[24:27], v5, s[72:73] nt
    v_add_u32 v5, s13, v5
    global_load_dwordx4 v[28:31], v5, s[72:73] nt
    s_nop 0
    s_branch L_f_gvb
L_f_misc:
    s_cmp_eq_u32 s3, 183
    s_cbranch_scc1 L_f_end
    s_memrealtime s[12:13]
    v_mov_b32 v4, 0
    s_cmp_lg_u32 s36, 0
    s_waitcnt lgkmcnt(0)
    s_cbranch_scc1 L_f_end
    s_mul_i32 s12, s12, 0x9e3779b1
    s_lshr_b32 s13, s12, 15
    s_xor_b32 s12, s12, s13
    s_or_b32 s12, s12, 0x80000000
    s_and_b32 s12, s12, 0xdfffffff
    v_mov_b32 v5, s12
    v_mov_b32 v6, 0x1B000
    s_mov_b64 exec, 1
    global_store_dword v4, v5, s[76:77] sc1
    global_store_dword v6, v5, s[78:79] sc1
    s_branch L_f_end
L_f_ln:
    v_mul_u32_u24 v4, 2368, v1
    v_lshl_add_u32 v4, v2, 4, v4
    v_lshl_add_u32 v4, v6, 3, v4
    s_mov_b32 s12, 0xffff0000
    s_mov_b32 s17, 0xfffefffe
    v_lshrrev_b32 v5, 2, v2
    v_mul_u32_u24 v5, 2368, v5
    v_and_b32 v81, 3, v0
    v_lshl_add_u32 v5, v81, 3, v5
    v_lshrrev_b32 v6, 4, v0
    v_lshl_add_u32 v5, v6, 5, v5
    s_add_u32 s16, s36, 16
    s_min_u32 s16, s16, 17
    s_sub_u32 s16, s16, s36
    s_lshl_b32 s14, s16, 7
    v_add_u32 v76, s14, v5
    v_lshlrev_b32 v7, 4, v0
    s_mul_i32 s11, s37, 18432
    s_add_u32 s11, s11, 131072
    v_add_u32 v7, s11, v7
    s_lshl_b32 s14, s16, 10
    v_add_u32 v77, s14, v7
    v_add_u32 v78, 4096, v7
    v_add_u32 v79, 8192, v7
    v_add_u32 v80, 12288, v7
    s_waitcnt vmcnt(8)
    v_mov_b32 v82, 0
    global_load_dword v83, v82, s[76:77] sc1
    v_lshlrev_b32 v28, 16, v8
    v_and_b32 v29, s12, v8
    v_lshlrev_b32 v30, 16, v9
    v_and_b32 v31, s12, v9
    v_pk_mul_f32 v[68:69], v[28:29], v[28:29]
    v_pk_mul_f32 v[70:71], v[30:31], v[30:31]
    s_waitcnt vmcnt(8)
    v_lshlrev_b32 v32, 16, v10
    v_and_b32 v33, s12, v10
    v_lshlrev_b32 v34, 16, v11
    v_and_b32 v35, s12, v11
    v_pk_fma_f32 v[68:69], v[32:33], v[32:33], v[68:69]
    v_pk_add_f32 v[64:65], v[28:29], v[32:33]
    v_pk_fma_f32 v[70:71], v[34:35], v[34:35], v[70:71]
    v_pk_add_f32 v[66:67], v[30:31], v[34:35]
    s_waitcnt vmcnt(7)
    v_lshlrev_b32 v36, 16, v12
    v_and_b32 v37, s12, v12
    v_lshlrev_b32 v38, 16, v13
    v_and_b32 v39, s12, v13
    v_pk_fma_f32 v[68:69], v[36:37], v[36:37], v[68:69]
    v_pk_add_f32 v[64:65], v[64:65], v[36:37]
    v_pk_fma_f32 v[70:71], v[38:39], v[38:39], v[70:71]
    v_pk_add_f32 v[66:67], v[66:67], v[38:39]
    s_waitcnt vmcnt(6)
    v_lshlrev_b32 v40, 16, v14
    v_and_b32 v41, s12, v14
    v_lshlrev_b32 v42, 16, v15
    v_and_b32 v43, s12, v15
    v_pk_fma_f32 v[68:69], v[40:41], v[40:41], v[68:69]
    v_pk_add_f32 v[64:65], v[64:65], v[40:41]
    v_pk_fma_f32 v[70:71], v[42:43], v[42:43], v[70:71]
    v_pk_add_f32 v[66:67], v[66:67], v[42:43]
    s_waitcnt vmcnt(5)
    v_lshlrev_b32 v44, 16, v16
    v_and_b32 v45, s12, v16
    v_lshlrev_b32 v46, 16, v17
    v_and_b32 v47, s12, v17
    v_pk_fma_f32 v[68:69], v[44:45], v[44:45], v[68:69]
    v_pk_add_f32 v[64:65], v[64:65], v[44:45]
    v_pk_fma_f32 v[70:71], v[46:47], v[46:47], v[70:71]
    v_pk_add_f32 v[66:67], v[66:67], v[46:47]
    s_waitcnt vmcnt(4)
    v_lshlrev_b32 v48, 16, v18
    v_and_b32 v49, s12, v18
    v_lshlrev_b32 v50, 16, v19
    v_and_b32 v51, s12, v19
    v_pk_fma_f32 v[68:69], v[48:49], v[48:49], v[68:69]
    v_pk_add_f32 v[64:65], v[64:65], v[48:49]
    v_pk_fma_f32 v[70:71], v[50:51], v[50:51], v[70:71]
    v_pk_add_f32 v[66:67], v[66:67], v[50:51]
    s_waitcnt vmcnt(3)
    v_lshlrev_b32 v52, 16, v20
    v_and_b32 v53, s12, v20
    v_lshlrev_b32 v54, 16, v21
    v_and_b32 v55, s12, v21
    v_pk_fma_f32 v[68:69], v[52:53], v[52:53], v[68:69]
    v_pk_add_f32 v[64:65], v[64:65], v[52:53]
    v_pk_fma_f32 v[70:71], v[54:55], v[54:55], v[70:71]
    v_pk_add_f32 v[66:67], v[66:67], v[54:55]
    s_waitcnt vmcnt(2)
    v_lshlrev_b32 v56, 16, v22
    v_and_b32 v57, s12, v22
    v_lshlrev_b32 v58, 16, v23
    v_and_b32 v59, s12, v23
    v_pk_fma_f32 v[68:69], v[56:57], v[56:57], v[68:69]
    v_pk_add_f32 v[64:65], v[64:65], v[56:57]
    v_pk_fma_f32 v[70:71], v[58:59], v[58:59], v[70:71]
    v_pk_add_f32 v[66:67], v[66:67], v[58:59]
    s_waitcnt vmcnt(1)
    v_lshlrev_b32 v60, 16, v24
    v_and_b32 v61, s12, v24
    v_lshlrev_b32 v62, 16, v25
    v_and_b32 v63, s12, v25
    v_pk_fma_f32 v[68:69], v[60:61], v[60:61], v[68:69]
    v_pk_add_f32 v[64:65], v[64:65], v[60:61]
    v_pk_fma_f32 v[70:71], v[62:63], v[62:63], v[70:71]
    v_pk_add_f32 v[66:67], v[66:67], v[62:63]
    v_pk_add_f32 v[64:65], v[64:65], v[66:67]
    v_pk_add_f32 v[68:69], v[68:69], v[70:71]
    v_add_f32 v64, v64, v65
    v_add_f32 v66, v68, v69
    s_nop 0
    v_add_f32_dpp v64, v64, v64 row_ror:8 row_mask:0xf bank_mask:0xf
    v_add_f32_dpp v66, v66, v66 row_ror:8 row_mask:0xf bank_mask:0xf
    s_nop 0
    v_add_f32_dpp v64, v64, v64 row_ror:4 row_mask:0xf bank_mask:0xf
    v_add_f32_dpp v66, v66, v66 row_ror:4 row_mask:0xf bank_mask:0xf
    s_nop 0
    v_add_f32_dpp v64, v64, v64 row_ror:2 row_mask:0xf bank_mask:0xf
    v_add_f32_dpp v66, v66, v66 row_ror:2 row_mask:0xf bank_mask:0xf
    s_nop 0
    v_add_f32_dpp v64, v64, v64 row_ror:1 row_mask:0xf bank_mask:0xf
    v_add_f32_dpp v66, v66, v66 row_ror:1 row_mask:0xf bank_mask:0xf
    v_mul_f32 v64, 0x3ae38e39, v64
    v_mul_f32 v66, 0x3ae38e39, v66
    v_fma_f32 v66, -v64, v64, v66
    v_max_f32 v66, 0, v66
    v_add_f32 v66, 0x3727c5ac, v66
    v_rsq_f32 v66, v66
    s_nop 0
    v_mul_f32 v68, -v64, v66
    v_pk_fma_f32 v[28:29], v[28:29], v[66:67], v[68:69] op_sel_hi:[1,0,0]
    v_pk_fma_f32 v[30:31], v[30:31], v[66:67], v[68:69] op_sel_hi:[1,0,0]
    v_pk_fma_f32 v[32:33], v[32:33], v[66:67], v[68:69] op_sel_hi:[1,0,0]
    v_pk_fma_f32 v[34:35], v[34:35], v[66:67], v[68:69] op_sel_hi:[1,0,0]
    v_permlane16_swap_b32 v28, v30
    v_permlane16_swap_b32 v29, v31
    v_pk_fma_f32 v[36:37], v[36:37], v[66:67], v[68:69] op_sel_hi:[1,0,0]
    v_pk_fma_f32 v[38:39], v[38:39], v[66:67], v[68:69] op_sel_hi:[1,0,0]
    v_permlane16_swap_b32 v32, v34
    v_permlane16_swap_b32 v33, v35
    v_cvt_pk_bf16_f32 v8, v28, v30
    v_cvt_pk_bf16_f32 v9, v29, v31
    ds_write_b64 v4, v[8:9] offset:0
    v_pk_fma_f32 v[40:41], v[40:41], v[66:67], v[68:69] op_sel_hi:[1,0,0]
    v_pk_fma_f32 v[42:43], v[42:43], v[66:67], v[68:69] op_sel_hi:[1,0,0]
    v_permlane16_swap_b32 v36, v38
    v_permlane16_swap_b32 v37, v39
    v_cvt_pk_bf16_f32 v10, v32, v34
    v_cvt_pk_bf16_f32 v11, v33, v35
    ds_write_b64 v4, v[10:11] offset:256
    v_pk_fma_f32 v[44:45], v[44:45], v[66:67], v[68:69] op_sel_hi:[1,0,0]
    v_pk_fma_f32 v[46:47], v[46:47], v[66:67], v[68:69] op_sel_hi:[1,0,0]
    v_permlane16_swap_b32 v40, v42
    v_permlane16_swap_b32 v41, v43
    v_cvt_pk_bf16_f32 v12, v36, v38
    v_cvt_pk_bf16_f32 v13, v37, v39
    ds_write_b64 v4, v[12:13] offset:512
    v_pk_fma_f32 v[48:49], v[48:49], v[66:67], v[68:69] op_sel_hi:[1,0,0]
    v_pk_fma_f32 v[50:51], v[50:51], v[66:67], v[68:69] op_sel_hi:[1,0,0]
    v_permlane16_swap_b32 v44, v46
    v_permlane16_swap_b32 v45, v47
    v_cvt_pk_bf16_f32 v14, v40, v42
    v_cvt_pk_bf16_f32 v15, v41, v43
    ds_write_b64 v4, v[14:15] offset:768
    v_pk_fma_f32 v[52:53], v[52:53], v[66:67], v[68:69] op_sel_hi:[1,0,0]
    v_pk_fma_f32 v[54:55], v[54:55], v[66:67], v[68:69] op_sel_hi:[1,0,0]
    v_permlane16_swap_b32 v48, v50
    v_permlane16_swap_b32 v49, v51
    v_cvt_pk_bf16_f32 v16, v44, v46
    v_cvt_pk_bf16_f32 v17, v45, v47
    ds_write_b64 v4, v[16:17] offset:1024
    v_pk_fma_f32 v[56:57], v[56:57], v[66:67], v[68:69] op_sel_hi:[1,0,0]
    v_pk_fma_f32 v[58:59], v[58:59], v[66:67], v[68:69] op_sel_hi:[1,0,0]
    v_permlane16_swap_b32 v52, v54
    v_permlane16_swap_b32 v53, v55
    v_cvt_pk_bf16_f32 v18, v48, v50
    v_cvt_pk_bf16_f32 v19, v49, v51
    ds_write_b64 v4, v[18:19] offset:1280
    v_pk_fma_f32 v[60:61], v[60:61], v[66:67], v[68:69] op_sel_hi:[1,0,0]
    v_pk_fma_f32 v[62:63], v[62:63], v[66:67], v[68:69] op_sel_hi:[1,0,0]
    v_permlane16_swap_b32 v56, v58
    v_permlane16_swap_b32 v57, v59
    v_cvt_pk_bf16_f32 v20, v52, v54
    v_cvt_pk_bf16_f32 v21, v53, v55
    ds_write_b64 v4, v[20:21] offset:1536
    v_cvt_pk_bf16_f32 v22, v56, v58
    v_cvt_pk_bf16_f32 v23, v57, v59
    ds_write_b64 v4, v[22:23] offset:1792
    v_permlane16_swap_b32 v60, v62
    v_permlane16_swap_b32 v61, v63
    v_cvt_pk_bf16_f32 v24, v60, v62
    v_cvt_pk_bf16_f32 v25, v61, v63
    ds_write_b64 v4, v[24:25] offset:2048
    s_waitcnt vmcnt(0)
    s_mov_b32 s41, 400000
L_non_ln:
    v_readfirstlane_b32 s40, v83
    s_sub_u32 s41, s41, 1
    s_nop 0
    s_cmp_lg_u32 s40, 0
    s_nop 1
    s_cbranch_scc1 L_non_ln_ok
    s_cmp_eq_u32 s41, 0
    s_cbranch_scc1 L_non_ln_ok
    s_sleep 1
    global_load_dword v83, v82, s[76:77] sc1
    s_waitcnt vmcnt(0)
    s_branch L_non_ln
L_non_ln_ok:
    v_lshlrev_b32 v88, 3, v81
    v_lshrrev_b32 v88, v88, s40
    v_and_b32 v88, 0xff, v88
    v_lshl_or_b32 v88, v88, 15, v88
    v_and_b32 v84, 0x10001, v88
    v_lshrrev_b32 v85, 2, v88
    v_and_b32 v85, 0x10001, v85
    v_lshrrev_b32 v86, 4, v88
    v_and_b32 v86, 0x10001, v86
    v_lshrrev_b32 v87, 6, v88
    v_and_b32 v87, 0x10001, v87
    s_waitcnt lgkmcnt(0)
    s_barrier
    ds_read_b64_tr_b16 v[8:9], v5 offset:0
    ds_read_b64_tr_b16 v[10:11], v5 offset:9472
    ds_read_b64_tr_b16 v[12:13], v5 offset:512
    ds_read_b64_tr_b16 v[14:15], v5 offset:9984
    ds_read_b64_tr_b16 v[16:17], v5 offset:1024
    ds_read_b64_tr_b16 v[18:19], v5 offset:10496
    ds_read_b64_tr_b16 v[20:21], v5 offset:1536
    ds_read_b64_tr_b16 v[22:23], v5 offset:11008
    ds_read_b64_tr_b16 v[24:25], v76 offset:0
    ds_read_b64_tr_b16 v[26:27], v76 offset:9472
    s_waitcnt lgkmcnt(8)
    v_and_or_b32 v8, v8, s17, v84
    v_and_or_b32 v9, v9, s17, v85
    v_and_or_b32 v10, v10, s17, v86
    v_and_or_b32 v11, v11, s17, v87
    global_store_dwordx4 v7, v[8:11], s[78:79] sc1
    s_waitcnt lgkmcnt(6)
    v_and_or_b32 v12, v12, s17, v84
    v_and_or_b32 v13, v13, s17, v85
    v_and_or_b32 v14, v14, s17, v86
    v_and_or_b32 v15, v15, s17, v87
    global_store_dwordx4 v78, v[12:15], s[78:79] sc1
    s_waitcnt lgkmcnt(4)
    v_and_or_b32 v16, v16, s17, v84
    v_and_or_b32 v17, v17, s17, v85
    v_and_or_b32 v18, v18, s17, v86
    v_and_or_b32 v19, v19, s17, v87
    global_store_dwordx4 v79, v[16:19], s[78:79] sc1
    s_waitcnt lgkmcnt(2)
    v_and_or_b32 v20, v20, s17, v84
    v_and_or_b32 v21, v21, s17, v85
    v_and_or_b32 v22, v22, s17, v86
    v_and_or_b32 v23, v23, s17, v87
    global_store_dwordx4 v80, v[20:23], s[78:79] sc1
    s_waitcnt lgkmcnt(0)
    v_and_or_b32 v24, v24, s17, v84
    v_and_or_b32 v25, v25, s17, v85
    v_and_or_b32 v26, v26, s17, v86
    v_and_or_b32 v27, v27, s17, v87
    global_store_dwordx4 v77, v[24:27], s[78:79] sc1
    s_nop 1
    s_branch L_f_end
L_f_gvb:
    s_mov_b32 s15, 0xffff0000
    v_lshlrev_b32 v6, 9, v1
    v_lshl_add_u32 v6, v2, 5, v6
    v_and_b32 v7, 127, v0
    v_lshlrev_b32 v7, 2, v7
    s_mul_i32 s12, s10, 13824
    s_lshl_b32 s14, s11, 9
    s_add_u32 s12, s12, s14
    v_add_u32 v3, s12, v7
    s_waitcnt vmcnt(6)
    v_lshlrev_b32 v53, 16, v44
    v_mul_f32 v62, 0xbfb8aa3b, v53
    v_exp_f32 v62, v62
    s_nop 0
    v_add_f32 v62, 1.0, v62
    v_rcp_f32 v62, v62
    s_nop 0
    v_mul_f32 v53, v53, v62
    v_cvt_pk_bf16_f32 v53, v53, v53
    v_and_b32 v53, 0xffff0000, v53
    s_nop 1
    v_mov_b32_dpp v36, v53 row_newbcast:0 row_mask:0xf bank_mask:0xf
    v_mov_b32_dpp v38, v53 row_newbcast:1 row_mask:0xf bank_mask:0xf
    v_mov_b32_dpp v40, v53 row_newbcast:2 row_mask:0xf bank_mask:0xf
    v_mov_b32_dpp v42, v53 row_newbcast:3 row_mask:0xf bank_mask:0xf
    v_mov_b32_dpp v44, v53 row_newbcast:4 row_mask:0xf bank_mask:0xf
    v_mov_b32_dpp v46, v53 row_newbcast:5 row_mask:0xf bank_mask:0xf
    s_waitcnt vmcnt(5)
    v_lshlrev_b32 v62, 16, v8
    v_and_b32 v63, s15, v8
    v_lshlrev_b32 v64, 16, v9
    v_and_b32 v65, s15, v9
    v_lshlrev_b32 v66, 16, v10
    v_and_b32 v67, s15, v10
    v_lshlrev_b32 v68, 16, v11
    v_and_b32 v69, s15, v11
    v_pk_mul_f32 v[54:55], v[62:63], v[36:37] op_sel_hi:[1,0]
    v_pk_mul_f32 v[56:57], v[64:65], v[36:37] op_sel_hi:[1,0]
    v_pk_mul_f32 v[58:59], v[66:67], v[36:37] op_sel_hi:[1,0]
    v_pk_mul_f32 v[60:61], v[68:69], v[36:37] op_sel_hi:[1,0]
    s_waitcnt vmcnt(4)
    v_lshlrev_b32 v62, 16, v12
    v_and_b32 v63, s15, v12
    v_lshlrev_b32 v64, 16, v13
    v_and_b32 v65, s15, v13
    v_lshlrev_b32 v66, 16, v14
    v_and_b32 v67, s15, v14
    v_lshlrev_b32 v68, 16, v15
    v_and_b32 v69, s15, v15
    v_pk_fma_f32 v[54:55], v[62:63], v[38:39], v[54:55] op_sel_hi:[1,0,1]
    v_pk_fma_f32 v[56:57], v[64:65], v[38:39], v[56:57] op_sel_hi:[1,0,1]
    v_pk_fma_f32 v[58:59], v[66:67], v[38:39], v[58:59] op_sel_hi:[1,0,1]
    v_pk_fma_f32 v[60:61], v[68:69], v[38:39], v[60:61] op_sel_hi:[1,0,1]
    s_waitcnt vmcnt(3)
    v_lshlrev_b32 v62, 16, v16
    v_and_b32 v63, s15, v16
    v_lshlrev_b32 v64, 16, v17
    v_and_b32 v65, s15, v17
    v_lshlrev_b32 v66, 16, v18
    v_and_b32 v67, s15, v18
    v_lshlrev_b32 v68, 16, v19
    v_and_b32 v69, s15, v19
    v_pk_fma_f32 v[54:55], v[62:63], v[40:41], v[54:55] op_sel_hi:[1,0,1]
    v_pk_fma_f32 v[56:57], v[64:65], v[40:41], v[56:57] op_sel_hi:[1,0,1]
    v_pk_fma_f32 v[58:59], v[66:67], v[40:41], v[58:59] op_sel_hi:[1,0,1]
    v_pk_fma_f32 v[60:61], v[68:69], v[40:41], v[60:61] op_sel_hi:[1,0,1]
    s_waitcnt vmcnt(2)
    v_lshlrev_b32 v62, 16, v20
    v_and_b32 v63, s15, v20
    v_lshlrev_b32 v64, 16, v21
    v_and_b32 v65, s15, v21
    v_lshlrev_b32 v66, 16, v22
    v_and_b32 v67, s15, v22
    v_lshlrev_b32 v68, 16, v23
    v_and_b32 v69, s15, v23
    v_pk_fma_f32 v[54:55], v[62:63], v[42:43], v[54:55] op_sel_hi:[1,0,1]
    v_pk_fma_f32 v[56:57], v[64:65], v[42:43], v[56:57] op_sel_hi:[1,0,1]
    v_pk_fma_f32 v[58:59], v[66:67], v[42:43], v[58:59] op_sel_hi:[1,0,1]
    v_pk_fma_f32 v[60:61], v[68:69], v[42:43], v[60:61] op_sel_hi:[1,0,1]
    s_waitcnt vmcnt(1)
    v_lshlrev_b32 v62, 16, v24
    v_and_b32 v63, s15, v24
    v_lshlrev_b32 v64, 16, v25
    v_and_b32 v65, s15, v25
    v_lshlrev_b32 v66, 16, v26
    v_and_b32 v67, s15, v26
    v_lshlrev_b32 v68, 16, v27
    v_and_b32 v69, s15, v27
    v_pk_fma_f32 v[54:55], v[62:63], v[44:45], v[54:55] op_sel_hi:[1,0,1]
    v_pk_fma_f32 v[56:57], v[64:65], v[44:45], v[56:57] op_sel_hi:[1,0,1]
    v_pk_fma_f32 v[58:59], v[66:67], v[44:45], v[58:59] op_sel_hi:[1,0,1]
    v_pk_fma_f32 v[60:61], v[68:69], v[44:45], v[60:61] op_sel_hi:[1,0,1]
    s_waitcnt vmcnt(0)
    v_mov_b32 v32, 0
    global_load_dword v33, v32, s[76:77] sc1
    v_lshlrev_b32 v62, 16, v28
    v_and_b32 v63, s15, v28
    v_lshlrev_b32 v64, 16, v29
    v_and_b32 v65, s15, v29
    v_lshlrev_b32 v66, 16, v30
    v_and_b32 v67, s15, v30
    v_lshlrev_b32 v68, 16, v31
    v_and_b32 v69, s15, v31
    v_pk_fma_f32 v[54:55], v[62:63], v[46:47], v[54:55] op_sel_hi:[1,0,1]
    v_pk_fma_f32 v[56:57], v[64:65], v[46:47], v[56:57] op_sel_hi:[1,0,1]
    v_pk_fma_f32 v[58:59], v[66:67], v[46:47], v[58:59] op_sel_hi:[1,0,1]
    v_pk_fma_f32 v[60:61], v[68:69], v[46:47], v[60:61] op_sel_hi:[1,0,1]
    ds_write_b128 v6, v[54:57] offset:32768
    ds_write_b128 v6, v[58:61] offset:32784
    s_waitcnt lgkmcnt(0)
    s_barrier
    ds_read2st64_b32 v[8:9], v7 offset0:128 offset1:130
    ds_read2st64_b32 v[10:11], v7 offset0:132 offset1:134
    ds_read2st64_b32 v[12:13], v7 offset0:136 offset1:138
    ds_read2st64_b32 v[14:15], v7 offset0:140 offset1:142
    ds_read2st64_b32 v[16:17], v7 offset0:144 offset1:146
    ds_read2st64_b32 v[18:19], v7 offset0:148 offset1:150
    ds_read2st64_b32 v[20:21], v7 offset0:152 offset1:154
    ds_read2st64_b32 v[22:23], v7 offset0:156 offset1:158
    s_waitcnt lgkmcnt(0)
    v_pk_add_f32 v[8:9], v[8:9], v[16:17]
    v_pk_add_f32 v[10:11], v[10:11], v[18:19]
    v_pk_add_f32 v[12:13], v[12:13], v[20:21]
    v_pk_add_f32 v[14:15], v[14:15], v[22:23]
    v_pk_add_f32 v[8:9], v[8:9], v[12:13]
    v_pk_add_f32 v[10:11], v[10:11], v[14:15]
    v_pk_add_f32 v[8:9], v[8:9], v[10:11]
    v_add_f32 v8, v8, v9
    s_cmp_ge_u32 s36, 2
    s_nop 0
    s_cbranch_scc1 L_gv_nost
    global_store_dword v3, v8, s[78:79] offset:0 sc1
L_gv_nost:
    s_cmp_lt_u32 s39, 108
    s_cbranch_scc1 L_f_fin
    s_waitcnt vmcnt(0)
    s_mov_b32 s41, 400000
L_non_gv:
    v_readfirstlane_b32 s40, v33
    s_sub_u32 s41, s41, 1
    s_nop 0
    s_cmp_lg_u32 s40, 0
    s_nop 1
    s_cbranch_scc1 L_non_gv_ok
    s_cmp_eq_u32 s41, 0
    s_cbranch_scc1 L_non_gv_ok
    s_sleep 1
    global_load_dword v33, v32, s[76:77] sc1
    s_waitcnt vmcnt(0)
    s_branch L_non_gv
L_non_gv_ok:
    s_lshl_b32 s43, s3, 6
    s_add_u32 s43, s43, 86016
    v_mov_b32 v30, s43
    v_mov_b32 v31, s40
    s_cmp_lg_u32 s36, 0
    s_waitcnt vmcnt(0)
    s_barrier
    s_cbranch_scc1 L_f_end
    s_mov_b64 exec, 1
    global_store_dword v30, v31, s[78:79] sc1
    s_mov_b64 exec, -1
    s_branch L_f_end
L_f_fin:
    s_cmp_ge_u32 s36, 2
    s_cbranch_scc1 L_f_end
    s_lshl_b32 s12, s11, 1
    s_add_u32 s12, s12, s36
    s_lshl_b32 s12, s12, 2
    s_add_u32 s12, s12, 40
    v_mov_b32 v9, s12
    v_mov_b32 v10, 1
    v_add_u32 v7, s14, v7
    s_waitcnt vmcnt(0)
    s_mov_b64 exec, 1
    global_atomic_add v11, v9, v10, s[76:77] sc0
    s_waitcnt vmcnt(0)
    v_readfirstlane_b32 s12, v11
    s_mov_b64 exec, -1
    s_nop 0
    s_cmp_lg_u32 s12, 5
    s_cbranch_scc1 L_f_end
    v_mov_b32 v9, v7
    global_load_dword v12, v9, s[78:79] offset:0 sc1
    v_add_u32 v9, 13824, v9
    global_load_dword v13, v9, s[78:79] offset:0 sc1
    v_add_u32 v9, 13824, v9
    global_load_dword v14, v9, s[78:79] offset:0 sc1
    v_add_u32 v9, 13824, v9
    global_load_dword v15, v9, s[78:79] offset:0 sc1
    v_add_u32 v9, 13824, v9
    global_load_dword v16, v9, s[78:79] offset:0 sc1
    v_add_u32 v9, 13824, v9
    global_load_dword v17, v9, s[78:79] offset:0 sc1
    v_subrev_u32 v9, 9216, v7
    v_cmp_gt_u32 vcc, 2304, v9
    s_nop 1
    v_cndmask_b32 v10, 0, 1.0, vcc
    v_add_u32 v7, 93696, v7
    s_waitcnt vmcnt(0)
    v_add_f32 v12, v12, v13
    v_add_f32 v14, v14, v15
    v_add_f32 v16, v16, v17
    v_add_f32 v12, v12, v14
    v_add_f32 v12, v12, v16
    v_cvt_pk_bf16_f32 v12, v12, v12
    v_and_b32 v12, 0xffff0000, v12
    v_add_f32 v12, v10, v12
    v_cvt_pk_bf16_f32 v12, v12, v12
    v_and_b32 v12, 0xffff0000, v12
    global_store_dword v7, v12, s[78:79] sc1
    s_nop 0
    s_branch L_f_end
L_f_chan:
    v_subrev_u32 v24, 238, v0
    v_med3_i32 v24, v24, 0, 2
    v_lshlrev_b32 v24, 6, v24
    v_lshlrev_b32 v5, 3, v0
    v_sub_u32 v25, v24, v5
    v_add_u32 v25, 2047, v25
    v_cvt_f32_u32 v32, v25
    v_lshlrev_b32 v24, 1, v24
    v_sub_u32 v24, -6048, v24
    v_subrev_f32 v33, 0x3f800000, v32
    v_subrev_f32 v34, 0x40000000, v32
    v_subrev_f32 v35, 0x40400000, v32
    v_subrev_f32 v36, 0x40800000, v32
    v_subrev_f32 v37, 0x40a00000, v32
    v_subrev_f32 v38, 0x40c00000, v32
    v_subrev_f32 v39, 0x40e00000, v32
    v_subrev_f32 v40, 0x41000000, v32
    v_cvt_pk_bf16_f32 v42, v32, v33
    v_cvt_pk_bf16_f32 v43, v34, v35
    v_cvt_pk_bf16_f32 v44, v36, v37
    v_cvt_pk_bf16_f32 v45, v38, v39
    v_cvt_pk_bf16_f32 v46, v40, v40
    v_and_b32 v112, 0xffff, v42
    v_lshrrev_b32 v113, 16, v42
    v_and_b32 v114, 0xffff, v43
    v_lshrrev_b32 v115, 16, v43
    v_and_b32 v116, 0xffff, v44
    v_lshrrev_b32 v117, 16, v44
    v_and_b32 v118, 0xffff, v45
    v_lshrrev_b32 v119, 16, v45
    v_and_b32 v120, 0xffff, v46
    v_lshl_add_u32 v112, v112, 1, v24
    v_lshl_add_u32 v113, v113, 1, v24
    v_lshl_add_u32 v114, v114, 1, v24
    v_lshl_add_u32 v115, v115, 1, v24
    v_lshl_add_u32 v116, v116, 1, v24
    v_lshl_add_u32 v117, v117, 1, v24
    v_lshl_add_u32 v118, v118, 1, v24
    v_lshl_add_u32 v119, v119, 1, v24
    v_lshl_add_u32 v120, v120, 1, v24
    v_and_b32 v2, 15, v0
    v_bfe_u32 v3, v0, 4, 3
    v_lshrrev_b32 v27, 7, v0
    v_lshl_add_u32 v27, v27, 4, v2
    v_sub_u32 v25, 4, v3
    v_med3_i32 v25, v25, 0, 3
    v_lshlrev_b32 v24, v25, v27
    v_min_u32 v25, 6, v3
    v_lshlrev_b32 v25, 7, v25
    v_cmp_eq_u32 vcc, 1, v3
    s_nop 1
    v_cndmask_b32 v25, v25, 4, vcc
    v_add_lshl_u32 v122, v24, v25, 1
    v_cmp_le_u32 vcc, 4, v3
    s_nop 1
    v_cndmask_b32 v25, 2, 64, vcc
    v_cmp_le_u32 vcc, 3, v3
    s_nop 1
    v_cndmask_b32 v26, 2, 64, vcc
    v_add_u32 v123, v25, v122
    v_lshl_add_u32 v124, v26, 1, v122
    v_lshl_add_u32 v125, v26, 1, v123
    v_bfe_u32 v3, v0, 4, 2
    v_bfe_u32 v24, v0, 6, 1
    v_lshl_add_u32 v24, v24, 4, v2
    v_min_u32 v24, 20, v24
    v_mul_u32_u24 v126, 528, v24
    v_lshl_add_u32 v126, v3, 4, v126
    v_mul_u32_u24 v127, 528, v27
    v_lshl_add_u32 v127, v3, 4, v127
    v_lshlrev_b32 v4, 2, v1
    s_mov_b32 s12, 0xffff0000
    v_lshlrev_b32 v1, 4, v0
    v_lshrrev_b32 v96, 1, v0
    v_mul_u32_u24 v96, 18432, v96
    v_and_b32 v97, 1, v0
    v_lshl_add_u32 v96, v97, 4, v96
    s_lshl_b32 s24, s37, 5
    s_add_u32 s24, s24, 131072
    v_add_u32 v96, s24, v96
    v_and_b32 v103, 7, v0
    v_min_u32 v97, 5, v103
    v_bfe_u32 v98, v0, 3, 1
    v_mul_u32_u24 v98, 2304, v98
    v_mul_u32_u24 v97, 13824, v97
    s_lshl_b32 s24, s37, 2
    v_add3_u32 v97, v97, v98, s24
    v_bfe_u32 v99, v0, 2, 4
    v_min_u32 v99, 11, v99
    v_and_b32 v100, 1, v99
    v_lshrrev_b32 v99, 1, v99
    v_mul_u32_u24 v99, 9, v99
    v_mul_u32_u24 v100, 576, v100
    v_add_u32 v100, s37, v100
    v_lshrrev_b32 v100, 7, v100
    v_add_lshl_u32 v98, v99, v100, 6
    v_add_u32 v98, 94208, v98
    v_xor_b32 v121, 32, v96
    v_sub_u32 v100, 2031, v2
    v_and_b32 v101, 3, v100
    v_and_b32 v100, -4, v100
    v_mul_u32_u24 v101, 4160, v101
    v_lshl_add_u32 v100, v100, 1, v101
    v_lshl_add_u32 v100, v3, 4, v100
    s_lshl_b32 s24, s36, 7
    s_sub_u32 s25, -3632, s24
    v_add_u32 v5, s25, v100
    v_lshlrev_b32 v100, 5, v2
    v_lshl_add_u32 v100, v3, 4, v100
    s_sub_u32 s25, 17040, s24
    v_add_u32 v6, s25, v100
    v_bfe_u32 v100, v0, 3, 2
    v_mul_u32_u24 v101, 4160, v100
    v_lshrrev_b32 v100, 1, v100
    v_sub_u32 v102, v103, v100
    v_lshl_add_u32 v102, v102, 2, v101
    v_min_u32 v104, 29, v0
    v_lshlrev_b32 v104, 4, v104
    v_add_u32 v100, 8332, v1
    v_add_u32 v101, 12492, v1
    v_mov_b32 v20, 0
    v_mov_b32 v21, 0
    v_mov_b32 v22, 0
    v_mov_b32 v23, 0
    ds_write_b32 v20, v20 offset:27996
    s_and_b32 s24, s37, 1
    s_lshl_b32 s24, s24, 4
    s_waitcnt lgkmcnt(0)
    s_lshr_b32 s26, s26, s24
    s_lshr_b32 s27, s27, s24
    s_lshl_b32 s26, s26, 16
    s_lshl_b32 s27, s27, 16
    v_mov_b32 v7, s27
    v_mov_b32 v16, 0x3fb8aa3b
    v_mul_f32 v16, s26, v16
    v_exp_f32 v16, v16
    s_nop 0
    v_cvt_pk_bf16_f32 v16, v16, v16
    v_and_b32 v16, 0xffff0000, v16
    s_waitcnt vmcnt(0)
    v_mov_b32 v110, 0
    global_load_dword v111, v110, s[76:77] sc1
    v_lshlrev_b32 v10, 16, v10
    v_lshlrev_b32 v11, 16, v11
    v_mul_f32 v10, v16, v10
    v_mul_f32 v11, v16, v11
    v_mul_f32 v10, 0x3fb8aa3b, v10
    v_mul_f32 v11, 0x3e22f983, v11
    s_and_b32 s24, s36, 1
    s_lshl_b32 m0, s24, 8
    s_cmp_ge_u32 s36, 2
    s_cbranch_scc1 L_ch_u
    v_mul_f32 v24, 0x41000000, v10
    v_mul_f32 v35, 0x41000000, v11
    v_mul_f32 v27, 0x42000000, v10
    v_mul_f32 v49, 0x42000000, v11
    v_exp_f32 v24, v24
    v_fract_f32 v35, v35
    v_exp_f32 v27, v27
    v_fract_f32 v49, v49
    v_cos_f32 v34, v35
    v_sin_f32 v35, v35
    v_cos_f32 v48, v49
    v_sin_f32 v49, v49
    v_mul_f32 v34, v24, v34
    v_mul_f32 v35, v24, v35
    v_mul_f32 v48, v27, v48
    v_mul_f32 v49, v27, v49
    v_mov_b32 v32, 1.0
    v_mov_b32 v33, 0
    v_pk_mul_f32 v[36:37], v[34:35], v[34:35] op_sel_hi:[0,1]
    v_pk_fma_f32 v[36:37], v[34:35], v[34:35], v[36:37] op_sel:[1,1,0] op_sel_hi:[1,0,1] neg_lo:[1,0,0]
    v_pk_mul_f32 v[38:39], v[36:37], v[34:35] op_sel_hi:[0,1]
    v_pk_fma_f32 v[38:39], v[36:37], v[34:35], v[38:39] op_sel:[1,1,0] op_sel_hi:[1,0,1] neg_lo:[1,0,0]
    v_pk_mul_f32 v[40:41], v[32:33], v[48:49] op_sel_hi:[0,1]
    v_pk_mul_f32 v[42:43], v[34:35], v[48:49] op_sel_hi:[0,1]
    v_pk_mul_f32 v[44:45], v[36:37], v[48:49] op_sel_hi:[0,1]
    v_pk_mul_f32 v[46:47], v[38:39], v[48:49] op_sel_hi:[0,1]
    v_pk_fma_f32 v[40:41], v[32:33], v[48:49], v[40:41] op_sel:[1,1,0] op_sel_hi:[1,0,1] neg_lo:[1,0,0]
    v_pk_fma_f32 v[42:43], v[34:35], v[48:49], v[42:43] op_sel:[1,1,0] op_sel_hi:[1,0,1] neg_lo:[1,0,0]
    v_pk_fma_f32 v[44:45], v[36:37], v[48:49], v[44:45] op_sel:[1,1,0] op_sel_hi:[1,0,1] neg_lo:[1,0,0]
    v_pk_fma_f32 v[46:47], v[38:39], v[48:49], v[46:47] op_sel:[1,1,0] op_sel_hi:[1,0,1] neg_lo:[1,0,0]
    v_cvt_pk_bf16_f32 v80, v32, v33
    ds_write_addtid_b32 v80 offset:0
    v_cvt_pk_bf16_f32 v81, v34, v35
    ds_write_addtid_b32 v81 offset:528
    v_cvt_pk_bf16_f32 v82, v36, v37
    ds_write_addtid_b32 v82 offset:1056
    v_cvt_pk_bf16_f32 v83, v38, v39
    ds_write_addtid_b32 v83 offset:1584
    v_pk_mul_f32 v[32:33], v[40:41], v[48:49] op_sel_hi:[0,1]
    v_pk_mul_f32 v[34:35], v[42:43], v[48:49] op_sel_hi:[0,1]
    v_pk_mul_f32 v[36:37], v[44:45], v[48:49] op_sel_hi:[0,1]
    v_pk_mul_f32 v[38:39], v[46:47], v[48:49] op_sel_hi:[0,1]
    v_pk_fma_f32 v[32:33], v[40:41], v[48:49], v[32:33] op_sel:[1,1,0] op_sel_hi:[1,0,1] neg_lo:[1,0,0]
    v_pk_fma_f32 v[34:35], v[42:43], v[48:49], v[34:35] op_sel:[1,1,0] op_sel_hi:[1,0,1] neg_lo:[1,0,0]
    v_pk_fma_f32 v[36:37], v[44:45], v[48:49], v[36:37] op_sel:[1,1,0] op_sel_hi:[1,0,1] neg_lo:[1,0,0]
    v_pk_fma_f32 v[38:39], v[46:47], v[48:49], v[38:39] op_sel:[1,1,0] op_sel_hi:[1,0,1] neg_lo:[1,0,0]
    v_cvt_pk_bf16_f32 v84, v40, v41
    ds_write_addtid_b32 v84 offset:2112
    v_cvt_pk_bf16_f32 v85, v42, v43
    ds_write_addtid_b32 v85 offset:2640
    v_cvt_pk_bf16_f32 v86, v44, v45
    ds_write_addtid_b32 v86 offset:3168
    v_cvt_pk_bf16_f32 v87, v46, v47
    ds_write_addtid_b32 v87 offset:3696
    v_pk_mul_f32 v[40:41], v[32:33], v[48:49] op_sel_hi:[0,1]
    v_pk_mul_f32 v[42:43], v[34:35], v[48:49] op_sel_hi:[0,1]
    v_pk_mul_f32 v[44:45], v[36:37], v[48:49] op_sel_hi:[0,1]
    v_pk_mul_f32 v[46:47], v[38:39], v[48:49] op_sel_hi:[0,1]
    v_pk_fma_f32 v[40:41], v[32:33], v[48:49], v[40:41] op_sel:[1,1,0] op_sel_hi:[1,0,1] neg_lo:[1,0,0]
    v_pk_fma_f32 v[42:43], v[34:35], v[48:49], v[42:43] op_sel:[1,1,0] op_sel_hi:[1,0,1] neg_lo:[1,0,0]
    v_pk_fma_f32 v[44:45], v[36:37], v[48:49], v[44:45] op_sel:[1,1,0] op_sel_hi:[1,0,1] neg_lo:[1,0,0]
    v_pk_fma_f32 v[46:47], v[38:39], v[48:49], v[46:47] op_sel:[1,1,0] op_sel_hi:[1,0,1] neg_lo:[1,0,0]
    v_cvt_pk_bf16_f32 v80, v32, v33
    ds_write_addtid_b32 v80 offset:4224
    v_cvt_pk_bf16_f32 v81, v34, v35
    ds_write_addtid_b32 v81 offset:4752
    v_cvt_pk_bf16_f32 v82, v36, v37
    ds_write_addtid_b32 v82 offset:5280
    v_cvt_pk_bf16_f32 v83, v38, v39
    ds_write_addtid_b32 v83 offset:5808
    v_pk_mul_f32 v[32:33], v[40:41], v[48:49] op_sel_hi:[0,1]
    v_pk_mul_f32 v[34:35], v[42:43], v[48:49] op_sel_hi:[0,1]
    v_pk_mul_f32 v[36:37], v[44:45], v[48:49] op_sel_hi:[0,1]
    v_pk_mul_f32 v[38:39], v[46:47], v[48:49] op_sel_hi:[0,1]
    v_pk_fma_f32 v[32:33], v[40:41], v[48:49], v[32:33] op_sel:[1,1,0] op_sel_hi:[1,0,1] neg_lo:[1,0,0]
    v_pk_fma_f32 v[34:35], v[42:43], v[48:49], v[34:35] op_sel:[1,1,0] op_sel_hi:[1,0,1] neg_lo:[1,0,0]
    v_pk_fma_f32 v[36:37], v[44:45], v[48:49], v[36:37] op_sel:[1,1,0] op_sel_hi:[1,0,1] neg_lo:[1,0,0]
    v_pk_fma_f32 v[38:39], v[46:47], v[48:49], v[38:39] op_sel:[1,1,0] op_sel_hi:[1,0,1] neg_lo:[1,0,0]
    v_cvt_pk_bf16_f32 v84, v40, v41
    ds_write_addtid_b32 v84 offset:6336
    v_cvt_pk_bf16_f32 v85, v42, v43
    ds_write_addtid_b32 v85 offset:6864
    v_cvt_pk_bf16_f32 v86, v44, v45
    ds_write_addtid_b32 v86 offset:7392
    v_cvt_pk_bf16_f32 v87, v46, v47
    ds_write_addtid_b32 v87 offset:7920
    v_pk_mul_f32 v[40:41], v[32:33], v[48:49] op_sel_hi:[0,1]
    v_pk_mul_f32 v[42:43], v[34:35], v[48:49] op_sel_hi:[0,1]
    v_pk_mul_f32 v[44:45], v[36:37], v[48:49] op_sel_hi:[0,1]
    v_pk_mul_f32 v[46:47], v[38:39], v[48:49] op_sel_hi:[0,1]
    v_pk_fma_f32 v[40:41], v[32:33], v[48:49], v[40:41] op_sel:[1,1,0] op_sel_hi:[1,0,1] neg_lo:[1,0,0]
    v_pk_fma_f32 v[42:43], v[34:35], v[48:49], v[42:43] op_sel:[1,1,0] op_sel_hi:[1,0,1] neg_lo:[1,0,0]
    v_pk_fma_f32 v[44:45], v[36:37], v[48:49], v[44:45] op_sel:[1,1,0] op_sel_hi:[1,0,1] neg_lo:[1,0,0]
    v_pk_fma_f32 v[46:47], v[38:39], v[48:49], v[46:47] op_sel:[1,1,0] op_sel_hi:[1,0,1] neg_lo:[1,0,0]
    v_cvt_pk_bf16_f32 v80, v32, v33
    ds_write_addtid_b32 v80 offset:8448
    v_cvt_pk_bf16_f32 v81, v34, v35
    ds_write_addtid_b32 v81 offset:8976
    v_cvt_pk_bf16_f32 v82, v36, v37
    ds_write_addtid_b32 v82 offset:9504
    v_cvt_pk_bf16_f32 v83, v38, v39
    ds_write_addtid_b32 v83 offset:10032
    v_pk_mul_f32 v[32:33], v[40:41], v[48:49] op_sel_hi:[0,1]
    v_pk_mul_f32 v[34:35], v[42:43], v[48:49] op_sel_hi:[0,1]
    v_pk_mul_f32 v[36:37], v[44:45], v[48:49] op_sel_hi:[0,1]
    v_pk_mul_f32 v[38:39], v[46:47], v[48:49] op_sel_hi:[0,1]
    v_pk_fma_f32 v[32:33], v[40:41], v[48:49], v[32:33] op_sel:[1,1,0] op_sel_hi:[1,0,1] neg_lo:[1,0,0]
    v_pk_fma_f32 v[34:35], v[42:43], v[48:49], v[34:35] op_sel:[1,1,0] op_sel_hi:[1,0,1] neg_lo:[1,0,0]
    v_pk_fma_f32 v[36:37], v[44:45], v[48:49], v[36:37] op_sel:[1,1,0] op_sel_hi:[1,0,1] neg_lo:[1,0,0]
    v_pk_fma_f32 v[38:39], v[46:47], v[48:49], v[38:39] op_sel:[1,1,0] op_sel_hi:[1,0,1] neg_lo:[1,0,0]
    v_cvt_pk_bf16_f32 v84, v40, v41
    ds_write_addtid_b32 v84 offset:10560
    v_cvt_pk_bf16_f32 v85, v42, v43
    ds_write_addtid_b32 v85 offset:11088
    v_cvt_pk_bf16_f32 v86, v44, v45
    ds_write_addtid_b32 v86 offset:11616
    v_cvt_pk_bf16_f32 v87, v46, v47
    ds_write_addtid_b32 v87 offset:12144
    v_pk_mul_f32 v[40:41], v[32:33], v[48:49] op_sel_hi:[0,1]
    v_pk_mul_f32 v[42:43], v[34:35], v[48:49] op_sel_hi:[0,1]
    v_pk_mul_f32 v[44:45], v[36:37], v[48:49] op_sel_hi:[0,1]
    v_pk_mul_f32 v[46:47], v[38:39], v[48:49] op_sel_hi:[0,1]
    v_pk_fma_f32 v[40:41], v[32:33], v[48:49], v[40:41] op_sel:[1,1,0] op_sel_hi:[1,0,1] neg_lo:[1,0,0]
    v_pk_fma_f32 v[42:43], v[34:35], v[48:49], v[42:43] op_sel:[1,1,0] op_sel_hi:[1,0,1] neg_lo:[1,0,0]
    v_pk_fma_f32 v[44:45], v[36:37], v[48:49], v[44:45] op_sel:[1,1,0] op_sel_hi:[1,0,1] neg_lo:[1,0,0]
    v_pk_fma_f32 v[46:47], v[38:39], v[48:49], v[46:47] op_sel:[1,1,0] op_sel_hi:[1,0,1] neg_lo:[1,0,0]
    v_cvt_pk_bf16_f32 v80, v32, v33
    ds_write_addtid_b32 v80 offset:12672
    v_cvt_pk_bf16_f32 v81, v34, v35
    ds_write_addtid_b32 v81 offset:13200
    v_cvt_pk_bf16_f32 v82, v36, v37
    ds_write_addtid_b32 v82 offset:13728
    v_cvt_pk_bf16_f32 v83, v38, v39
    ds_write_addtid_b32 v83 offset:14256
    v_cvt_pk_bf16_f32 v84, v40, v41
    ds_write_addtid_b32 v84 offset:14784
    v_cvt_pk_bf16_f32 v85, v42, v43
    ds_write_addtid_b32 v85 offset:15312
    v_cvt_pk_bf16_f32 v86, v44, v45
    ds_write_addtid_b32 v86 offset:15840
    v_cvt_pk_bf16_f32 v87, v46, v47
    ds_write_addtid_b32 v87 offset:16368
    s_nop 0
    s_branch L_ch_join
L_ch_u:
    v_mul_f32 v76, 0x3f800000, v10
    v_mul_f32 v25, 0x3f800000, v11
    v_mul_f32 v78, 0x40800000, v10
    v_mul_f32 v29, 0x40800000, v11
    v_mul_f32 v79, 0x43800000, v10
    v_mul_f32 v31, 0x43800000, v11
    v_mul_f32 v77, 0x44000000, v10
    v_mul_f32 v33, 0x44000000, v11
    v_exp_f32 v76, v76
    v_fract_f32 v25, v25
    v_exp_f32 v78, v78
    v_fract_f32 v29, v29
    v_exp_f32 v79, v79
    v_fract_f32 v31, v31
    v_exp_f32 v77, v77
    v_fract_f32 v33, v33
    v_cos_f32 v24, v25
    v_sin_f32 v25, v25
    v_cos_f32 v28, v29
    v_sin_f32 v29, v29
    v_cos_f32 v30, v31
    v_sin_f32 v31, v31
    v_cos_f32 v32, v33
    v_sin_f32 v33, v33
    v_mul_f32 v24, v76, v24
    v_mul_f32 v25, v76, v25
    v_mul_f32 v28, v78, v28
    v_mul_f32 v29, v78, v29
    v_mul_f32 v30, v79, v30
    v_mul_f32 v31, v79, v31
    v_mul_f32 v32, v77, v32
    v_mul_f32 v33, v77, v33
    v_lshlrev_b32 v12, 16, v12
    v_lshlrev_b32 v13, 16, v13
    v_lshlrev_b32 v14, 16, v14
    v_lshlrev_b32 v15, 16, v15
    v_pk_mul_f32 v[12:13], v[12:13], v[16:17] op_sel_hi:[1,0]
    v_pk_mul_f32 v[34:35], v[14:15], v[12:13] op_sel_hi:[0,1]
    v_pk_mul_f32 v[26:27], v[24:25], v[24:25] op_sel_hi:[0,1]
    v_pk_fma_f32 v[34:35], v[14:15], v[12:13], v[34:35] op_sel:[1,1,0] op_sel_hi:[1,0,1] neg_lo:[1,0,0]
    v_pk_fma_f32 v[26:27], v[24:25], v[24:25], v[26:27] op_sel:[1,1,0] op_sel_hi:[1,0,1] neg_lo:[1,0,0]
    v_pk_mul_f32 v[36:37], v[34:35], v[24:25] op_sel_hi:[0,1]
    v_pk_mul_f32 v[38:39], v[34:35], v[26:27] op_sel_hi:[0,1]
    v_pk_mul_f32 v[42:43], v[34:35], v[28:29] op_sel_hi:[0,1]
    v_pk_mul_f32 v[50:51], v[34:35], v[30:31] op_sel_hi:[0,1]
    v_pk_mul_f32 v[58:59], v[34:35], v[32:33] op_sel_hi:[0,1]
    v_pk_fma_f32 v[36:37], v[34:35], v[24:25], v[36:37] op_sel:[1,1,0] op_sel_hi:[1,0,1] neg_lo:[1,0,0]
    v_pk_fma_f32 v[38:39], v[34:35], v[26:27], v[38:39] op_sel:[1,1,0] op_sel_hi:[1,0,1] neg_lo:[1,0,0]
    v_pk_fma_f32 v[42:43], v[34:35], v[28:29], v[42:43] op_sel:[1,1,0] op_sel_hi:[1,0,1] neg_lo:[1,0,0]
    v_pk_fma_f32 v[50:51], v[34:35], v[30:31], v[50:51] op_sel:[1,1,0] op_sel_hi:[1,0,1] neg_lo:[1,0,0]
    v_pk_fma_f32 v[58:59], v[34:35], v[32:33], v[58:59] op_sel:[1,1,0] op_sel_hi:[1,0,1] neg_lo:[1,0,0]
    v_cvt_pk_bf16_f32 v80, v34, -v35
    ds_write_addtid_b32 v80 offset:16896
    v_pk_mul_f32 v[40:41], v[36:37], v[26:27] op_sel_hi:[0,1]
    v_pk_mul_f32 v[44:45], v[36:37], v[28:29] op_sel_hi:[0,1]
    v_pk_mul_f32 v[46:47], v[38:39], v[28:29] op_sel_hi:[0,1]
    v_pk_mul_f32 v[52:53], v[38:39], v[30:31] op_sel_hi:[0,1]
    v_pk_mul_f32 v[54:55], v[42:43], v[30:31] op_sel_hi:[0,1]
    v_pk_mul_f32 v[60:61], v[42:43], v[32:33] op_sel_hi:[0,1]
    v_pk_mul_f32 v[62:63], v[50:51], v[32:33] op_sel_hi:[0,1]
    v_pk_mul_f32 v[66:67], v[58:59], v[32:33] op_sel_hi:[0,1]
    v_pk_fma_f32 v[40:41], v[36:37], v[26:27], v[40:41] op_sel:[1,1,0] op_sel_hi:[1,0,1] neg_lo:[1,0,0]
    v_pk_fma_f32 v[44:45], v[36:37], v[28:29], v[44:45] op_sel:[1,1,0] op_sel_hi:[1,0,1] neg_lo:[1,0,0]
    v_pk_fma_f32 v[46:47], v[38:39], v[28:29], v[46:47] op_sel:[1,1,0] op_sel_hi:[1,0,1] neg_lo:[1,0,0]
    v_pk_fma_f32 v[52:53], v[38:39], v[30:31], v[52:53] op_sel:[1,1,0] op_sel_hi:[1,0,1] neg_lo:[1,0,0]
    v_pk_fma_f32 v[54:55], v[42:43], v[30:31], v[54:55] op_sel:[1,1,0] op_sel_hi:[1,0,1] neg_lo:[1,0,0]
    v_pk_fma_f32 v[60:61], v[42:43], v[32:33], v[60:61] op_sel:[1,1,0] op_sel_hi:[1,0,1] neg_lo:[1,0,0]
    v_pk_fma_f32 v[62:63], v[50:51], v[32:33], v[62:63] op_sel:[1,1,0] op_sel_hi:[1,0,1] neg_lo:[1,0,0]
    v_pk_fma_f32 v[66:67], v[58:59], v[32:33], v[66:67] op_sel:[1,1,0] op_sel_hi:[1,0,1] neg_lo:[1,0,0]
    v_cvt_pk_bf16_f32 v81, v36, -v37
    ds_write_addtid_b32 v81 offset:17424
    v_cvt_pk_bf16_f32 v82, v38, -v39
    ds_write_addtid_b32 v82 offset:17952
    v_cvt_pk_bf16_f32 v83, v42, -v43
    ds_write_addtid_b32 v83 offset:19008
    v_cvt_pk_bf16_f32 v84, v50, -v51
    ds_write_addtid_b32 v84 offset:21120
    v_cvt_pk_bf16_f32 v85, v58, -v59
    ds_write_addtid_b32 v85 offset:23232
    v_pk_mul_f32 v[48:49], v[40:41], v[28:29] op_sel_hi:[0,1]
    v_pk_mul_f32 v[56:57], v[46:47], v[30:31] op_sel_hi:[0,1]
    v_pk_mul_f32 v[64:65], v[54:55], v[32:33] op_sel_hi:[0,1]
    v_pk_mul_f32 v[68:69], v[62:63], v[32:33] op_sel_hi:[0,1]
    v_pk_mul_f32 v[70:71], v[66:67], v[32:33] op_sel_hi:[0,1]
    v_pk_fma_f32 v[48:49], v[40:41], v[28:29], v[48:49] op_sel:[1,1,0] op_sel_hi:[1,0,1] neg_lo:[1,0,0]
    v_pk_fma_f32 v[56:57], v[46:47], v[30:31], v[56:57] op_sel:[1,1,0] op_sel_hi:[1,0,1] neg_lo:[1,0,0]
    v_pk_fma_f32 v[64:65], v[54:55], v[32:33], v[64:65] op_sel:[1,1,0] op_sel_hi:[1,0,1] neg_lo:[1,0,0]
    v_pk_fma_f32 v[68:69], v[62:63], v[32:33], v[68:69] op_sel:[1,1,0] op_sel_hi:[1,0,1] neg_lo:[1,0,0]
    v_pk_fma_f32 v[70:71], v[66:67], v[32:33], v[70:71] op_sel:[1,1,0] op_sel_hi:[1,0,1] neg_lo:[1,0,0]
    v_cvt_pk_bf16_f32 v86, v40, -v41
    ds_write_addtid_b32 v86 offset:18480
    v_cvt_pk_bf16_f32 v87, v44, -v45
    ds_write_addtid_b32 v87 offset:19536
    v_cvt_pk_bf16_f32 v80, v46, -v47
    ds_write_addtid_b32 v80 offset:20064
    v_cvt_pk_bf16_f32 v81, v52, -v53
    ds_write_addtid_b32 v81 offset:21648
    v_cvt_pk_bf16_f32 v82, v54, -v55
    ds_write_addtid_b32 v82 offset:22176
    v_cvt_pk_bf16_f32 v83, v60, -v61
    ds_write_addtid_b32 v83 offset:23760
    v_cvt_pk_bf16_f32 v84, v62, -v63
    ds_write_addtid_b32 v84 offset:24288
    v_cvt_pk_bf16_f32 v85, v66, -v67
    ds_write_addtid_b32 v85 offset:25344
    v_pk_mul_f32 v[72:73], v[68:69], v[32:33] op_sel_hi:[0,1]
    v_pk_mul_f32 v[74:75], v[70:71], v[32:33] op_sel_hi:[0,1]
    v_pk_fma_f32 v[72:73], v[68:69], v[32:33], v[72:73] op_sel:[1,1,0] op_sel_hi:[1,0,1] neg_lo:[1,0,0]
    v_pk_fma_f32 v[74:75], v[70:71], v[32:33], v[74:75] op_sel:[1,1,0] op_sel_hi:[1,0,1] neg_lo:[1,0,0]
    v_cvt_pk_bf16_f32 v86, v48, -v49
    ds_write_addtid_b32 v86 offset:20592
    v_cvt_pk_bf16_f32 v87, v56, -v57
    ds_write_addtid_b32 v87 offset:22704
    v_cvt_pk_bf16_f32 v80, v64, -v65
    ds_write_addtid_b32 v80 offset:24816
    v_cvt_pk_bf16_f32 v81, v68, -v69
    ds_write_addtid_b32 v81 offset:25872
    v_cvt_pk_bf16_f32 v82, v70, -v71
    ds_write_addtid_b32 v82 offset:26400
    v_cvt_pk_bf16_f32 v83, v72, -v73
    ds_write_addtid_b32 v83 offset:26928
    v_cvt_pk_bf16_f32 v84, v74, -v75
    ds_write_addtid_b32 v84 offset:27456
    s_nop 0
L_ch_join:
    s_waitcnt vmcnt(0) lgkmcnt(0)
    s_barrier
    ds_read_b128 v[24:27], v127 offset:0
    ds_read_b128 v[28:31], v126 offset:16896
    ds_read_b128 v[32:35], v127 offset:64
    ds_read_b128 v[36:39], v126 offset:16960
    ds_read_b128 v[40:43], v127 offset:128
    ds_read_b128 v[44:47], v126 offset:17024
    ds_read_b128 v[48:51], v127 offset:192
    ds_read_b128 v[52:55], v126 offset:17088
    ds_read_b128 v[56:59], v127 offset:256
    ds_read_b128 v[60:63], v126 offset:17152
    ds_read_b128 v[64:67], v127 offset:320
    ds_read_b128 v[68:71], v126 offset:17216
    ds_read_b128 v[72:75], v127 offset:384
    ds_read_b128 v[76:79], v126 offset:17280
    ds_read_b128 v[80:83], v127 offset:448
    ds_read_b128 v[84:87], v126 offset:17344
    s_mov_b32 s41, 400000
L_non_ch:
    v_readfirstlane_b32 s40, v111
    s_sub_u32 s41, s41, 1
    s_nop 0
    s_cmp_lg_u32 s40, 0
    s_nop 1
    s_cbranch_scc1 L_non_ch_ok
    s_cmp_eq_u32 s41, 0
    s_cbranch_scc1 L_non_ch_ok
    s_sleep 1
    global_load_dword v111, v110, s[76:77] sc1
    s_waitcnt vmcnt(0)
    s_branch L_non_ch
L_non_ch_ok:
    s_waitcnt lgkmcnt(14)
    v_mfma_f32_16x16x32_bf16 v[8:11], v[28:31], v[24:27], 0
    s_waitcnt lgkmcnt(12)
    v_mfma_f32_16x16x32_bf16 v[12:15], v[36:39], v[32:35], 0
    s_waitcnt lgkmcnt(10)
    v_mfma_f32_16x16x32_bf16 v[8:11], v[44:47], v[40:43], v[8:11]
    s_waitcnt lgkmcnt(8)
    v_mfma_f32_16x16x32_bf16 v[12:15], v[52:55], v[48:51], v[12:15]
    s_waitcnt lgkmcnt(6)
    v_mfma_f32_16x16x32_bf16 v[8:11], v[60:63], v[56:59], v[8:11]
    s_waitcnt lgkmcnt(4)
    v_mfma_f32_16x16x32_bf16 v[12:15], v[68:71], v[64:67], v[12:15]
    s_waitcnt lgkmcnt(2)
    v_mfma_f32_16x16x32_bf16 v[8:11], v[76:79], v[72:75], v[8:11]
    s_waitcnt lgkmcnt(0)
    v_mfma_f32_16x16x32_bf16 v[12:15], v[84:87], v[80:83], v[12:15]
    s_nop 7
    v_pk_add_f32 v[8:9], v[8:9], v[12:13]
    v_pk_add_f32 v[10:11], v[10:11], v[14:15]
    v_cvt_pk_bf16_f32 v8, v8, v9
    v_cvt_pk_bf16_f32 v9, v10, v11
    ds_write_b16 v122, v8 offset:28000
    ds_write_b16_d16_hi v123, v8 offset:28000
    ds_write_b16 v124, v9 offset:28000
    ds_write_b16_d16_hi v125, v9 offset:28000
    s_waitcnt lgkmcnt(0)
    s_barrier
    s_mov_b64 s[18:19], 0x30003
    s_and_b32 s24, s37, 15
    s_lshl_b32 s24, s24, 1
    s_lshl_b64 s[18:19], s[18:19], s24
    s_cmp_lt_u32 s35, 1
    s_cselect_b64 s[18:19], s[18:19], -1
    s_mov_b64 exec, s[18:19]
    global_load_dword v99, v98, s[78:79] sc1
    global_load_dword v105, v97, s[78:79] offset:0 sc1
    global_load_dwordx4 v[92:95], v121, s[78:79] sc1
    global_load_dwordx4 v[88:91], v96, s[78:79] sc1
    s_mov_b64 exec, -1
    ds_read_u16 v24, v112
    ds_read_u16 v25, v113
    ds_read_u16 v26, v114
    ds_read_u16 v27, v115
    ds_read_u16 v28, v116
    ds_read_u16 v29, v117
    ds_read_u16 v30, v118
    ds_read_u16 v31, v119
    ds_read_u16 v32, v120
    ds_write_b32 v102, v20 offset:4112
    ds_write_b128 v104, v[20:23] offset:16656
    s_waitcnt lgkmcnt(2)
    v_lshl_or_b32 v12, v25, 16, v24
    v_lshl_or_b32 v13, v27, 16, v26
    v_lshl_or_b32 v14, v29, 16, v28
    v_lshl_or_b32 v15, v31, 16, v30
    v_lshl_or_b32 v16, v26, 16, v25
    v_lshl_or_b32 v17, v28, 16, v27
    v_lshl_or_b32 v18, v30, 16, v29
    v_lshl_or_b32 v19, v32, 16, v31
    ds_write_b128 v1, v[12:15] offset:16
    ds_write_b128 v1, v[16:19] offset:4176
    ds_write2_b32 v100, v12, v13 offset0:0 offset1:1
    ds_write2_b32 v100, v14, v15 offset0:2 offset1:3
    ds_write2_b32 v101, v16, v17 offset0:0 offset1:1
    ds_write2_b32 v101, v18, v19 offset0:2 offset1:3
    s_mov_b32 s41, 400000
    v_lshlrev_b32 v21, 5, v2
    v_lshl_add_u32 v21, v3, 3, v21
    s_lshl_b32 s24, s36, 10
    s_add_u32 s24, s24, 17136
    v_add_u32 v21, s24, v21
    s_waitcnt lgkmcnt(0)
    s_barrier
    ds_read_b64 v[24:25], v5 offset:3648
    ds_read_b64 v[26:27], v5 offset:3656
    ds_read_b64 v[28:29], v5 offset:3136
    ds_read_b64 v[30:31], v5 offset:3144
    ds_read_b64 v[32:33], v5 offset:2624
    ds_read_b64 v[34:35], v5 offset:2632
    ds_read_b64 v[36:37], v5 offset:2112
    ds_read_b64 v[38:39], v5 offset:2120
    ds_read_b64 v[40:41], v5 offset:1600
    ds_read_b64 v[42:43], v5 offset:1608
    ds_read_b64 v[44:45], v5 offset:1088
    ds_read_b64 v[46:47], v5 offset:1096
    ds_read_b64 v[48:49], v5 offset:576
    ds_read_b64 v[50:51], v5 offset:584
    ds_read_b64 v[52:53], v5 offset:64
    ds_read_b64 v[54:55], v5 offset:72
    ds_read_b64 v[56:57], v5 offset:3584
    ds_read_b64 v[58:59], v5 offset:3592
    ds_read_b64 v[60:61], v5 offset:3072
    ds_read_b64 v[62:63], v5 offset:3080
    ds_read_b64 v[64:65], v5 offset:2560
    ds_read_b64 v[66:67], v5 offset:2568
    ds_read_b64 v[68:69], v5 offset:2048
    ds_read_b64 v[70:71], v5 offset:2056
    ds_read_b64 v[72:73], v5 offset:1536
    ds_read_b64 v[74:75], v5 offset:1544
    ds_read_b64 v[76:77], v5 offset:1024
    ds_read_b64 v[78:79], v5 offset:1032
    ds_read_b64 v[80:81], v5 offset:512
    ds_read_b64 v[82:83], v5 offset:520
    ds_read_b64 v[84:85], v5 offset:0
    ds_read_b64 v[86:87], v5 offset:8
    v_mov_b32 v116, 0x8000
    s_mov_b32 s16, 0x55555555
    s_mov_b32 s17, 0x55555555
    s_mov_b32 s22, 0
    v_bfe_u32 v16, v96, 4, 2
    v_lshlrev_b32 v17, 3, v16
    v_lshrrev_b32 v17, v17, s40
    v_and_b32 v17, 0xff, v17
    v_lshl_or_b32 v17, v17, 15, v17
    v_and_b32 v106, 0x10001, v17
    v_lshrrev_b32 v107, 2, v17
    v_and_b32 v107, 0x10001, v107
    v_lshrrev_b32 v108, 4, v17
    v_and_b32 v108, 0x10001, v108
    v_lshrrev_b32 v109, 6, v17
    v_and_b32 v109, 0x10001, v109
    v_xor_b32 v16, 2, v16
    v_lshlrev_b32 v17, 3, v16
    v_lshrrev_b32 v17, v17, s40
    v_and_b32 v17, 0xff, v17
    v_lshl_or_b32 v17, v17, 15, v17
    v_and_b32 v112, 0x10001, v17
    v_lshrrev_b32 v113, 2, v17
    v_and_b32 v113, 0x10001, v113
    v_lshrrev_b32 v114, 4, v17
    v_and_b32 v114, 0x10001, v114
    v_lshrrev_b32 v115, 6, v17
    v_and_b32 v115, 0x10001, v115
    s_mov_b64 exec, s[18:19]
    s_nop 0
L_ch_poll:
    s_waitcnt vmcnt(0)
    v_xor_b32 v8, v88, v106
    v_xor_b32 v9, v89, v107
    v_xor_b32 v10, v90, v108
    v_xor_b32 v11, v91, v109
    v_or3_b32 v16, v8, v9, v10
    v_bitop3_b32 v17, v11, v92, v112 bitop3:0xf6
    v_bitop3_b32 v16, v16, v93, v113 bitop3:0xf6
    v_bitop3_b32 v17, v17, v94, v114 bitop3:0xf6
    v_bitop3_b32 v16, v16, v95, v115 bitop3:0xf6
    v_or_b32 v16, v16, v17
    v_and_b32 v16, 0x10001, v16
    v_bitop3_b32 v16, v16, s40, v99 bitop3:0xf6
    v_cmp_ne_u32 vcc, 0, v16
    s_sub_u32 s41, s41, 1
    s_cmp_eq_u32 s41, 0
    s_nop 2
    s_cbranch_scc1 L_ch_poll_ok
    s_cbranch_vccz L_ch_pn
    s_lshr_b64 s[20:21], vcc, 1
    s_or_b64 s[20:21], s[20:21], vcc
    s_and_b64 s[20:21], s[20:21], s[16:17]
    s_lshl_b64 s[28:29], s[20:21], 1
    s_or_b64 exec, s[20:21], s[28:29]
    s_mov_b32 s22, 1
    s_sleep 2
L_ch_re:
    global_load_dword v99, v98, s[78:79] sc1
    global_load_dword v105, v97, s[78:79] offset:0 sc1
    global_load_dwordx4 v[92:95], v121, s[78:79] sc1
    global_load_dwordx4 v[88:91], v96, s[78:79] sc1
    s_branch L_ch_poll
L_ch_pn:
    s_cmp_eq_u64 s[18:19], -1
    s_mov_b64 exec, -1
    s_cbranch_scc1 L_ch_full
    s_mov_b64 s[18:19], -1
    s_mov_b32 s22, 0
    s_branch L_ch_re
L_ch_full:
    s_cmp_eq_u32 s22, 0
    s_cbranch_scc1 L_ch_poll_ok
    global_load_dword v105, v97, s[78:79] offset:0 sc1
    s_waitcnt vmcnt(0)
L_ch_poll_ok:
    s_mov_b64 exec, -1
    v_cmp_gt_u32 vcc, 6, v103
    s_nop 1
    v_cndmask_b32 v16, 0, v105, vcc
    s_nop 1
    v_add_f32_dpp v16, v16, v16 quad_perm:[1,0,3,2] row_mask:0xf bank_mask:0xf
    s_nop 1
    v_add_f32_dpp v16, v16, v16 quad_perm:[2,3,0,1] row_mask:0xf bank_mask:0xf
    s_nop 1
    v_add_f32_dpp v16, v16, v16 row_half_mirror row_mask:0xf bank_mask:0xf
    v_cvt_pk_bf16_f32 v16, v16, v16
    v_and_b32 v16, 0xffff0000, v16
    v_add_f32 v17, 1.0, v16
    v_cvt_pk_bf16_f32 v17, v17, v17
    v_and_b32 v17, 0xffff0000, v17
    v_mov_b32_dpp v22, v16 row_newbcast:0 row_mask:0xf bank_mask:0xf
    s_nop 0
    v_mov_b32_dpp v120, v17 row_newbcast:8 row_mask:0xf bank_mask:0xf
    v_lshl_or_b32 v12, v8, 16, v116
    v_and_or_b32 v13, v8, s12, v116
    v_lshl_or_b32 v14, v9, 16, v116
    v_and_or_b32 v15, v9, s12, v116
    v_lshl_or_b32 v16, v10, 16, v116
    v_and_or_b32 v17, v10, s12, v116
    v_lshl_or_b32 v18, v11, 16, v116
    v_and_or_b32 v19, v11, s12, v116
    v_pk_fma_f32 v[12:13], v[12:13], v[120:121], v[22:23] op_sel_hi:[1,0,0]
    v_pk_fma_f32 v[14:15], v[14:15], v[120:121], v[22:23] op_sel_hi:[1,0,0]
    v_pk_fma_f32 v[16:17], v[16:17], v[120:121], v[22:23] op_sel_hi:[1,0,0]
    v_pk_fma_f32 v[18:19], v[18:19], v[120:121], v[22:23] op_sel_hi:[1,0,0]
    v_cvt_pk_bf16_f32 v8, v12, v13
    v_cvt_pk_bf16_f32 v9, v14, v15
    v_cvt_pk_bf16_f32 v10, v16, v17
    v_cvt_pk_bf16_f32 v11, v18, v19
    ds_write_b128 v1, v[8:11] offset:17136
    s_waitcnt lgkmcnt(0)
    s_barrier
    ds_read_b128 v[120:123], v6 offset:64
    ds_read_b128 v[124:127], v6 offset:576
    ds_read_b128 v[12:15], v6 offset:1088
    ds_read_b128 v[16:19], v6 offset:1600
    ds_read_b128 v[8:11], v6 offset:2112
    s_waitcnt lgkmcnt(4)
    v_mfma_f32_16x16x32_bf16 v[88:91], v[24:27], v[120:123], 0
    v_mfma_f32_16x16x32_bf16 v[92:95], v[28:31], v[120:123], 0
    v_mfma_f32_16x16x32_bf16 v[96:99], v[32:35], v[120:123], 0
    v_mfma_f32_16x16x32_bf16 v[100:103], v[36:39], v[120:123], 0
    v_mfma_f32_16x16x32_bf16 v[104:107], v[40:43], v[120:123], 0
    v_mfma_f32_16x16x32_bf16 v[108:111], v[44:47], v[120:123], 0
    v_mfma_f32_16x16x32_bf16 v[112:115], v[48:51], v[120:123], 0
    v_mfma_f32_16x16x32_bf16 v[116:119], v[52:55], v[120:123], 0
    ds_read_b128 v[120:123], v6 offset:2624
    s_waitcnt lgkmcnt(4)
    v_mfma_f32_16x16x32_bf16 v[92:95], v[24:27], v[124:127], v[92:95]
    v_mfma_f32_16x16x32_bf16 v[96:99], v[28:31], v[124:127], v[96:99]
    v_mfma_f32_16x16x32_bf16 v[100:103], v[32:35], v[124:127], v[100:103]
    v_mfma_f32_16x16x32_bf16 v[104:107], v[36:39], v[124:127], v[104:107]
    v_mfma_f32_16x16x32_bf16 v[108:111], v[40:43], v[124:127], v[108:111]
    v_mfma_f32_16x16x32_bf16 v[112:115], v[44:47], v[124:127], v[112:115]
    v_mfma_f32_16x16x32_bf16 v[116:119], v[48:51], v[124:127], v[116:119]
    ds_read_b128 v[124:127], v6 offset:3136
    s_waitcnt lgkmcnt(4)
    v_mfma_f32_16x16x32_bf16 v[96:99], v[24:27], v[12:15], v[96:99]
    v_mfma_f32_16x16x32_bf16 v[100:103], v[28:31], v[12:15], v[100:103]
    v_mfma_f32_16x16x32_bf16 v[104:107], v[32:35], v[12:15], v[104:107]
    v_mfma_f32_16x16x32_bf16 v[108:111], v[36:39], v[12:15], v[108:111]
    v_mfma_f32_16x16x32_bf16 v[112:115], v[40:43], v[12:15], v[112:115]
    v_mfma_f32_16x16x32_bf16 v[116:119], v[44:47], v[12:15], v[116:119]
    ds_read_b128 v[12:15], v6 offset:3648
    s_waitcnt lgkmcnt(4)
    v_mfma_f32_16x16x32_bf16 v[100:103], v[24:27], v[16:19], v[100:103]
    v_mfma_f32_16x16x32_bf16 v[104:107], v[28:31], v[16:19], v[104:107]
    v_mfma_f32_16x16x32_bf16 v[108:111], v[32:35], v[16:19], v[108:111]
    v_mfma_f32_16x16x32_bf16 v[112:115], v[36:39], v[16:19], v[112:115]
    v_mfma_f32_16x16x32_bf16 v[116:119], v[40:43], v[16:19], v[116:119]
    ds_read_b128 v[16:19], v6 offset:3584
    s_waitcnt lgkmcnt(4)
    v_mfma_f32_16x16x32_bf16 v[104:107], v[24:27], v[8:11], v[104:107]
    v_mfma_f32_16x16x32_bf16 v[108:111], v[28:31], v[8:11], v[108:111]
    v_mfma_f32_16x16x32_bf16 v[112:115], v[32:35], v[8:11], v[112:115]
    v_mfma_f32_16x16x32_bf16 v[116:119], v[36:39], v[8:11], v[116:119]
    ds_read_b128 v[8:11], v6 offset:3072
    s_waitcnt lgkmcnt(4)
    v_mfma_f32_16x16x32_bf16 v[108:111], v[24:27], v[120:123], v[108:111]
    v_mfma_f32_16x16x32_bf16 v[112:115], v[28:31], v[120:123], v[112:115]
    v_mfma_f32_16x16x32_bf16 v[116:119], v[32:35], v[120:123], v[116:119]
    ds_read_b128 v[120:123], v6 offset:2560
    s_waitcnt lgkmcnt(4)
    v_mfma_f32_16x16x32_bf16 v[112:115], v[24:27], v[124:127], v[112:115]
    v_mfma_f32_16x16x32_bf16 v[116:119], v[28:31], v[124:127], v[116:119]
    ds_read_b128 v[124:127], v6 offset:2048
    s_waitcnt lgkmcnt(4)
    v_mfma_f32_16x16x32_bf16 v[116:119], v[24:27], v[12:15], v[116:119]
    ds_read_b128 v[12:15], v6 offset:1536
    s_waitcnt lgkmcnt(4)
    v_mfma_f32_16x16x32_bf16 v[116:119], v[56:59], v[16:19], v[116:119]
    ds_read_b128 v[16:19], v6 offset:1024
    s_waitcnt lgkmcnt(4)
    v_mfma_f32_16x16x32_bf16 v[112:115], v[56:59], v[8:11], v[112:115]
    v_mfma_f32_16x16x32_bf16 v[116:119], v[60:63], v[8:11], v[116:119]
    ds_read_b128 v[8:11], v6 offset:512
    s_waitcnt lgkmcnt(4)
    v_mfma_f32_16x16x32_bf16 v[108:111], v[56:59], v[120:123], v[108:111]
    v_mfma_f32_16x16x32_bf16 v[112:115], v[60:63], v[120:123], v[112:115]
    v_mfma_f32_16x16x32_bf16 v[116:119], v[64:67], v[120:123], v[116:119]
    ds_read_b128 v[120:123], v6 offset:0
    s_waitcnt lgkmcnt(4)
    v_mfma_f32_16x16x32_bf16 v[104:107], v[56:59], v[124:127], v[104:107]
    v_mfma_f32_16x16x32_bf16 v[108:111], v[60:63], v[124:127], v[108:111]
    v_mfma_f32_16x16x32_bf16 v[112:115], v[64:67], v[124:127], v[112:115]
    v_mfma_f32_16x16x32_bf16 v[116:119], v[68:71], v[124:127], v[116:119]
    ds_read_b64 v[22:23], v21 offset:512
    ds_read_b64 v[20:21], v21
    s_waitcnt lgkmcnt(5)
    v_mfma_f32_16x16x32_bf16 v[100:103], v[56:59], v[12:15], v[100:103]
    v_mfma_f32_16x16x32_bf16 v[104:107], v[60:63], v[12:15], v[104:107]
    v_mfma_f32_16x16x32_bf16 v[108:111], v[64:67], v[12:15], v[108:111]
    v_mfma_f32_16x16x32_bf16 v[112:115], v[68:71], v[12:15], v[112:115]
    v_mfma_f32_16x16x32_bf16 v[116:119], v[72:75], v[12:15], v[116:119]
    s_waitcnt lgkmcnt(4)
    v_mfma_f32_16x16x32_bf16 v[96:99], v[56:59], v[16:19], v[96:99]
    v_mfma_f32_16x16x32_bf16 v[100:103], v[60:63], v[16:19], v[100:103]
    v_mfma_f32_16x16x32_bf16 v[104:107], v[64:67], v[16:19], v[104:107]
    v_mfma_f32_16x16x32_bf16 v[108:111], v[68:71], v[16:19], v[108:111]
    v_mfma_f32_16x16x32_bf16 v[112:115], v[72:75], v[16:19], v[112:115]
    v_mfma_f32_16x16x32_bf16 v[116:119], v[76:79], v[16:19], v[116:119]
    s_waitcnt lgkmcnt(3)
    v_mfma_f32_16x16x32_bf16 v[92:95], v[56:59], v[8:11], v[92:95]
    v_mfma_f32_16x16x32_bf16 v[96:99], v[60:63], v[8:11], v[96:99]
    v_mfma_f32_16x16x32_bf16 v[100:103], v[64:67], v[8:11], v[100:103]
    v_mfma_f32_16x16x32_bf16 v[104:107], v[68:71], v[8:11], v[104:107]
    v_mfma_f32_16x16x32_bf16 v[108:111], v[72:75], v[8:11], v[108:111]
    v_mfma_f32_16x16x32_bf16 v[112:115], v[76:79], v[8:11], v[112:115]
    v_mfma_f32_16x16x32_bf16 v[116:119], v[80:83], v[8:11], v[116:119]
    s_waitcnt lgkmcnt(2)
    v_mfma_f32_16x16x32_bf16 v[88:91], v[56:59], v[120:123], v[88:91]
    v_mfma_f32_16x16x32_bf16 v[92:95], v[60:63], v[120:123], v[92:95]
    v_mfma_f32_16x16x32_bf16 v[96:99], v[64:67], v[120:123], v[96:99]
    v_mfma_f32_16x16x32_bf16 v[100:103], v[68:71], v[120:123], v[100:103]
    v_mfma_f32_16x16x32_bf16 v[104:107], v[72:75], v[120:123], v[104:107]
    v_mfma_f32_16x16x32_bf16 v[108:111], v[76:79], v[120:123], v[108:111]
    v_mfma_f32_16x16x32_bf16 v[112:115], v[80:83], v[120:123], v[112:115]
    v_mfma_f32_16x16x32_bf16 v[116:119], v[84:87], v[120:123], v[116:119]
    v_and_b32 v5, 63, v0
    v_lshlrev_b32 v5, 4, v5
    s_mul_i32 s24, s36, 6144
    v_add_u32 v6, s24, v5
    s_waitcnt lgkmcnt(0)
    s_barrier
    s_cmp_lg_u32 s36, 0
    s_nop 0
    s_cbranch_scc1 L_ch_x0
    ds_write_b128 v5, v[96:99] offset:6144
    ds_write_b128 v5, v[100:103] offset:7168
    ds_write_b128 v5, v[104:107] offset:12288
    ds_write_b128 v5, v[108:111] offset:13312
    ds_write_b128 v5, v[112:115] offset:18432
    ds_write_b128 v5, v[116:119] offset:19456
    v_pk_mul_f32 v[24:25], v[88:89], 1.0 op_sel_hi:[1,0]
    v_pk_mul_f32 v[26:27], v[90:91], 1.0 op_sel_hi:[1,0]
    v_pk_mul_f32 v[28:29], v[92:93], 1.0 op_sel_hi:[1,0]
    v_pk_mul_f32 v[30:31], v[94:95], 1.0 op_sel_hi:[1,0]
    s_nop 1
    s_branch L_ch_xe
L_ch_x0:
    s_cmp_lg_u32 s36, 1
    s_cbranch_scc1 L_ch_x1
    ds_write_b128 v5, v[88:91] offset:0
    ds_write_b128 v5, v[92:95] offset:1024
    ds_write_b128 v5, v[104:107] offset:14336
    ds_write_b128 v5, v[108:111] offset:15360
    ds_write_b128 v5, v[112:115] offset:20480
    ds_write_b128 v5, v[116:119] offset:21504
    v_pk_mul_f32 v[24:25], v[96:97], 1.0 op_sel_hi:[1,0]
    v_pk_mul_f32 v[26:27], v[98:99], 1.0 op_sel_hi:[1,0]
    v_pk_mul_f32 v[28:29], v[100:101], 1.0 op_sel_hi:[1,0]
    v_pk_mul_f32 v[30:31], v[102:103], 1.0 op_sel_hi:[1,0]
    s_nop 1
    s_branch L_ch_xe
L_ch_x1:
    s_cmp_lg_u32 s36, 2
    s_cbranch_scc1 L_ch_x2
    ds_write_b128 v5, v[88:91] offset:2048
    ds_write_b128 v5, v[92:95] offset:3072
    ds_write_b128 v5, v[96:99] offset:8192
    ds_write_b128 v5, v[100:103] offset:9216
    ds_write_b128 v5, v[112:115] offset:22528
    ds_write_b128 v5, v[116:119] offset:23552
    v_pk_mul_f32 v[24:25], v[104:105], 1.0 op_sel_hi:[1,0]
    v_pk_mul_f32 v[26:27], v[106:107], 1.0 op_sel_hi:[1,0]
    v_pk_mul_f32 v[28:29], v[108:109], 1.0 op_sel_hi:[1,0]
    v_pk_mul_f32 v[30:31], v[110:111], 1.0 op_sel_hi:[1,0]
    s_nop 1
    s_branch L_ch_xe
L_ch_x2:
    ds_write_b128 v5, v[88:91] offset:4096
    ds_write_b128 v5, v[92:95] offset:5120
    ds_write_b128 v5, v[96:99] offset:10240
    ds_write_b128 v5, v[100:103] offset:11264
    ds_write_b128 v5, v[104:107] offset:16384
    ds_write_b128 v5, v[108:111] offset:17408
    v_pk_mul_f32 v[24:25], v[112:113], 1.0 op_sel_hi:[1,0]
    v_pk_mul_f32 v[26:27], v[114:115], 1.0 op_sel_hi:[1,0]
    v_pk_mul_f32 v[28:29], v[116:117], 1.0 op_sel_hi:[1,0]
    v_pk_mul_f32 v[30:31], v[118:119], 1.0 op_sel_hi:[1,0]
    s_nop 1
L_ch_xe:
    v_lshlrev_b32 v12, 16, v20
    v_and_b32 v13, s12, v20
    v_lshlrev_b32 v14, 16, v21
    v_and_b32 v15, s12, v21
    v_lshlrev_b32 v16, 16, v22
    v_and_b32 v17, s12, v22
    v_lshlrev_b32 v18, 16, v23
    v_and_b32 v19, s12, v23
    v_pk_fma_f32 v[24:25], v[6:7], v[12:13], v[24:25] op_sel:[1,0,0] op_sel_hi:[1,1,1]
    v_pk_fma_f32 v[26:27], v[6:7], v[14:15], v[26:27] op_sel:[1,0,0] op_sel_hi:[1,1,1]
    v_pk_fma_f32 v[28:29], v[6:7], v[16:17], v[28:29] op_sel:[1,0,0] op_sel_hi:[1,1,1]
    v_pk_fma_f32 v[30:31], v[6:7], v[18:19], v[30:31] op_sel:[1,0,0] op_sel_hi:[1,1,1]
    v_and_b32 v8, 31, v0
    v_bfe_u32 v9, v0, 5, 1
    v_lshl_add_u32 v8, v8, 1, v9
    v_mul_u32_u24 v8, 9216, v8
    s_lshl_b32 s24, s37, 4
    s_mul_i32 s25, s36, 589824
    s_add_u32 s24, s24, s25
    s_add_u32 s24, s24, 5242880
    v_add_u32 v8, s24, v8
    s_waitcnt lgkmcnt(0)
    s_barrier
    ds_read_b128 v[32:35], v6 offset:0
    ds_read_b128 v[36:39], v6 offset:1024
    ds_read_b128 v[40:43], v6 offset:2048
    ds_read_b128 v[44:47], v6 offset:3072
    ds_read_b128 v[48:51], v6 offset:4096
    ds_read_b128 v[52:55], v6 offset:5120
    s_waitcnt lgkmcnt(4)
    v_pk_add_f32 v[24:25], v[24:25], v[32:33]
    v_pk_add_f32 v[26:27], v[26:27], v[34:35]
    v_pk_add_f32 v[28:29], v[28:29], v[36:37]
    v_pk_add_f32 v[30:31], v[30:31], v[38:39]
    s_waitcnt lgkmcnt(2)
    v_pk_add_f32 v[24:25], v[24:25], v[40:41]
    v_pk_add_f32 v[26:27], v[26:27], v[42:43]
    v_pk_add_f32 v[28:29], v[28:29], v[44:45]
    v_pk_add_f32 v[30:31], v[30:31], v[46:47]
    s_waitcnt lgkmcnt(0)
    v_pk_add_f32 v[24:25], v[24:25], v[48:49]
    v_pk_add_f32 v[26:27], v[26:27], v[50:51]
    v_pk_add_f32 v[28:29], v[28:29], v[52:53]
    v_pk_add_f32 v[30:31], v[30:31], v[54:55]
    v_cvt_pk_bf16_f32 v12, v24, v25
    v_cvt_pk_bf16_f32 v13, v26, v27
    v_cvt_pk_bf16_f32 v14, v28, v29
    v_cvt_pk_bf16_f32 v15, v30, v31
    s_nop 0
    v_permlane16_swap_b32 v12, v14
    v_permlane16_swap_b32 v13, v15
    global_store_dwordx4 v8, v[12:15], s[78:79]
    s_nop 1
    s_branch L_f_end
L_f_zero:
    v_lshlrev_b32 v1, 4, v0
    s_sub_u32 s8, s39, 108
    s_mul_i32 s8, s8, 36864
    s_add_u32 s8, s8, 2490368
    v_add_u32 v1, s8, v1
    v_mov_b32 v4, 0
    v_mov_b32 v5, 0
    v_mov_b32 v6, 0
    v_mov_b32 v7, 0
    s_mov_b32 s8, 9
    s_waitcnt lgkmcnt(0)
L_f_zl:
    global_store_dwordx4 v1, v[4:7], s[78:79] sc1
    v_add_u32 v1, 4096, v1
    s_sub_u32 s8, s8, 1
    s_cmp_lg_u32 s8, 0
    s_cbranch_scc1 L_f_zl
    s_branch L_f_b3
L_f_bulk:
    s_cmp_ge_u32 s35, 4
    s_cbranch_scc1 L_f_end
    s_lshl_b32 s39, s35, 6
    s_add_u32 s39, s39, s3
    s_sub_u32 s39, s39, 192
    s_cmp_ge_u32 s39, 108
    s_cbranch_scc1 L_f_b1
    s_mul_i32 s10, s39, 3641
    s_lshr_b32 s10, s10, 16
    s_mul_i32 s12, s10, 18
    s_sub_u32 s11, s39, s12
    s_add_u32 s11, s11, 9
    s_branch L_f_gv
L_f_b1:
    v_and_b32 v74, 63, v0
    v_lshrrev_b32 v75, 3, v74
    v_mul_u32_u24 v72, 9216, v75
    v_and_b32 v75, 2, v75
    v_and_b32 v76, 7, v74
    v_xor_b32 v76, v76, v75
    v_lshl_add_u32 v72, v76, 4, v72
    v_xor_b32 v73, 64, v72
    v_lshrrev_b32 v75, 4, v74
    v_lshlrev_b32 v75, 10, v75
    v_bfe_u32 v76, v74, 2, 2
    v_lshl_add_u32 v75, v76, 7, v75
    v_bfe_u32 v76, v74, 3, 2
    v_lshl_add_u32 v75, v76, 5, v75
    v_and_b32 v76, 3, v74
    v_lshl_add_u32 v74, v76, 3, v75
    s_sub_u32 s42, s39, 108
    s_lshl_b32 s42, s42, 1
    s_add_u32 s42, s42, s36
    s_cmp_ge_u32 s36, 2
    s_cselect_b32 s42, 288, s42
    s_lshl_b32 s34, s36, 12
    s_cmp_ge_u32 s42, 288
    s_waitcnt lgkmcnt(0)
    s_cbranch_scc1 L_f_b2
    s_and_b32 s26, s42, 1
    s_lshr_b32 s27, s42, 1
    s_lshr_b32 s32, s27, 3
    s_and_b32 s27, s27, 7
    s_cmp_eq_u32 s26, 0
    s_cselect_b32 s28, s64, s66
    s_cselect_b32 s29, s65, s67
    s_mov_b32 s30, 5308416
    s_mov_b32 s31, 0x20000
    s_mul_i32 s33, s27, 144
    s_add_u32 s33, s33, s26
    s_lshl_b32 s26, s32, 1
    s_add_u32 s33, s33, s26
    s_lshl_b32 s33, s33, 10
    s_add_u32 s33, s33, 12582912
    s_mul_i32 s32, s32, 294912
    s_lshl_b32 s27, s27, 7
    s_add_u32 s32, s32, s27
    s_add_u32 s32, s32, 8192
    s_add_u32 m0, s34, 0
    s_nop 0
    buffer_load_dwordx4 v72, s[28:31], s32 offen nt lds
    s_add_u32 m0, s34, 1024
    s_add_u32 s32, s32, 73728
    buffer_load_dwordx4 v73, s[28:31], s32 offen nt lds
    s_add_u32 m0, s34, 2048
    s_add_u32 s32, s32, 73728
    buffer_load_dwordx4 v72, s[28:31], s32 offen nt lds
    s_add_u32 m0, s34, 3072
    s_add_u32 s32, s32, 73728
    buffer_load_dwordx4 v73, s[28:31], s32 offen nt lds
L_f_b2:
    s_cmp_lt_u32 s39, 112
    s_cbranch_scc1 L_f_zero
    s_sub_u32 s12, s39, 112
    s_lshr_b32 s12, s12, 3
    s_lshl_b32 s12, s12, 5
    s_and_b32 s13, s2, 1
    s_add_u32 s12, s12, s13
    v_bfe_u32 v1, v0, 3, 4
    v_lshl_add_u32 v1, v1, 1, s12
    v_mul_u32_u24 v1, 9216, v1
    v_and_b32 v2, 7, v0
    v_lshl_add_u32 v1, v2, 7, v1
    s_and_b32 s13, s2, 6
    s_lshl_b32 s13, s13, 9
    v_add_u32 v1, s13, v1
    s_cmp_ge_u32 s36, 2
    s_cselect_b32 s8, s66, s64
    s_cselect_b32 s9, s67, s65
    global_load_dword v4, v1, s[8:9]
    v_add_u32 v1, 4096, v1
    global_load_dword v5, v1, s[8:9]
    s_nop 0
L_f_b3:
    s_cmp_ge_u32 s42, 288
    s_waitcnt vmcnt(0)
    s_cbranch_scc1 L_f_end
    v_add_u32 v112, s34, v74
    v_xor_b32 v113, 32, v112
    v_xor_b32 v114, 64, v112
    v_xor_b32 v115, 96, v112
    ds_read_b64_tr_b16 v[80:81], v112 offset:0
    ds_read_b64_tr_b16 v[82:83], v112 offset:512
    ds_read_b64_tr_b16 v[84:85], v113 offset:0
    ds_read_b64_tr_b16 v[86:87], v113 offset:512
    ds_read_b64_tr_b16 v[88:89], v114 offset:0
    ds_read_b64_tr_b16 v[90:91], v114 offset:512
    ds_read_b64_tr_b16 v[92:93], v115 offset:0
    ds_read_b64_tr_b16 v[94:95], v115 offset:512
    v_and_b32 v116, 63, v0
    v_lshlrev_b32 v116, 4, v116
    v_add_u32 v116, s33, v116
    s_waitcnt lgkmcnt(6)
    global_store_dwordx4 v116, v[80:83], s[78:79] sc1
    v_add_u32 v116, 36864, v116
    s_waitcnt lgkmcnt(4)
    global_store_dwordx4 v116, v[84:87], s[78:79] sc1
    v_add_u32 v116, 36864, v116
    s_waitcnt lgkmcnt(2)
    global_store_dwordx4 v116, v[88:91], s[78:79] sc1
    v_add_u32 v116, 36864, v116
    s_waitcnt lgkmcnt(0)
    global_store_dwordx4 v116, v[92:95], s[78:79] sc1
    s_nop 1
L_f_end:
    s_endpgm
.section .rodata,"a"
.p2align 6
.amdhsa_kernel front_kernel
  .amdhsa_next_free_vgpr 128
  .amdhsa_next_free_sgpr 80
  .amdhsa_accum_offset 128
  .amdhsa_group_segment_fixed_size 0
  .amdhsa_kernarg_size 144
  .amdhsa_user_sgpr_count 2
  .amdhsa_user_sgpr_kernarg_segment_ptr 1
  .amdhsa_system_sgpr_workgroup_id_x 1
  .amdhsa_float_denorm_mode_32 3
.end_amdhsa_kernel
.text
.globl ffn_kernel
.p2align 8
.type ffn_kernel,@function
ffn_kernel:
    s_load_dwordx16 s[44:59], s[0:1], 0
    s_load_dwordx16 s[60:75], s[0:1], 64
    s_load_dwordx4 s[76:79], s[0:1], 128
    s_cmp_ge_u32 s2, 256
    s_cbranch_scc1 L_g_end
    v_lshrrev_b32 v1, 6, v0
    v_and_b32 v13, 63, v0
    v_readfirstlane_b32 s36, v1
    s_and_b32 s7, s2, 1
    s_lshl_b32 s7, s7, 2
    s_bfe_u32 s3, s2, 0x20003
    s_add_u32 s7, s7, s3
    s_bfe_u32 s37, s2, 0x20001
    s_lshl_b32 s3, s37, 3
    s_lshr_b32 s4, s2, 5
    s_add_u32 s3, s3, s4
    s_and_b32 s35, s3, 1
    v_lshlrev_b32 v1, 4, v13
    s_mul_i32 s34, s3, 36864
    s_add_u32 s34, s34, 12582912
    s_lshl_b32 s33, s3, 7
    s_lshl_b32 s5, s7, 5
    s_add_u32 s5, s5, s3
    s_cmp_eq_u32 s36, 3
    s_cbranch_scc1 L_g_w3
    s_mul_i32 s38, s36, 3072
    s_mul_i32 s28, s5, 9216
    s_add_u32 s6, s38, s28
    s_add_u32 s6, s6, 5242880
    v_add_u32 v2, s6, v1
    v_and_b32 v3, 7, v0
    v_lshrrev_b32 v4, 3, v13
    v_mul_u32_u24 v5, 1152, v4
    v_xor_b32 v6, v3, v4
    v_lshl_add_u32 v5, v6, 4, v5
    s_mul_i32 s6, s36, 384
    s_add_u32 s28, s28, s6
    v_add_u32 v5, s28, v5
    v_lshrrev_b32 v6, 4, v13
    v_mul_u32_u24 v6, 2304, v6
    v_and_b32 v7, 15, v0
    v_lshl_add_u32 v6, v7, 4, v6
    s_mul_i32 s28, s36, 768
    s_add_u32 s28, s28, 98304
    v_add_u32 v6, s28, v6
    v_add_u32 v7, 256, v6
    v_add_u32 v8, 512, v6
    s_add_u32 m0, s38, 131072
    s_waitcnt lgkmcnt(0)
    s_load_dword s76, s[78:79], 110592
    global_load_lds_dwordx4 v6, s[78:79]
    s_add_u32 m0, s38, 132096
    s_nop 0
    global_load_lds_dwordx4 v7, s[78:79]
    s_add_u32 m0, s38, 133120
    s_nop 0
    global_load_lds_dwordx4 v8, s[78:79]
    s_add_u32 m0, s38, 149504
    s_nop 0
    global_load_lds_dwordx4 v2, s[78:79] offset:0
    global_load_lds_dwordx4 v2, s[78:79] offset:1024
    global_load_lds_dwordx4 v2, s[78:79] offset:2048
    s_add_u32 m0, s38, 140288
    s_nop 0
    global_load_lds_dwordx4 v5, s[44:45] offset:0
    s_add_u32 m0, s38, 141184
    s_nop 0
    global_load_lds_dwordx4 v5, s[44:45] offset:128
    s_add_u32 m0, s38, 142080
    s_nop 0
    global_load_lds_dwordx4 v5, s[44:45] offset:256
    v_lshrrev_b32 v8, 4, v13
    v_lshlrev_b32 v8, 8, v8
    v_bfe_u32 v9, v0, 1, 1
    v_lshl_add_u32 v8, v9, 7, v8
    v_bfe_u32 v9, v0, 2, 2
    v_lshl_add_u32 v8, v9, 4, v8
    v_and_b32 v9, 1, v0
    v_lshl_add_u32 v8, v9, 3, v8
    s_add_u32 s28, s38, 149504
    v_add_u32 v8, s28, v8
    v_lshlrev_b32 v9, 5, v4
    s_add_u32 s28, s38, 131072
    v_add_u32 v9, s28, v9
    v_lshrrev_b32 v10, 2, v4
    v_lshlrev_b32 v10, 10, v10
    v_and_b32 v11, 3, v4
    v_lshl_add_u32 v10, v11, 8, v10
    v_lshl_add_u32 v10, v3, 4, v10
    s_lshr_b32 s28, s5, 1
    s_mul_i32 s28, s28, 18432
    s_lshl_b32 s6, s35, 7
    s_add_u32 s28, s28, s6
    s_mul_i32 s6, s36, 6144
    s_add_u32 s28, s28, s6
    s_add_u32 s28, s28, 9961472
    v_add_u32 v10, s28, v10
    v_add_u32 v208, 4096, v10
    v_subrev_u32 v209, 2359296, v10
    v_subrev_u32 v210, 2359296, v208
    v_lshlrev_b32 v11, 3, v3
    v_add_u32 v11, 158720, v11
    s_lshl_b32 s28, s36, 6
    v_add_u32 v12, s28, v11
    v_xor_b32 v5, v3, v4
    v_lshlrev_b32 v5, 4, v5
    v_lshl_add_u32 v5, v3, 7, v5
    s_add_u32 s28, s38, 140288
    v_add_u32 v5, s28, v5
    s_mov_b32 s39, 0xffff0000
    s_waitcnt vmcnt(6)
    ds_read_b128 v[120:123], v9 offset:0
    ds_read_b128 v[124:127], v9 offset:16
    ds_read_b128 v[128:131], v9 offset:1024
    ds_read_b128 v[132:135], v9 offset:1040
    ds_read_b128 v[136:139], v9 offset:2048
    ds_read_b128 v[140:143], v9 offset:2064
    s_waitcnt vmcnt(3)
    ds_read_b64_tr_b16 v[60:61], v8 offset:0
    ds_read_b64_tr_b16 v[62:63], v8 offset:64
    ds_read_b64_tr_b16 v[64:65], v8 offset:1024
    ds_read_b64_tr_b16 v[66:67], v8 offset:1088
    ds_read_b64_tr_b16 v[68:69], v8 offset:2048
    ds_read_b64_tr_b16 v[70:71], v8 offset:2112
    s_waitcnt vmcnt(0)
    ds_read_b128 v[48:51], v5 offset:0
    ds_read_b128 v[52:55], v5 offset:1024
    ds_read_b128 v[56:59], v5 offset:2048
    s_waitcnt lgkmcnt(3)
    v_lshlrev_b32 v96, 16, v60
    v_and_b32 v97, s39, v60
    v_lshlrev_b32 v98, 16, v61
    v_and_b32 v99, s39, v61
    v_lshlrev_b32 v100, 16, v62
    v_and_b32 v101, s39, v62
    v_lshlrev_b32 v102, 16, v63
    v_and_b32 v103, s39, v63
    v_lshlrev_b32 v104, 16, v64
    v_and_b32 v105, s39, v64
    v_lshlrev_b32 v106, 16, v65
    v_and_b32 v107, s39, v65
    v_lshlrev_b32 v108, 16, v66
    v_and_b32 v109, s39, v66
    v_lshlrev_b32 v110, 16, v67
    v_and_b32 v111, s39, v67
    v_lshlrev_b32 v112, 16, v68
    v_and_b32 v113, s39, v68
    v_lshlrev_b32 v114, 16, v69
    v_and_b32 v115, s39, v69
    v_lshlrev_b32 v116, 16, v70
    v_and_b32 v117, s39, v70
    v_lshlrev_b32 v118, 16, v71
    v_and_b32 v119, s39, v71
    s_waitcnt lgkmcnt(0)
    ds_read_b128 v[144:147], v9 offset:256
    ds_read_b128 v[148:151], v9 offset:272
    ds_read_b128 v[152:155], v9 offset:1280
    ds_read_b128 v[156:159], v9 offset:1296
    ds_read_b128 v[160:163], v9 offset:2304
    ds_read_b128 v[164:167], v9 offset:2320
    ds_read_b128 v[168:171], v9 offset:512
    ds_read_b128 v[172:175], v9 offset:528
    ds_read_b128 v[176:179], v9 offset:1536
    ds_read_b128 v[180:183], v9 offset:1552
    ds_read_b128 v[184:187], v9 offset:2560
    ds_read_b128 v[188:191], v9 offset:2576
    v_lshlrev_b32 v72, 16, v48
    v_and_b32 v73, s39, v48
    v_lshlrev_b32 v74, 16, v49
    v_and_b32 v75, s39, v49
    v_lshlrev_b32 v76, 16, v50
    v_and_b32 v77, s39, v50
    v_lshlrev_b32 v78, 16, v51
    v_and_b32 v79, s39, v51
    v_lshlrev_b32 v80, 16, v52
    v_and_b32 v81, s39, v52
    v_lshlrev_b32 v82, 16, v53
    v_and_b32 v83, s39, v53
    v_lshlrev_b32 v84, 16, v54
    v_and_b32 v85, s39, v54
    v_lshlrev_b32 v86, 16, v55
    v_and_b32 v87, s39, v55
    v_lshlrev_b32 v88, 16, v56
    v_and_b32 v89, s39, v56
    v_lshlrev_b32 v90, 16, v57
    v_and_b32 v91, s39, v57
    v_lshlrev_b32 v92, 16, v58
    v_and_b32 v93, s39, v58
    v_lshlrev_b32 v94, 16, v59
    v_and_b32 v95, s39, v59
    v_pk_fma_f32 v[72:73], v[96:97], v[120:121], v[72:73]
    v_pk_fma_f32 v[74:75], v[98:99], v[122:123], v[74:75]
    v_pk_fma_f32 v[76:77], v[100:101], v[124:125], v[76:77]
    v_pk_fma_f32 v[78:79], v[102:103], v[126:127], v[78:79]
    v_pk_fma_f32 v[80:81], v[104:105], v[128:129], v[80:81]
    v_pk_fma_f32 v[82:83], v[106:107], v[130:131], v[82:83]
    v_pk_fma_f32 v[84:85], v[108:109], v[132:133], v[84:85]
    v_pk_fma_f32 v[86:87], v[110:111], v[134:135], v[86:87]
    v_pk_fma_f32 v[88:89], v[112:113], v[136:137], v[88:89]
    v_pk_fma_f32 v[90:91], v[114:115], v[138:139], v[90:91]
    v_pk_fma_f32 v[92:93], v[116:117], v[140:141], v[92:93]
    v_pk_fma_f32 v[94:95], v[118:119], v[142:143], v[94:95]
    v_pk_mul_f32 v[204:205], v[72:73], v[72:73]
    v_pk_mul_f32 v[206:207], v[74:75], v[74:75]
    v_pk_fma_f32 v[204:205], v[76:77], v[76:77], v[204:205]
    v_pk_add_f32 v[200:201], v[72:73], v[76:77]
    v_pk_fma_f32 v[206:207], v[78:79], v[78:79], v[206:207]
    v_pk_add_f32 v[202:203], v[74:75], v[78:79]
    v_pk_fma_f32 v[204:205], v[80:81], v[80:81], v[204:205]
    v_pk_add_f32 v[200:201], v[200:201], v[80:81]
    v_pk_fma_f32 v[206:207], v[82:83], v[82:83], v[206:207]
    v_pk_add_f32 v[202:203], v[202:203], v[82:83]
    v_pk_fma_f32 v[204:205], v[84:85], v[84:85], v[204:205]
    v_pk_add_f32 v[200:201], v[200:201], v[84:85]
    v_pk_fma_f32 v[206:207], v[86:87], v[86:87], v[206:207]
    v_pk_add_f32 v[202:203], v[202:203], v[86:87]
    v_pk_fma_f32 v[204:205], v[88:89], v[88:89], v[204:205]
    v_pk_add_f32 v[200:201], v[200:201], v[88:89]
    v_pk_fma_f32 v[206:207], v[90:91], v[90:91], v[206:207]
    v_pk_add_f32 v[202:203], v[202:203], v[90:91]
    v_pk_fma_f32 v[204:205], v[92:93], v[92:93], v[204:205]
    v_pk_add_f32 v[200:201], v[200:201], v[92:93]
    v_pk_fma_f32 v[206:207], v[94:95], v[94:95], v[206:207]
    v_pk_add_f32 v[202:203], v[202:203], v[94:95]
    v_pk_add_f32 v[200:201], v[200:201], v[202:203]
    v_pk_add_f32 v[204:205], v[204:205], v[206:207]
    v_add_f32 v200, v200, v201
    v_add_f32 v201, v204, v205
    s_nop 0
    v_add_f32_dpp v200, v200, v200 row_ror:8 row_mask:0xf bank_mask:0xf
    v_add_f32_dpp v201, v201, v201 row_ror:8 row_mask:0xf bank_mask:0xf
    v_mov_b32 v202, v200
    v_mov_b32 v203, v201
    s_nop 0
    v_permlane32_swap_b32 v200, v202
    v_permlane32_swap_b32 v201, v203
    v_pk_add_f32 v[200:201], v[200:201], v[202:203]
    v_mov_b32 v202, v200
    v_mov_b32 v203, v201
    s_nop 0
    v_permlane16_swap_b32 v200, v202
    v_permlane16_swap_b32 v201, v203
    v_pk_add_f32 v[200:201], v[200:201], v[202:203]
    ds_write_b64 v12, v[200:201]
    s_waitcnt lgkmcnt(0)
    s_barrier
    ds_read_b64 v[200:201], v11 offset:0
    ds_read_b64 v[202:203], v11 offset:64
    ds_read_b64 v[204:205], v11 offset:128
    v_cvt_pk_bf16_f32 v48, v72, v73
    v_cvt_pk_bf16_f32 v49, v74, v75
    v_cvt_pk_bf16_f32 v50, v76, v77
    v_cvt_pk_bf16_f32 v51, v78, v79
    v_cvt_pk_bf16_f32 v52, v80, v81
    v_cvt_pk_bf16_f32 v53, v82, v83
    v_cvt_pk_bf16_f32 v54, v84, v85
    v_cvt_pk_bf16_f32 v55, v86, v87
    v_cvt_pk_bf16_f32 v56, v88, v89
    v_cvt_pk_bf16_f32 v57, v90, v91
    v_cvt_pk_bf16_f32 v58, v92, v93
    v_cvt_pk_bf16_f32 v59, v94, v95
    s_waitcnt lgkmcnt(0)
    v_pk_add_f32 v[200:201], v[200:201], v[202:203]
    v_pk_add_f32 v[200:201], v[200:201], v[204:205]
    v_mul_f32 v200, 0x3ae38e39, v200
    v_mul_f32 v202, 0x3ae38e39, v201
    v_fma_f32 v202, -v200, v200, v202
    v_max_f32 v202, 0, v202
    v_add_f32 v202, 0x3727c5ac, v202
    v_rsq_f32 v202, v202
    s_nop 0
    v_mul_f32 v204, -v200, v202
    v_pk_fma_f32 v[72:73], v[72:73], v[202:203], v[204:205] op_sel_hi:[1,0,0]
    v_pk_fma_f32 v[74:75], v[74:75], v[202:203], v[204:205] op_sel_hi:[1,0,0]
    v_pk_fma_f32 v[76:77], v[76:77], v[202:203], v[204:205] op_sel_hi:[1,0,0]
    v_pk_fma_f32 v[78:79], v[78:79], v[202:203], v[204:205] op_sel_hi:[1,0,0]
    v_pk_fma_f32 v[72:73], v[72:73], v[168:169], v[144:145]
    v_pk_fma_f32 v[74:75], v[74:75], v[170:171], v[146:147]
    v_pk_fma_f32 v[76:77], v[76:77], v[172:173], v[148:149]
    v_pk_fma_f32 v[78:79], v[78:79], v[174:175], v[150:151]
    v_cvt_pk_bf16_f32 v60, v72, v73
    v_cvt_pk_bf16_f32 v61, v74, v75
    v_cvt_pk_bf16_f32 v62, v76, v77
    v_cvt_pk_bf16_f32 v63, v78, v79
    global_store_dwordx4 v10, v[60:63], s[78:79] sc1
    v_pk_fma_f32 v[80:81], v[80:81], v[202:203], v[204:205] op_sel_hi:[1,0,0]
    v_pk_fma_f32 v[82:83], v[82:83], v[202:203], v[204:205] op_sel_hi:[1,0,0]
    v_pk_fma_f32 v[84:85], v[84:85], v[202:203], v[204:205] op_sel_hi:[1,0,0]
    v_pk_fma_f32 v[86:87], v[86:87], v[202:203], v[204:205] op_sel_hi:[1,0,0]
    v_pk_fma_f32 v[80:81], v[80:81], v[176:177], v[152:153]
    v_pk_fma_f32 v[82:83], v[82:83], v[178:179], v[154:155]
    v_pk_fma_f32 v[84:85], v[84:85], v[180:181], v[156:157]
    v_pk_fma_f32 v[86:87], v[86:87], v[182:183], v[158:159]
    v_cvt_pk_bf16_f32 v64, v80, v81
    v_cvt_pk_bf16_f32 v65, v82, v83
    v_cvt_pk_bf16_f32 v66, v84, v85
    v_cvt_pk_bf16_f32 v67, v86, v87
    global_store_dwordx4 v10, v[64:67], s[78:79] offset:2048 sc1
    v_pk_fma_f32 v[88:89], v[88:89], v[202:203], v[204:205] op_sel_hi:[1,0,0]
    v_pk_fma_f32 v[90:91], v[90:91], v[202:203], v[204:205] op_sel_hi:[1,0,0]
    v_pk_fma_f32 v[92:93], v[92:93], v[202:203], v[204:205] op_sel_hi:[1,0,0]
    v_pk_fma_f32 v[94:95], v[94:95], v[202:203], v[204:205] op_sel_hi:[1,0,0]
    v_pk_fma_f32 v[88:89], v[88:89], v[184:185], v[160:161]
    v_pk_fma_f32 v[90:91], v[90:91], v[186:187], v[162:163]
    v_pk_fma_f32 v[92:93], v[92:93], v[188:189], v[164:165]
    v_pk_fma_f32 v[94:95], v[94:95], v[190:191], v[166:167]
    v_cvt_pk_bf16_f32 v68, v88, v89
    v_cvt_pk_bf16_f32 v69, v90, v91
    v_cvt_pk_bf16_f32 v70, v92, v93
    v_cvt_pk_bf16_f32 v71, v94, v95
    global_store_dwordx4 v208, v[68:71], s[78:79] sc1
    global_store_dwordx4 v209, v[48:51], s[78:79] sc1
    global_store_dwordx4 v209, v[52:55], s[78:79] offset:2048 sc1
    global_store_dwordx4 v210, v[56:59], s[78:79] sc1
    s_lshl_b32 s6, s5, 6
    s_add_u32 s6, s6, 2490368
    v_mov_b32 v240, s6
    v_mov_b32 v247, s76
    s_lshl_b32 s42, s7, 4
    s_lshl_b32 s6, s36, 2
    s_add_u32 s42, s42, s6
    s_mul_i32 s6, s42, 18432
    s_add_u32 s6, s6, 9961472
    s_add_u32 s8, s78, s6
    s_addc_u32 s9, s79, 0
    s_mov_b32 s10, 73728
    s_mov_b32 s11, 0x20000
    s_mov_b32 s12, s64
    s_mov_b32 s13, s65
    s_mov_b32 s14, 5308416
    s_mov_b32 s15, 0x20000
    s_mov_b32 s44, s66
    s_mov_b32 s45, s67
    s_mov_b32 s46, 5308416
    s_mov_b32 s47, 0x20000
    v_lshrrev_b32 v2, 3, v13
    v_mul_u32_u24 v250, 9216, v2
    v_and_b32 v2, 2, v2
    v_and_b32 v3, 7, v13
    v_xor_b32 v2, v2, v3
    v_lshl_add_u32 v250, v2, 4, v250
    v_xor_b32 v251, 64, v250
    s_and_b32 s6, s36, 1
    s_lshl_b32 s6, s6, 6
    v_xor_b32 v5, s6, v250
    s_mul_i32 s6, s36, 73728
    v_add_u32 v5, s6, v5
    v_lshrrev_b32 v2, 4, v13
    v_lshlrev_b32 v2, 10, v2
    v_bfe_u32 v3, v13, 2, 2
    v_lshl_add_u32 v2, v3, 7, v2
    v_bfe_u32 v3, v13, 3, 2
    v_lshl_add_u32 v2, v3, 5, v2
    v_and_b32 v3, 3, v13
    v_lshl_add_u32 v220, v3, 3, v2
    v_xor_b32 v221, 32, v220
    v_xor_b32 v222, 64, v220
    v_xor_b32 v223, 96, v220
    v_add_u32 v231, 65536, v220
    v_add_u32 v245, 65536, v221
    v_add_u32 v252, 65536, v222
    v_add_u32 v0, 65536, v223
    v_add_u32 v2, 18432, v1
    v_add_u32 v3, 36864, v1
    v_add_u32 v4, 55296, v1
    s_lshl_b32 s38, s36, 10
    v_add_u32 v6, s38, v1
    v_add_u32 v7, 49152, v1
    v_add_u32 v8, 98304, v1
    s_mov_b32 s29, 4096
    s_mov_b32 s30, 8192
    s_mov_b32 s31, 12288
    s_mov_b32 s32, 16384
    v_and_b32 v14, 7, v13
    s_lshl_b32 s6, s42, 1
    v_add_u32 v14, s6, v14
    v_lshlrev_b32 v14, 6, v14
    v_add_u32 v14, 2490368, v14
    s_mov_b32 s49, 400000
    s_mov_b32 s64, s76
    s_cmp_lg_u32 s36, 0
    s_waitcnt vmcnt(0)
    s_barrier
    s_cbranch_scc1 L_g_poll0
    s_mov_b64 exec, 1
    global_store_dword v240, v247, s[78:79] sc1
    s_mov_b64 exec, -1
    s_branch L_g_poll0
L_g_w3:
    s_waitcnt lgkmcnt(0)
    s_load_dword s76, s[78:79], 110592
    s_waitcnt lgkmcnt(0)
    s_lshl_b32 s6, s5, 6
    s_add_u32 s6, s6, 2490368
    v_mov_b32 v240, s6
    v_mov_b32 v247, s76
    s_lshl_b32 s42, s7, 4
    s_lshl_b32 s6, s36, 2
    s_add_u32 s42, s42, s6
    s_mul_i32 s6, s42, 18432
    s_add_u32 s6, s6, 9961472
    s_add_u32 s8, s78, s6
    s_addc_u32 s9, s79, 0
    s_mov_b32 s10, 73728
    s_mov_b32 s11, 0x20000
    s_mov_b32 s12, s64
    s_mov_b32 s13, s65
    s_mov_b32 s14, 5308416
    s_mov_b32 s15, 0x20000
    s_mov_b32 s44, s66
    s_mov_b32 s45, s67
    s_mov_b32 s46, 5308416
    s_mov_b32 s47, 0x20000
    v_lshrrev_b32 v2, 3, v13
    v_mul_u32_u24 v250, 9216, v2
    v_and_b32 v2, 2, v2
    v_and_b32 v3, 7, v13
    v_xor_b32 v2, v2, v3
    v_lshl_add_u32 v250, v2, 4, v250
    v_xor_b32 v251, 64, v250
    s_and_b32 s6, s36, 1
    s_lshl_b32 s6, s6, 6
    v_xor_b32 v5, s6, v250
    s_mul_i32 s6, s36, 73728
    v_add_u32 v5, s6, v5
    v_lshrrev_b32 v2, 4, v13
    v_lshlrev_b32 v2, 10, v2
    v_bfe_u32 v3, v13, 2, 2
    v_lshl_add_u32 v2, v3, 7, v2
    v_bfe_u32 v3, v13, 3, 2
    v_lshl_add_u32 v2, v3, 5, v2
    v_and_b32 v3, 3, v13
    v_lshl_add_u32 v220, v3, 3, v2
    v_xor_b32 v221, 32, v220
    v_xor_b32 v222, 64, v220
    v_xor_b32 v223, 96, v220
    v_add_u32 v231, 65536, v220
    v_add_u32 v245, 65536, v221
    v_add_u32 v252, 65536, v222
    v_add_u32 v0, 65536, v223
    v_add_u32 v2, 18432, v1
    v_add_u32 v3, 36864, v1
    v_add_u32 v4, 55296, v1
    s_lshl_b32 s38, s36, 10
    v_add_u32 v6, s38, v1
    v_add_u32 v7, 49152, v1
    v_add_u32 v8, 98304, v1
    s_mov_b32 s29, 4096
    s_mov_b32 s30, 8192
    s_mov_b32 s31, 12288
    s_mov_b32 s32, 16384
    v_and_b32 v14, 7, v13
    s_lshl_b32 s6, s42, 1
    v_add_u32 v14, s6, v14
    v_lshlrev_b32 v14, 6, v14
    v_add_u32 v14, 2490368, v14
    s_mov_b32 s49, 400000
    s_mov_b32 s64, s76
    s_mov_b32 m0, 0
    s_add_u32 s28, s33, 0
    buffer_load_dwordx4 v250, s[12:15], s28 offen lds
    s_mov_b32 m0, 1024
    s_add_u32 s28, s33, 73728
    buffer_load_dwordx4 v251, s[12:15], s28 offen lds
    s_mov_b32 m0, 2048
    s_add_u32 s28, s33, 147456
    buffer_load_dwordx4 v250, s[12:15], s28 offen lds
    s_mov_b32 m0, 3072
    s_add_u32 s28, s33, 221184
    buffer_load_dwordx4 v251, s[12:15], s28 offen lds
    s_mov_b32 m0, 4096
    s_add_u32 s28, s33, 0
    buffer_load_dwordx4 v250, s[44:47], s28 offen lds
    s_mov_b32 m0, 5120
    s_add_u32 s28, s33, 73728
    buffer_load_dwordx4 v251, s[44:47], s28 offen lds
    s_mov_b32 m0, 6144
    s_add_u32 s28, s33, 147456
    buffer_load_dwordx4 v250, s[44:47], s28 offen lds
    s_mov_b32 m0, 7168
    s_add_u32 s28, s33, 221184
    buffer_load_dwordx4 v251, s[44:47], s28 offen lds
    s_mov_b32 m0, 8192
    s_add_u32 s28, s33, 294912
    buffer_load_dwordx4 v250, s[12:15], s28 offen lds
    s_mov_b32 m0, 9216
    s_add_u32 s28, s33, 368640
    buffer_load_dwordx4 v251, s[12:15], s28 offen lds
    s_mov_b32 m0, 10240
    s_add_u32 s28, s33, 442368
    buffer_load_dwordx4 v250, s[12:15], s28 offen lds
    s_mov_b32 m0, 11264
    s_add_u32 s28, s33, 516096
    buffer_load_dwordx4 v251, s[12:15], s28 offen lds
    s_mov_b32 m0, 12288
    s_add_u32 s28, s33, 294912
    buffer_load_dwordx4 v250, s[44:47], s28 offen lds
    s_mov_b32 m0, 13312
    s_add_u32 s28, s33, 368640
    buffer_load_dwordx4 v251, s[44:47], s28 offen lds
    s_mov_b32 m0, 14336
    s_add_u32 s28, s33, 442368
    buffer_load_dwordx4 v250, s[44:47], s28 offen lds
    s_mov_b32 m0, 15360
    s_add_u32 s28, s33, 516096
    buffer_load_dwordx4 v251, s[44:47], s28 offen lds
    s_mov_b32 m0, 16384
    s_add_u32 s28, s33, 589824
    buffer_load_dwordx4 v250, s[12:15], s28 offen lds
    s_mov_b32 m0, 17408
    s_add_u32 s28, s33, 663552
    buffer_load_dwordx4 v251, s[12:15], s28 offen lds
    s_mov_b32 m0, 18432
    s_add_u32 s28, s33, 737280
    buffer_load_dwordx4 v250, s[12:15], s28 offen lds
    s_mov_b32 m0, 19456
    s_add_u32 s28, s33, 811008
    buffer_load_dwordx4 v251, s[12:15], s28 offen lds
    s_mov_b32 m0, 20480
    s_add_u32 s28, s33, 589824
    buffer_load_dwordx4 v250, s[44:47], s28 offen lds
    s_mov_b32 m0, 21504
    s_add_u32 s28, s33, 663552
    buffer_load_dwordx4 v251, s[44:47], s28 offen lds
    s_mov_b32 m0, 22528
    s_add_u32 s28, s33, 737280
    buffer_load_dwordx4 v250, s[44:47], s28 offen lds
    s_mov_b32 m0, 23552
    s_add_u32 s28, s33, 811008
    buffer_load_dwordx4 v251, s[44:47], s28 offen lds
    s_mov_b32 m0, 24576
    s_add_u32 s28, s33, 884736
    buffer_load_dwordx4 v250, s[12:15], s28 offen lds
    s_mov_b32 m0, 25600
    s_add_u32 s28, s33, 958464
    buffer_load_dwordx4 v251, s[12:15], s28 offen lds
    s_mov_b32 m0, 26624
    s_add_u32 s28, s33, 1032192
    buffer_load_dwordx4 v250, s[12:15], s28 offen lds
    s_mov_b32 m0, 27648
    s_add_u32 s28, s33, 1105920
    buffer_load_dwordx4 v251, s[12:15], s28 offen lds
    s_mov_b32 m0, 28672
    s_add_u32 s28, s33, 884736
    buffer_load_dwordx4 v250, s[44:47], s28 offen lds
    s_mov_b32 m0, 29696
    s_add_u32 s28, s33, 958464
    buffer_load_dwordx4 v251, s[44:47], s28 offen lds
    s_mov_b32 m0, 30720
    s_add_u32 s28, s33, 1032192
    buffer_load_dwordx4 v250, s[44:47], s28 offen lds
    s_mov_b32 m0, 31744
    s_add_u32 s28, s33, 1105920
    buffer_load_dwordx4 v251, s[44:47], s28 offen lds
    s_mov_b32 m0, 32768
    s_add_u32 s28, s33, 1179648
    buffer_load_dwordx4 v250, s[12:15], s28 offen lds
    s_mov_b32 m0, 33792
    s_add_u32 s28, s33, 1253376
    buffer_load_dwordx4 v251, s[12:15], s28 offen lds
    s_mov_b32 m0, 34816
    s_add_u32 s28, s33, 1327104
    buffer_load_dwordx4 v250, s[12:15], s28 offen lds
    s_mov_b32 m0, 35840
    s_add_u32 s28, s33, 1400832
    buffer_load_dwordx4 v251, s[12:15], s28 offen lds
    s_mov_b32 m0, 36864
    s_add_u32 s28, s33, 1179648
    buffer_load_dwordx4 v250, s[44:47], s28 offen lds
    s_mov_b32 m0, 37888
    s_add_u32 s28, s33, 1253376
    buffer_load_dwordx4 v251, s[44:47], s28 offen lds
    s_mov_b32 m0, 38912
    s_add_u32 s28, s33, 1327104
    buffer_load_dwordx4 v250, s[44:47], s28 offen lds
    s_mov_b32 m0, 39936
    s_add_u32 s28, s33, 1400832
    buffer_load_dwordx4 v251, s[44:47], s28 offen lds
    s_barrier
    s_mov_b32 m0, 40960
    s_add_u32 s28, s33, 1474560
    buffer_load_dwordx4 v250, s[12:15], s28 offen lds
    s_mov_b32 m0, 41984
    s_add_u32 s28, s33, 1548288
    buffer_load_dwordx4 v251, s[12:15], s28 offen lds
    s_mov_b32 m0, 43008
    s_add_u32 s28, s33, 1622016
    buffer_load_dwordx4 v250, s[12:15], s28 offen lds
    s_mov_b32 m0, 44032
    s_add_u32 s28, s33, 1695744
    buffer_load_dwordx4 v251, s[12:15], s28 offen lds
    s_mov_b32 m0, 45056
    s_add_u32 s28, s33, 1474560
    buffer_load_dwordx4 v250, s[44:47], s28 offen lds
    s_mov_b32 m0, 46080
    s_add_u32 s28, s33, 1548288
    buffer_load_dwordx4 v251, s[44:47], s28 offen lds
    s_mov_b32 m0, 47104
    s_add_u32 s28, s33, 1622016
    buffer_load_dwordx4 v250, s[44:47], s28 offen lds
    s_mov_b32 m0, 48128
    s_add_u32 s28, s33, 1695744
    buffer_load_dwordx4 v251, s[44:47], s28 offen lds
    s_mov_b32 m0, 49152
    s_add_u32 s28, s33, 1769472
    buffer_load_dwordx4 v250, s[12:15], s28 offen lds
    s_mov_b32 m0, 50176
    s_add_u32 s28, s33, 1843200
    buffer_load_dwordx4 v251, s[12:15], s28 offen lds
    s_mov_b32 m0, 51200
    s_add_u32 s28, s33, 1916928
    buffer_load_dwordx4 v250, s[12:15], s28 offen lds
    s_mov_b32 m0, 52224
    s_add_u32 s28, s33, 1990656
    buffer_load_dwordx4 v251, s[12:15], s28 offen lds
    s_mov_b32 m0, 53248
    s_add_u32 s28, s33, 1769472
    buffer_load_dwordx4 v250, s[44:47], s28 offen lds
    s_mov_b32 m0, 54272
    s_add_u32 s28, s33, 1843200
    buffer_load_dwordx4 v251, s[44:47], s28 offen lds
    s_mov_b32 m0, 55296
    s_add_u32 s28, s33, 1916928
    buffer_load_dwordx4 v250, s[44:47], s28 offen lds
    s_mov_b32 m0, 56320
    s_add_u32 s28, s33, 1990656
    buffer_load_dwordx4 v251, s[44:47], s28 offen lds
    s_mov_b32 m0, 57344
    s_add_u32 s28, s33, 2064384
    buffer_load_dwordx4 v250, s[12:15], s28 offen lds
    s_mov_b32 m0, 58368
    s_add_u32 s28, s33, 2138112
    buffer_load_dwordx4 v251, s[12:15], s28 offen lds
    s_mov_b32 m0, 59392
    s_add_u32 s28, s33, 2211840
    buffer_load_dwordx4 v250, s[12:15], s28 offen lds
    s_mov_b32 m0, 60416
    s_add_u32 s28, s33, 2285568
    buffer_load_dwordx4 v251, s[12:15], s28 offen lds
    s_mov_b32 m0, 61440
    s_add_u32 s28, s33, 2064384
    buffer_load_dwordx4 v250, s[44:47], s28 offen lds
    s_mov_b32 m0, 62464
    s_add_u32 s28, s33, 2138112
    buffer_load_dwordx4 v251, s[44:47], s28 offen lds
    s_mov_b32 m0, 63488
    s_add_u32 s28, s33, 2211840
    buffer_load_dwordx4 v250, s[44:47], s28 offen lds
    s_mov_b32 m0, 64512
    s_add_u32 s28, s33, 2285568
    buffer_load_dwordx4 v251, s[44:47], s28 offen lds
    s_mov_b32 m0, 65536
    s_add_u32 s28, s33, 2359296
    buffer_load_dwordx4 v250, s[12:15], s28 offen lds
    s_mov_b32 m0, 66560
    s_add_u32 s28, s33, 2433024
    buffer_load_dwordx4 v251, s[12:15], s28 offen lds
    s_mov_b32 m0, 67584
    s_add_u32 s28, s33, 2506752
    buffer_load_dwordx4 v250, s[12:15], s28 offen lds
    s_mov_b32 m0, 68608
    s_add_u32 s28, s33, 2580480
    buffer_load_dwordx4 v251, s[12:15], s28 offen lds
    s_mov_b32 m0, 69632
    s_add_u32 s28, s33, 2359296
    buffer_load_dwordx4 v250, s[44:47], s28 offen lds
    s_mov_b32 m0, 70656
    s_add_u32 s28, s33, 2433024
    buffer_load_dwordx4 v251, s[44:47], s28 offen lds
    s_mov_b32 m0, 71680
    s_add_u32 s28, s33, 2506752
    buffer_load_dwordx4 v250, s[44:47], s28 offen lds
    s_mov_b32 m0, 72704
    s_add_u32 s28, s33, 2580480
    buffer_load_dwordx4 v251, s[44:47], s28 offen lds
    s_mov_b32 m0, 73728
    s_add_u32 s28, s33, 2654208
    buffer_load_dwordx4 v250, s[12:15], s28 offen lds
    s_mov_b32 m0, 74752
    s_add_u32 s28, s33, 2727936
    buffer_load_dwordx4 v251, s[12:15], s28 offen lds
    s_mov_b32 m0, 75776
    s_add_u32 s28, s33, 2801664
    buffer_load_dwordx4 v250, s[12:15], s28 offen lds
    s_mov_b32 m0, 76800
    s_add_u32 s28, s33, 2875392
    buffer_load_dwordx4 v251, s[12:15], s28 offen lds
    s_mov_b32 m0, 77824
    s_add_u32 s28, s33, 2654208
    buffer_load_dwordx4 v250, s[44:47], s28 offen lds
    s_mov_b32 m0, 78848
    s_add_u32 s28, s33, 2727936
    buffer_load_dwordx4 v251, s[44:47], s28 offen lds
    s_mov_b32 m0, 79872
    s_add_u32 s28, s33, 2801664
    buffer_load_dwordx4 v250, s[44:47], s28 offen lds
    s_mov_b32 m0, 80896
    s_add_u32 s28, s33, 2875392
    buffer_load_dwordx4 v251, s[44:47], s28 offen lds
    s_barrier
    s_mov_b32 m0, 81920
    s_add_u32 s28, s33, 2949120
    buffer_load_dwordx4 v250, s[12:15], s28 offen lds
    s_mov_b32 m0, 82944
    s_add_u32 s28, s33, 3022848
    buffer_load_dwordx4 v251, s[12:15], s28 offen lds
    s_mov_b32 m0, 83968
    s_add_u32 s28, s33, 3096576
    buffer_load_dwordx4 v250, s[12:15], s28 offen lds
    s_mov_b32 m0, 84992
    s_add_u32 s28, s33, 3170304
    buffer_load_dwordx4 v251, s[12:15], s28 offen lds
    s_mov_b32 m0, 86016
    s_add_u32 s28, s33, 2949120
    buffer_load_dwordx4 v250, s[44:47], s28 offen lds
    s_mov_b32 m0, 87040
    s_add_u32 s28, s33, 3022848
    buffer_load_dwordx4 v251, s[44:47], s28 offen lds
    s_mov_b32 m0, 88064
    s_add_u32 s28, s33, 3096576
    buffer_load_dwordx4 v250, s[44:47], s28 offen lds
    s_mov_b32 m0, 89088
    s_add_u32 s28, s33, 3170304
    buffer_load_dwordx4 v251, s[44:47], s28 offen lds
    s_mov_b32 m0, 90112
    s_add_u32 s28, s33, 3244032
    buffer_load_dwordx4 v250, s[12:15], s28 offen lds
    s_mov_b32 m0, 91136
    s_add_u32 s28, s33, 3317760
    buffer_load_dwordx4 v251, s[12:15], s28 offen lds
    s_mov_b32 m0, 92160
    s_add_u32 s28, s33, 3391488
    buffer_load_dwordx4 v250, s[12:15], s28 offen lds
    s_mov_b32 m0, 93184
    s_add_u32 s28, s33, 3465216
    buffer_load_dwordx4 v251, s[12:15], s28 offen lds
    s_mov_b32 m0, 94208
    s_add_u32 s28, s33, 3244032
    buffer_load_dwordx4 v250, s[44:47], s28 offen lds
    s_mov_b32 m0, 95232
    s_add_u32 s28, s33, 3317760
    buffer_load_dwordx4 v251, s[44:47], s28 offen lds
    s_mov_b32 m0, 96256
    s_add_u32 s28, s33, 3391488
    buffer_load_dwordx4 v250, s[44:47], s28 offen lds
    s_mov_b32 m0, 97280
    s_add_u32 s28, s33, 3465216
    buffer_load_dwordx4 v251, s[44:47], s28 offen lds
L_g_poll0:
    s_getpc_b64 s[50:51]
L_g_pc2:
    v_lshlrev_b32 v254, 1, v6
    v_and_b32 v254, -128, v254
    s_bfe_u32 s6, s2, 0x20003
    s_lshl_b32 s6, s6, 13
    v_add_u32 v254, s6, v254
    v_add_u32 v254, 4096, v254
    v_min_u32 v254, L_code_end-L_g_pc2-4, v254
    global_load_dword v255, v254, s[50:51]
    s_and_b32 s40, s2, 1
    s_lshl_b32 s40, s40, 3
    s_bfe_u32 s6, s2, 0x30003
    s_add_u32 s40, s40, s6
    s_lshr_b32 s41, s2, 6
    s_and_b32 s0, s36, 1
    s_lshr_b32 s1, s36, 1
    s_lshl_b32 s55, s40, 2
    s_add_u32 s55, s55, s41
    s_lshl_b32 s55, s55, 2
    s_mov_b32 s56, s36
    s_lshl_b32 s6, s55, 15
    s_add_u32 s6, s6, 48234496
    s_add_u32 s60, s78, s6
    s_addc_u32 s61, s79, 0
    s_mov_b32 s62, 131072
    s_mov_b32 s63, 0x20000
    s_lshl_b32 s59, s37, 15
    s_add_u32 s6, s36, 5
    s_lshl_b32 s6, s6, 14
    s_cmp_eq_u32 s36, 0
    s_cselect_b32 s6, 0, s6
    s_cselect_b32 s53, 0x4000, 0
    v_add_u32 v240, s6, v240
    s_mul_i32 s6, s42, 147456
    s_add_u32 s6, s6, 29360128
    s_add_u32 s16, s78, s6
    s_addc_u32 s17, s79, 0
    s_mov_b32 s18, 589824
    s_mov_b32 s19, 0x20000
    s_mul_i32 s6, s3, 9
    s_add_u32 s6, s6, s35
    s_lshr_b32 s6, s6, 1
    s_lshl_b32 s6, s6, 10
    v_add_u32 v9, s6, v1
    v_add_u32 v10, 147456, v9
    v_add_u32 v11, 294912, v9
    v_add_u32 v12, 442368, v9
    s_mul_i32 s6, s35, 4608
    s_sub_u32 s6, 4096, s6
    v_lshlrev_b32 v241, 3, v13
    v_subrev_u32 v241, s6, v241
    s_lshl_b32 s43, s40, 3
    s_lshl_b32 s6, s36, 1
    s_add_u32 s43, s43, s6
    s_mul_i32 s6, s43, 144
    s_mul_i32 s67, s37, 36
    s_add_u32 s6, s6, s67
    s_lshl_b32 s6, s6, 10
    s_add_u32 s6, s6, 29360128
    s_add_u32 s20, s78, s6
    s_addc_u32 s21, s79, 0
    s_mov_b32 s22, 294912
    s_mov_b32 s23, 0x20000
    s_mov_b32 s24, s78
    s_mov_b32 s25, s79
    s_mov_b32 s26, 28532736
    s_mov_b32 s27, 0x20000
    s_mov_b32 s70, 5308416
    s_mov_b32 s71, 0x20000
    v_add_u32 v242, 147456, v1
    v_lshlrev_b32 v243, 3, v13
    v_add_u32 v244, 147456, v243
    s_mul_i32 s1, s1, 9
    s_mul_i32 s6, s0, 5
    s_add_u32 s1, s1, s6
    s_mul_i32 s67, s41, 144
    s_mul_i32 s6, s37, 36
    s_add_u32 s67, s67, s6
    s_add_u32 s67, s67, 2520
    s_add_u32 s1, s1, s67
    s_mul_i32 s1, s1, 9216
    s_mul_i32 s0, s36, 9
    s_add_u32 s0, s0, s67
    s_mul_i32 s0, s0, 9216
    s_mul_i32 s48, s36, 7168
    s_lshl_b32 s54, s36, 11
    v_add_u32 v224, 8192, v1
    s_add_u32 s6, s37, 1
    s_and_b32 s6, s6, 3
    s_lshl_b32 s6, s6, 11
    v_add_u32 v225, s6, v1
    s_add_u32 s6, s37, 2
    s_and_b32 s6, s6, 3
    s_lshl_b32 s6, s6, 11
    v_add_u32 v226, s6, v1
    s_add_u32 s6, s37, 3
    s_and_b32 s6, s6, 3
    s_lshl_b32 s6, s6, 11
    v_add_u32 v227, s6, v1
    s_add_u32 s6, s37, 4
    s_and_b32 s6, s6, 3
    s_lshl_b32 s6, s6, 11
    v_add_u32 v228, s6, v1
    v_lshrrev_b32 v229, 3, v13
    v_mul_u32_u24 v249, 1152, v229
    v_lshlrev_b32 v246, 5, v229
    v_and_b32 v229, 6, v229
    v_and_b32 v230, 7, v13
    v_add_u32 v246, v246, v230
    v_xor_b32 v229, v229, v230
    v_lshl_add_u32 v249, v229, 4, v249
    s_lshl_b32 s6, s37, 3
    v_add_u32 v246, s6, v246
    v_lshlrev_b32 v246, 6, v246
    v_add_u32 v246, 2506752, v246
    v_lshrrev_b32 v229, 2, v13
    v_lshlrev_b32 v229, 7, v229
    v_bfe_u32 v230, v13, 3, 2
    v_lshl_add_u32 v229, v230, 5, v229
    v_and_b32 v230, 3, v13
    v_lshl_add_u32 v229, v230, 3, v229
    s_lshl_b32 s72, s36, 13
    s_add_u32 s72, s72, 131072
    v_add_u32 v229, s72, v229
    s_and_b32 s65, s2, 1
    s_lshl_b32 s65, s65, 5
    s_lshr_b32 s6, s2, 3
    s_add_u32 s65, s65, s6
    s_lshl_b32 s65, s65, 2
    s_add_u32 s65, s65, s36
    s_mul_i32 s66, s65, 7282
    s_lshr_b32 s66, s66, 16
    s_mul_i32 s6, s66, 9
    s_sub_u32 s4, s65, s6
    s_mul_i32 s50, s66, 7282
    s_lshr_b32 s50, s50, 16
    s_mul_i32 s6, s50, 9
    s_sub_u32 s51, s66, s6
    s_lshl_b32 s6, s37, 2
    s_add_u32 s50, s50, s6
    s_cmp_gt_u32 s51, 4
    s_cselect_b32 s6, 5, 0
    s_sub_u32 s28, s51, s6
    s_lshr_b32 s6, s6, 1
    s_lshl_b32 s67, s50, 2
    s_add_u32 s6, s6, s67
    s_and_b32 s67, s28, 1
    s_add_u32 s6, s6, s67
    s_lshr_b32 s67, s28, 1
    s_lshl_b32 s67, s67, 6
    s_add_u32 s6, s6, s67
    s_add_u32 s50, s50, 128
    s_cmp_eq_u32 s51, 4
    s_cselect_b32 s28, s50, s6
    s_mul_i32 s6, s37, 36
    s_add_u32 s66, s66, s6
    s_mul_i32 s6, s28, 36864
    s_lshl_b32 s67, s4, 7
    s_add_u32 s73, s6, s67
    s_mul_i32 s66, s66, 9
    s_add_u32 s66, s66, 22680
    s_lshl_b32 s6, s4, 2
    s_add_u32 s6, s6, 0
    s_mul_i32 s67, s6, 57
    s_lshr_b32 s67, s67, 9
    s_mul_i32 s67, s67, 1287
    s_add_u32 s6, s6, s67
    s_add_u32 s6, s6, s66
    s_lshl_b32 s77, s6, 10
    s_lshl_b32 s6, s4, 2
    s_add_u32 s6, s6, 1
    s_mul_i32 s67, s6, 57
    s_lshr_b32 s67, s67, 9
    s_mul_i32 s67, s67, 1287
    s_add_u32 s6, s6, s67
    s_add_u32 s6, s6, s66
    s_lshl_b32 s57, s6, 10
    s_lshl_b32 s6, s4, 2
    s_add_u32 s6, s6, 2
    s_mul_i32 s67, s6, 57
    s_lshr_b32 s67, s67, 9
    s_mul_i32 s67, s67, 1287
    s_add_u32 s6, s6, s67
    s_add_u32 s6, s6, s66
    s_lshl_b32 s58, s6, 10
    s_lshl_b32 s6, s4, 2
    s_add_u32 s6, s6, 3
    s_mul_i32 s67, s6, 57
    s_lshr_b32 s67, s67, 9
    s_mul_i32 s67, s67, 1287
    s_add_u32 s6, s6, s67
    s_add_u32 s6, s6, s66
    s_lshl_b32 s39, s6, 10
    s_add_u32 s65, s65, 256
    s_mul_i32 s66, s65, 7282
    s_lshr_b32 s66, s66, 16
    s_mul_i32 s6, s66, 9
    s_sub_u32 s4, s65, s6
    s_mul_i32 s50, s66, 7282
    s_lshr_b32 s50, s50, 16
    s_mul_i32 s6, s50, 9
    s_sub_u32 s51, s66, s6
    s_lshl_b32 s6, s37, 2
    s_add_u32 s50, s50, s6
    s_cmp_gt_u32 s51, 4
    s_cselect_b32 s6, 5, 0
    s_sub_u32 s28, s51, s6
    s_lshr_b32 s6, s6, 1
    s_lshl_b32 s67, s50, 2
    s_add_u32 s6, s6, s67
    s_and_b32 s67, s28, 1
    s_add_u32 s6, s6, s67
    s_lshr_b32 s67, s28, 1
    s_lshl_b32 s67, s67, 6
    s_add_u32 s6, s6, s67
    s_add_u32 s50, s50, 128
    s_cmp_eq_u32 s51, 4
    s_cselect_b32 s28, s50, s6
    s_mul_i32 s6, s37, 36
    s_add_u32 s66, s66, s6
    s_mul_i32 s6, s28, 36864
    s_lshl_b32 s67, s4, 7
    s_add_u32 s76, s6, s67
    s_mul_i32 s66, s66, 9
    s_add_u32 s66, s66, 22680
    s_lshl_b32 s6, s4, 2
    s_add_u32 s6, s6, 0
    s_mul_i32 s67, s6, 57
    s_lshr_b32 s67, s67, 9
    s_mul_i32 s67, s67, 1287
    s_add_u32 s6, s6, s67
    s_add_u32 s6, s6, s66
    s_lshl_b32 s42, s6, 10
    s_lshl_b32 s6, s4, 2
    s_add_u32 s6, s6, 1
    s_mul_i32 s67, s6, 57
    s_lshr_b32 s67, s67, 9
    s_mul_i32 s67, s67, 1287
    s_add_u32 s6, s6, s67
    s_add_u32 s6, s6, s66
    s_lshl_b32 s43, s6, 10
    s_lshl_b32 s6, s4, 2
    s_add_u32 s6, s6, 2
    s_mul_i32 s67, s6, 57
    s_lshr_b32 s67, s67, 9
    s_mul_i32 s67, s67, 1287
    s_add_u32 s6, s6, s67
    s_add_u32 s6, s6, s66
    s_lshl_b32 s5, s6, 10
    s_lshl_b32 s6, s4, 2
    s_add_u32 s6, s6, 3
    s_mul_i32 s67, s6, 57
    s_lshr_b32 s67, s67, 9
    s_mul_i32 s67, s67, 1287
    s_add_u32 s6, s6, s67
    s_add_u32 s6, s6, s66
    s_lshl_b32 s7, s6, 10
    s_cmp_ge_u32 s65, 324
    s_cselect_b32 s76, 0x40000000, s76
    s_cselect_b32 s42, 0x40000000, s42
    s_cselect_b32 s43, 0x40000000, s43
    s_cselect_b32 s5, 0x40000000, s5
    s_cselect_b32 s7, 0x40000000, s7
    s_lshr_b32 s6, s40, 1
    s_lshl_b32 s6, s6, 5
    s_lshl_b32 s67, s37, 3
    s_add_u32 s6, s6, s67
    v_and_b32 v253, 7, v13
    v_add_u32 v253, s6, v253
    v_lshlrev_b32 v253, 6, v253
    v_add_u32 v253, 2506752, v253
    v_mov_b32 v15, s64
    s_mov_b64 exec, 0xff
    s_nop 0
L_g_poll:
    global_load_dword v15, v14, s[78:79] sc1
    s_sub_u32 s49, s49, 1
    s_waitcnt vmcnt(0)
    v_cmp_ne_u32 vcc, s64, v15
    s_cmp_eq_u32 s49, 0
    s_nop 3
    s_cbranch_scc1 L_g_poll_ok
    s_cbranch_vccz L_g_poll_ok
    s_sleep 1
    s_branch L_g_poll
L_g_poll_ok:
    s_mov_b64 exec, -1
    buffer_load_dwordx4 a[0:3], v1, s[8:11], 0 offen offset:0 sc1
    buffer_load_dwordx4 a[4:7], v2, s[8:11], 0 offen offset:0 sc1
    buffer_load_dwordx4 a[8:11], v3, s[8:11], 0 offen offset:0 sc1
    buffer_load_dwordx4 a[12:15], v4, s[8:11], 0 offen offset:0 sc1
    buffer_load_dwordx4 a[16:19], v1, s[8:11], 0 offen offset:1024 sc1
    buffer_load_dwordx4 a[20:23], v2, s[8:11], 0 offen offset:1024 sc1
    buffer_load_dwordx4 a[24:27], v3, s[8:11], 0 offen offset:1024 sc1
    buffer_load_dwordx4 a[28:31], v4, s[8:11], 0 offen offset:1024 sc1
    s_barrier
    ds_read_b64_tr_b16 v[192:193], v220 offset:0
    ds_read_b64_tr_b16 v[194:195], v220 offset:512
    ds_read_b64_tr_b16 v[196:197], v221 offset:0
    ds_read_b64_tr_b16 v[198:199], v221 offset:512
    ds_read_b64_tr_b16 v[200:201], v222 offset:0
    ds_read_b64_tr_b16 v[202:203], v222 offset:512
    ds_read_b64_tr_b16 v[204:205], v223 offset:0
    ds_read_b64_tr_b16 v[206:207], v223 offset:512
    ds_read_b64_tr_b16 v[208:209], v220 offset:4096
    ds_read_b64_tr_b16 v[210:211], v220 offset:4608
    s_waitcnt vmcnt(4)
    s_waitcnt lgkmcnt(8)
    v_mfma_f32_16x16x32_bf16 v[48:51], v[192:195], a[0:3], 0
    ds_read_b64_tr_b16 v[212:213], v221 offset:4096
    v_mfma_f32_16x16x32_bf16 v[52:55], v[192:195], a[4:7], 0
    buffer_load_dwordx4 a[32:35], v1, s[8:11], 0 offen offset:2048 sc1
    v_mfma_f32_16x16x32_bf16 v[56:59], v[192:195], a[8:11], 0
    ds_read_b64_tr_b16 v[214:215], v221 offset:4608
    v_mfma_f32_16x16x32_bf16 v[60:63], v[192:195], a[12:15], 0
    s_waitcnt lgkmcnt(8)
    v_mfma_f32_16x16x32_bf16 v[92:95], v[196:199], a[12:15], 0
    ds_read_b64_tr_b16 v[216:217], v222 offset:4096
    v_mfma_f32_16x16x32_bf16 v[88:91], v[196:199], a[8:11], 0
    buffer_load_dwordx4 a[36:39], v2, s[8:11], 0 offen offset:2048 sc1
    v_mfma_f32_16x16x32_bf16 v[84:87], v[196:199], a[4:7], 0
    ds_read_b64_tr_b16 v[218:219], v222 offset:4608
    v_mfma_f32_16x16x32_bf16 v[80:83], v[196:199], a[0:3], 0
    s_waitcnt lgkmcnt(8)
    v_mfma_f32_16x16x32_bf16 v[112:115], v[200:203], a[0:3], 0
    ds_read_b64_tr_b16 v[192:193], v223 offset:4096
    v_mfma_f32_16x16x32_bf16 v[116:119], v[200:203], a[4:7], 0
    buffer_load_dwordx4 a[40:43], v3, s[8:11], 0 offen offset:2048 sc1
    v_mfma_f32_16x16x32_bf16 v[120:123], v[200:203], a[8:11], 0
    ds_read_b64_tr_b16 v[194:195], v223 offset:4608
    v_mfma_f32_16x16x32_bf16 v[124:127], v[200:203], a[12:15], 0
    s_waitcnt lgkmcnt(8)
    v_mfma_f32_16x16x32_bf16 v[156:159], v[204:207], a[12:15], 0
    ds_read_b64_tr_b16 v[196:197], v220 offset:8192
    v_mfma_f32_16x16x32_bf16 v[152:155], v[204:207], a[8:11], 0
    buffer_load_dwordx4 a[44:47], v4, s[8:11], 0 offen offset:2048 sc1
    v_mfma_f32_16x16x32_bf16 v[148:151], v[204:207], a[4:7], 0
    ds_read_b64_tr_b16 v[198:199], v220 offset:8704
    v_mfma_f32_16x16x32_bf16 v[144:147], v[204:207], a[0:3], 0
    s_waitcnt lgkmcnt(8)
    v_mfma_f32_16x16x32_bf16 v[64:67], v[208:211], a[0:3], 0
    ds_read_b64_tr_b16 v[200:201], v221 offset:8192
    v_mfma_f32_16x16x32_bf16 v[68:71], v[208:211], a[4:7], 0
    buffer_load_dwordx4 a[48:51], v1, s[8:11], 0 offen offset:3072 sc1
    v_mfma_f32_16x16x32_bf16 v[72:75], v[208:211], a[8:11], 0
    ds_read_b64_tr_b16 v[202:203], v221 offset:8704
    v_mfma_f32_16x16x32_bf16 v[76:79], v[208:211], a[12:15], 0
    s_waitcnt lgkmcnt(8)
    v_mfma_f32_16x16x32_bf16 v[108:111], v[212:215], a[12:15], 0
    ds_read_b64_tr_b16 v[204:205], v222 offset:8192
    v_mfma_f32_16x16x32_bf16 v[104:107], v[212:215], a[8:11], 0
    buffer_load_dwordx4 a[52:55], v2, s[8:11], 0 offen offset:3072 sc1
    v_mfma_f32_16x16x32_bf16 v[100:103], v[212:215], a[4:7], 0
    ds_read_b64_tr_b16 v[206:207], v222 offset:8704
    v_mfma_f32_16x16x32_bf16 v[96:99], v[212:215], a[0:3], 0
    s_waitcnt lgkmcnt(8)
    v_mfma_f32_16x16x32_bf16 v[128:131], v[216:219], a[0:3], 0
    ds_read_b64_tr_b16 v[208:209], v223 offset:8192
    v_mfma_f32_16x16x32_bf16 v[132:135], v[216:219], a[4:7], 0
    buffer_load_dwordx4 a[56:59], v3, s[8:11], 0 offen offset:3072 sc1
    v_mfma_f32_16x16x32_bf16 v[136:139], v[216:219], a[8:11], 0
    ds_read_b64_tr_b16 v[210:211], v223 offset:8704
    v_mfma_f32_16x16x32_bf16 v[140:143], v[216:219], a[12:15], 0
    s_waitcnt lgkmcnt(8)
    v_mfma_f32_16x16x32_bf16 v[172:175], v[192:195], a[12:15], 0
    ds_read_b64_tr_b16 v[212:213], v220 offset:12288
    v_mfma_f32_16x16x32_bf16 v[168:171], v[192:195], a[8:11], 0
    buffer_load_dwordx4 a[60:63], v4, s[8:11], 0 offen offset:3072 sc1
    v_mfma_f32_16x16x32_bf16 v[164:167], v[192:195], a[4:7], 0
    ds_read_b64_tr_b16 v[214:215], v220 offset:12800
    v_mfma_f32_16x16x32_bf16 v[160:163], v[192:195], a[0:3], 0
    s_waitcnt vmcnt(8)
    s_waitcnt lgkmcnt(8)
    v_mfma_f32_16x16x32_bf16 v[48:51], v[196:199], a[16:19], v[48:51]
    ds_read_b64_tr_b16 v[216:217], v221 offset:12288
    v_mfma_f32_16x16x32_bf16 v[52:55], v[196:199], a[20:23], v[52:55]
    buffer_load_dwordx4 a[64:67], v1, s[8:11], s29 offen offset:0 sc1
    v_mfma_f32_16x16x32_bf16 v[56:59], v[196:199], a[24:27], v[56:59]
    ds_read_b64_tr_b16 v[218:219], v221 offset:12800
    v_mfma_f32_16x16x32_bf16 v[60:63], v[196:199], a[28:31], v[60:63]
    s_waitcnt lgkmcnt(8)
    v_mfma_f32_16x16x32_bf16 v[92:95], v[200:203], a[28:31], v[92:95]
    ds_read_b64_tr_b16 v[192:193], v222 offset:12288
    v_mfma_f32_16x16x32_bf16 v[88:91], v[200:203], a[24:27], v[88:91]
    buffer_load_dwordx4 a[68:71], v2, s[8:11], s29 offen offset:0 sc1
    v_mfma_f32_16x16x32_bf16 v[84:87], v[200:203], a[20:23], v[84:87]
    ds_read_b64_tr_b16 v[194:195], v222 offset:12800
    v_mfma_f32_16x16x32_bf16 v[80:83], v[200:203], a[16:19], v[80:83]
    s_waitcnt lgkmcnt(8)
    v_mfma_f32_16x16x32_bf16 v[112:115], v[204:207], a[16:19], v[112:115]
    ds_read_b64_tr_b16 v[196:197], v223 offset:12288
    v_mfma_f32_16x16x32_bf16 v[116:119], v[204:207], a[20:23], v[116:119]
    buffer_load_dwordx4 a[72:75], v3, s[8:11], s29 offen offset:0 sc1
    v_mfma_f32_16x16x32_bf16 v[120:123], v[204:207], a[24:27], v[120:123]
    ds_read_b64_tr_b16 v[198:199], v223 offset:12800
    v_mfma_f32_16x16x32_bf16 v[124:127], v[204:207], a[28:31], v[124:127]
    s_waitcnt lgkmcnt(8)
    v_mfma_f32_16x16x32_bf16 v[156:159], v[208:211], a[28:31], v[156:159]
    ds_read_b64_tr_b16 v[200:201], v220 offset:16384
    v_mfma_f32_16x16x32_bf16 v[152:155], v[208:211], a[24:27], v[152:155]
    buffer_load_dwordx4 a[76:79], v4, s[8:11], s29 offen offset:0 sc1
    v_mfma_f32_16x16x32_bf16 v[148:151], v[208:211], a[20:23], v[148:151]
    ds_read_b64_tr_b16 v[202:203], v220 offset:16896
    v_mfma_f32_16x16x32_bf16 v[144:147], v[208:211], a[16:19], v[144:147]
    s_waitcnt lgkmcnt(8)
    v_mfma_f32_16x16x32_bf16 v[64:67], v[212:215], a[16:19], v[64:67]
    ds_read_b64_tr_b16 v[204:205], v221 offset:16384
    v_mfma_f32_16x16x32_bf16 v[68:71], v[212:215], a[20:23], v[68:71]
    v_mfma_f32_16x16x32_bf16 v[72:75], v[212:215], a[24:27], v[72:75]
    ds_read_b64_tr_b16 v[206:207], v221 offset:16896
    v_mfma_f32_16x16x32_bf16 v[76:79], v[212:215], a[28:31], v[76:79]
    s_waitcnt lgkmcnt(8)
    v_mfma_f32_16x16x32_bf16 v[108:111], v[216:219], a[28:31], v[108:111]
    ds_read_b64_tr_b16 v[208:209], v222 offset:16384
    v_mfma_f32_16x16x32_bf16 v[104:107], v[216:219], a[24:27], v[104:107]
    v_mfma_f32_16x16x32_bf16 v[100:103], v[216:219], a[20:23], v[100:103]
    ds_read_b64_tr_b16 v[210:211], v222 offset:16896
    v_mfma_f32_16x16x32_bf16 v[96:99], v[216:219], a[16:19], v[96:99]
    s_waitcnt lgkmcnt(8)
    v_mfma_f32_16x16x32_bf16 v[128:131], v[192:195], a[16:19], v[128:131]
    ds_read_b64_tr_b16 v[212:213], v223 offset:16384
    v_mfma_f32_16x16x32_bf16 v[132:135], v[192:195], a[20:23], v[132:135]
    buffer_load_dwordx4 a[80:83], v1, s[8:11], s29 offen offset:1024 sc1
    v_mfma_f32_16x16x32_bf16 v[136:139], v[192:195], a[24:27], v[136:139]
    ds_read_b64_tr_b16 v[214:215], v223 offset:16896
    v_mfma_f32_16x16x32_bf16 v[140:143], v[192:195], a[28:31], v[140:143]
    s_waitcnt lgkmcnt(8)
    v_mfma_f32_16x16x32_bf16 v[172:175], v[196:199], a[28:31], v[172:175]
    ds_read_b64_tr_b16 v[216:217], v220 offset:20480
    v_mfma_f32_16x16x32_bf16 v[168:171], v[196:199], a[24:27], v[168:171]
    buffer_load_dwordx4 a[84:87], v2, s[8:11], s29 offen offset:1024 sc1
    v_mfma_f32_16x16x32_bf16 v[164:167], v[196:199], a[20:23], v[164:167]
    ds_read_b64_tr_b16 v[218:219], v220 offset:20992
    v_mfma_f32_16x16x32_bf16 v[160:163], v[196:199], a[16:19], v[160:163]
    s_waitcnt vmcnt(10)
    s_waitcnt lgkmcnt(8)
    v_mfma_f32_16x16x32_bf16 v[48:51], v[200:203], a[32:35], v[48:51]
    ds_read_b64_tr_b16 v[192:193], v221 offset:20480
    v_mfma_f32_16x16x32_bf16 v[52:55], v[200:203], a[36:39], v[52:55]
    buffer_load_dwordx4 a[88:91], v3, s[8:11], s29 offen offset:1024 sc1
    v_mfma_f32_16x16x32_bf16 v[56:59], v[200:203], a[40:43], v[56:59]
    ds_read_b64_tr_b16 v[194:195], v221 offset:20992
    v_mfma_f32_16x16x32_bf16 v[60:63], v[200:203], a[44:47], v[60:63]
    s_waitcnt lgkmcnt(8)
    v_mfma_f32_16x16x32_bf16 v[92:95], v[204:207], a[44:47], v[92:95]
    ds_read_b64_tr_b16 v[196:197], v222 offset:20480
    v_mfma_f32_16x16x32_bf16 v[88:91], v[204:207], a[40:43], v[88:91]
    buffer_load_dwordx4 a[92:95], v4, s[8:11], s29 offen offset:1024 sc1
    v_mfma_f32_16x16x32_bf16 v[84:87], v[204:207], a[36:39], v[84:87]
    ds_read_b64_tr_b16 v[198:199], v222 offset:20992
    v_mfma_f32_16x16x32_bf16 v[80:83], v[204:207], a[32:35], v[80:83]
    s_waitcnt lgkmcnt(8)
    v_mfma_f32_16x16x32_bf16 v[112:115], v[208:211], a[32:35], v[112:115]
    ds_read_b64_tr_b16 v[200:201], v223 offset:20480
    v_mfma_f32_16x16x32_bf16 v[116:119], v[208:211], a[36:39], v[116:119]
    buffer_load_dwordx4 a[96:99], v1, s[8:11], s29 offen offset:2048 sc1
    v_mfma_f32_16x16x32_bf16 v[120:123], v[208:211], a[40:43], v[120:123]
    ds_read_b64_tr_b16 v[202:203], v223 offset:20992
    v_mfma_f32_16x16x32_bf16 v[124:127], v[208:211], a[44:47], v[124:127]
    s_waitcnt lgkmcnt(8)
    v_mfma_f32_16x16x32_bf16 v[156:159], v[212:215], a[44:47], v[156:159]
    s_barrier
    ds_read_b64_tr_b16 v[204:205], v220 offset:24576
    v_mfma_f32_16x16x32_bf16 v[152:155], v[212:215], a[40:43], v[152:155]
    buffer_load_dwordx4 a[100:103], v2, s[8:11], s29 offen offset:2048 sc1
    v_mfma_f32_16x16x32_bf16 v[148:151], v[212:215], a[36:39], v[148:151]
    ds_read_b64_tr_b16 v[206:207], v220 offset:25088
    v_mfma_f32_16x16x32_bf16 v[144:147], v[212:215], a[32:35], v[144:147]
    s_waitcnt lgkmcnt(8)
    v_mfma_f32_16x16x32_bf16 v[64:67], v[216:219], a[32:35], v[64:67]
    ds_read_b64_tr_b16 v[208:209], v221 offset:24576
    v_mfma_f32_16x16x32_bf16 v[68:71], v[216:219], a[36:39], v[68:71]
    v_mfma_f32_16x16x32_bf16 v[72:75], v[216:219], a[40:43], v[72:75]
    ds_read_b64_tr_b16 v[210:211], v221 offset:25088
    v_mfma_f32_16x16x32_bf16 v[76:79], v[216:219], a[44:47], v[76:79]
    s_waitcnt lgkmcnt(8)
    v_mfma_f32_16x16x32_bf16 v[108:111], v[192:195], a[44:47], v[108:111]
    ds_read_b64_tr_b16 v[212:213], v222 offset:24576
    v_mfma_f32_16x16x32_bf16 v[104:107], v[192:195], a[40:43], v[104:107]
    buffer_load_dwordx4 a[104:107], v3, s[8:11], s29 offen offset:2048 sc1
    v_mfma_f32_16x16x32_bf16 v[100:103], v[192:195], a[36:39], v[100:103]
    ds_read_b64_tr_b16 v[214:215], v222 offset:25088
    v_mfma_f32_16x16x32_bf16 v[96:99], v[192:195], a[32:35], v[96:99]
    s_waitcnt lgkmcnt(8)
    v_mfma_f32_16x16x32_bf16 v[128:131], v[196:199], a[32:35], v[128:131]
    ds_read_b64_tr_b16 v[216:217], v223 offset:24576
    v_mfma_f32_16x16x32_bf16 v[132:135], v[196:199], a[36:39], v[132:135]
    buffer_load_dwordx4 a[108:111], v4, s[8:11], s29 offen offset:2048 sc1
    v_mfma_f32_16x16x32_bf16 v[136:139], v[196:199], a[40:43], v[136:139]
    ds_read_b64_tr_b16 v[218:219], v223 offset:25088
    v_mfma_f32_16x16x32_bf16 v[140:143], v[196:199], a[44:47], v[140:143]
    s_waitcnt lgkmcnt(8)
    v_mfma_f32_16x16x32_bf16 v[172:175], v[200:203], a[44:47], v[172:175]
    ds_read_b64_tr_b16 v[192:193], v220 offset:28672
    v_mfma_f32_16x16x32_bf16 v[168:171], v[200:203], a[40:43], v[168:171]
    buffer_load_dwordx4 a[112:115], v1, s[8:11], s29 offen offset:3072 sc1
    v_mfma_f32_16x16x32_bf16 v[164:167], v[200:203], a[36:39], v[164:167]
    ds_read_b64_tr_b16 v[194:195], v220 offset:29184
    v_mfma_f32_16x16x32_bf16 v[160:163], v[200:203], a[32:35], v[160:163]
    s_waitcnt vmcnt(13)
    s_waitcnt lgkmcnt(8)
    v_mfma_f32_16x16x32_bf16 v[48:51], v[204:207], a[48:51], v[48:51]
    ds_read_b64_tr_b16 v[196:197], v221 offset:28672
    v_mfma_f32_16x16x32_bf16 v[52:55], v[204:207], a[52:55], v[52:55]
    buffer_load_dwordx4 a[116:119], v2, s[8:11], s29 offen offset:3072 sc1
    v_mfma_f32_16x16x32_bf16 v[56:59], v[204:207], a[56:59], v[56:59]
    ds_read_b64_tr_b16 v[198:199], v221 offset:29184
    v_mfma_f32_16x16x32_bf16 v[60:63], v[204:207], a[60:63], v[60:63]
    s_waitcnt lgkmcnt(8)
    v_mfma_f32_16x16x32_bf16 v[92:95], v[208:211], a[60:63], v[92:95]
    ds_read_b64_tr_b16 v[200:201], v222 offset:28672
    v_mfma_f32_16x16x32_bf16 v[88:91], v[208:211], a[56:59], v[88:91]
    buffer_load_dwordx4 a[120:123], v3, s[8:11], s29 offen offset:3072 sc1
    v_mfma_f32_16x16x32_bf16 v[84:87], v[208:211], a[52:55], v[84:87]
    ds_read_b64_tr_b16 v[202:203], v222 offset:29184
    v_mfma_f32_16x16x32_bf16 v[80:83], v[208:211], a[48:51], v[80:83]
    s_waitcnt lgkmcnt(8)
    v_mfma_f32_16x16x32_bf16 v[112:115], v[212:215], a[48:51], v[112:115]
    ds_read_b64_tr_b16 v[204:205], v223 offset:28672
    v_mfma_f32_16x16x32_bf16 v[116:119], v[212:215], a[52:55], v[116:119]
    buffer_load_dwordx4 a[124:127], v4, s[8:11], s29 offen offset:3072 sc1
    v_mfma_f32_16x16x32_bf16 v[120:123], v[212:215], a[56:59], v[120:123]
    ds_read_b64_tr_b16 v[206:207], v223 offset:29184
    v_mfma_f32_16x16x32_bf16 v[124:127], v[212:215], a[60:63], v[124:127]
    s_waitcnt lgkmcnt(8)
    v_mfma_f32_16x16x32_bf16 v[156:159], v[216:219], a[60:63], v[156:159]
    ds_read_b64_tr_b16 v[208:209], v220 offset:32768
    v_mfma_f32_16x16x32_bf16 v[152:155], v[216:219], a[56:59], v[152:155]
    buffer_load_dwordx4 a[128:131], v1, s[8:11], s30 offen offset:0 sc1
    v_mfma_f32_16x16x32_bf16 v[148:151], v[216:219], a[52:55], v[148:151]
    ds_read_b64_tr_b16 v[210:211], v220 offset:33280
    v_mfma_f32_16x16x32_bf16 v[144:147], v[216:219], a[48:51], v[144:147]
    s_waitcnt lgkmcnt(8)
    v_mfma_f32_16x16x32_bf16 v[64:67], v[192:195], a[48:51], v[64:67]
    ds_read_b64_tr_b16 v[212:213], v221 offset:32768
    v_mfma_f32_16x16x32_bf16 v[68:71], v[192:195], a[52:55], v[68:71]
    buffer_load_dwordx4 a[132:135], v2, s[8:11], s30 offen offset:0 sc1
    v_mfma_f32_16x16x32_bf16 v[72:75], v[192:195], a[56:59], v[72:75]
    ds_read_b64_tr_b16 v[214:215], v221 offset:33280
    v_mfma_f32_16x16x32_bf16 v[76:79], v[192:195], a[60:63], v[76:79]
    s_waitcnt lgkmcnt(8)
    v_mfma_f32_16x16x32_bf16 v[108:111], v[196:199], a[60:63], v[108:111]
    ds_read_b64_tr_b16 v[216:217], v222 offset:32768
    v_mfma_f32_16x16x32_bf16 v[104:107], v[196:199], a[56:59], v[104:107]
    v_mfma_f32_16x16x32_bf16 v[100:103], v[196:199], a[52:55], v[100:103]
    ds_read_b64_tr_b16 v[218:219], v222 offset:33280
    v_mfma_f32_16x16x32_bf16 v[96:99], v[196:199], a[48:51], v[96:99]
    s_waitcnt lgkmcnt(8)
    v_mfma_f32_16x16x32_bf16 v[128:131], v[200:203], a[48:51], v[128:131]
    ds_read_b64_tr_b16 v[192:193], v223 offset:32768
    v_mfma_f32_16x16x32_bf16 v[132:135], v[200:203], a[52:55], v[132:135]
    buffer_load_dwordx4 a[136:139], v3, s[8:11], s30 offen offset:0 sc1
    v_mfma_f32_16x16x32_bf16 v[136:139], v[200:203], a[56:59], v[136:139]
    ds_read_b64_tr_b16 v[194:195], v223 offset:33280
    v_mfma_f32_16x16x32_bf16 v[140:143], v[200:203], a[60:63], v[140:143]
    s_waitcnt lgkmcnt(8)
    v_mfma_f32_16x16x32_bf16 v[172:175], v[204:207], a[60:63], v[172:175]
    ds_read_b64_tr_b16 v[196:197], v220 offset:36864
    v_mfma_f32_16x16x32_bf16 v[168:171], v[204:207], a[56:59], v[168:171]
    buffer_load_dwordx4 a[140:143], v4, s[8:11], s30 offen offset:0 sc1
    v_mfma_f32_16x16x32_bf16 v[164:167], v[204:207], a[52:55], v[164:167]
    ds_read_b64_tr_b16 v[198:199], v220 offset:37376
    v_mfma_f32_16x16x32_bf16 v[160:163], v[204:207], a[48:51], v[160:163]
    s_waitcnt vmcnt(16)
    s_waitcnt lgkmcnt(8)
    v_mfma_f32_16x16x32_bf16 v[48:51], v[208:211], a[64:67], v[48:51]
    ds_read_b64_tr_b16 v[200:201], v221 offset:36864
    s_add_u32 m0, s38, 98304
    v_mfma_f32_16x16x32_bf16 v[52:55], v[208:211], a[68:71], v[52:55]
    s_add_u32 s28, s33, 3538944
    buffer_load_dwordx4 v5, s[12:15], s28 offen lds
    v_mfma_f32_16x16x32_bf16 v[56:59], v[208:211], a[72:75], v[56:59]
    ds_read_b64_tr_b16 v[202:203], v221 offset:37376
    v_mfma_f32_16x16x32_bf16 v[60:63], v[208:211], a[76:79], v[60:63]
    s_waitcnt lgkmcnt(8)
    v_mfma_f32_16x16x32_bf16 v[92:95], v[212:215], a[76:79], v[92:95]
    ds_read_b64_tr_b16 v[204:205], v222 offset:36864
    v_mfma_f32_16x16x32_bf16 v[88:91], v[212:215], a[72:75], v[88:91]
    buffer_load_dwordx4 a[144:147], v1, s[8:11], s30 offen offset:1024 sc1
    v_mfma_f32_16x16x32_bf16 v[84:87], v[212:215], a[68:71], v[84:87]
    ds_read_b64_tr_b16 v[206:207], v222 offset:37376
    v_mfma_f32_16x16x32_bf16 v[80:83], v[212:215], a[64:67], v[80:83]
    s_waitcnt lgkmcnt(8)
    v_mfma_f32_16x16x32_bf16 v[112:115], v[216:219], a[64:67], v[112:115]
    ds_read_b64_tr_b16 v[208:209], v223 offset:36864
    v_mfma_f32_16x16x32_bf16 v[116:119], v[216:219], a[68:71], v[116:119]
    buffer_load_dwordx4 a[148:151], v2, s[8:11], s30 offen offset:1024 sc1
    v_mfma_f32_16x16x32_bf16 v[120:123], v[216:219], a[72:75], v[120:123]
    ds_read_b64_tr_b16 v[210:211], v223 offset:37376
    v_mfma_f32_16x16x32_bf16 v[124:127], v[216:219], a[76:79], v[124:127]
    s_waitcnt lgkmcnt(8)
    v_mfma_f32_16x16x32_bf16 v[156:159], v[192:195], a[76:79], v[156:159]
    ds_read_b64_tr_b16 v[212:213], v220 offset:40960
    s_add_u32 m0, s38, 102400
    v_mfma_f32_16x16x32_bf16 v[152:155], v[192:195], a[72:75], v[152:155]
    s_add_u32 s28, s33, 3538944
    buffer_load_dwordx4 v5, s[44:47], s28 offen lds
    v_mfma_f32_16x16x32_bf16 v[148:151], v[192:195], a[68:71], v[148:151]
    ds_read_b64_tr_b16 v[214:215], v220 offset:41472
    v_mfma_f32_16x16x32_bf16 v[144:147], v[192:195], a[64:67], v[144:147]
    s_waitcnt lgkmcnt(8)
    v_mfma_f32_16x16x32_bf16 v[64:67], v[196:199], a[64:67], v[64:67]
    ds_read_b64_tr_b16 v[216:217], v221 offset:40960
    v_mfma_f32_16x16x32_bf16 v[68:71], v[196:199], a[68:71], v[68:71]
    buffer_load_dwordx4 a[152:155], v3, s[8:11], s30 offen offset:1024 sc1
    v_mfma_f32_16x16x32_bf16 v[72:75], v[196:199], a[72:75], v[72:75]
    ds_read_b64_tr_b16 v[218:219], v221 offset:41472
    v_mfma_f32_16x16x32_bf16 v[76:79], v[196:199], a[76:79], v[76:79]
    s_waitcnt lgkmcnt(8)
    v_mfma_f32_16x16x32_bf16 v[108:111], v[200:203], a[76:79], v[108:111]
    ds_read_b64_tr_b16 v[192:193], v222 offset:40960
    v_mfma_f32_16x16x32_bf16 v[104:107], v[200:203], a[72:75], v[104:107]
    buffer_load_dwordx4 a[156:159], v4, s[8:11], s30 offen offset:1024 sc1
    v_mfma_f32_16x16x32_bf16 v[100:103], v[200:203], a[68:71], v[100:103]
    ds_read_b64_tr_b16 v[194:195], v222 offset:41472
    v_mfma_f32_16x16x32_bf16 v[96:99], v[200:203], a[64:67], v[96:99]
    s_waitcnt lgkmcnt(8)
    v_mfma_f32_16x16x32_bf16 v[128:131], v[204:207], a[64:67], v[128:131]
    ds_read_b64_tr_b16 v[196:197], v223 offset:40960
    s_add_u32 m0, s38, 106496
    v_mfma_f32_16x16x32_bf16 v[132:135], v[204:207], a[68:71], v[132:135]
    s_add_u32 s28, s33, 3833856
    buffer_load_dwordx4 v5, s[12:15], s28 offen lds
    v_mfma_f32_16x16x32_bf16 v[136:139], v[204:207], a[72:75], v[136:139]
    ds_read_b64_tr_b16 v[198:199], v223 offset:41472
    v_mfma_f32_16x16x32_bf16 v[140:143], v[204:207], a[76:79], v[140:143]
    s_waitcnt lgkmcnt(8)
    v_mfma_f32_16x16x32_bf16 v[172:175], v[208:211], a[76:79], v[172:175]
    ds_read_b64_tr_b16 v[200:201], v220 offset:45056
    v_mfma_f32_16x16x32_bf16 v[168:171], v[208:211], a[72:75], v[168:171]
    v_mfma_f32_16x16x32_bf16 v[164:167], v[208:211], a[68:71], v[164:167]
    ds_read_b64_tr_b16 v[202:203], v220 offset:45568
    v_mfma_f32_16x16x32_bf16 v[160:163], v[208:211], a[64:67], v[160:163]
    s_waitcnt vmcnt(19)
    s_waitcnt lgkmcnt(8)
    v_mfma_f32_16x16x32_bf16 v[48:51], v[212:215], a[80:83], v[48:51]
    ds_read_b64_tr_b16 v[204:205], v221 offset:45056
    v_mfma_f32_16x16x32_bf16 v[52:55], v[212:215], a[84:87], v[52:55]
    buffer_load_dwordx4 a[160:163], v1, s[8:11], s30 offen offset:2048 sc1
    v_mfma_f32_16x16x32_bf16 v[56:59], v[212:215], a[88:91], v[56:59]
    ds_read_b64_tr_b16 v[206:207], v221 offset:45568
    v_mfma_f32_16x16x32_bf16 v[60:63], v[212:215], a[92:95], v[60:63]
    s_waitcnt lgkmcnt(8)
    v_mfma_f32_16x16x32_bf16 v[92:95], v[216:219], a[92:95], v[92:95]
    ds_read_b64_tr_b16 v[208:209], v222 offset:45056
    s_add_u32 m0, s38, 110592
    v_mfma_f32_16x16x32_bf16 v[88:91], v[216:219], a[88:91], v[88:91]
    s_add_u32 s28, s33, 3833856
    buffer_load_dwordx4 v5, s[44:47], s28 offen lds
    v_mfma_f32_16x16x32_bf16 v[84:87], v[216:219], a[84:87], v[84:87]
    ds_read_b64_tr_b16 v[210:211], v222 offset:45568
    v_mfma_f32_16x16x32_bf16 v[80:83], v[216:219], a[80:83], v[80:83]
    s_waitcnt lgkmcnt(8)
    v_mfma_f32_16x16x32_bf16 v[112:115], v[192:195], a[80:83], v[112:115]
    ds_read_b64_tr_b16 v[212:213], v223 offset:45056
    v_mfma_f32_16x16x32_bf16 v[116:119], v[192:195], a[84:87], v[116:119]
    buffer_load_dwordx4 a[164:167], v2, s[8:11], s30 offen offset:2048 sc1
    v_mfma_f32_16x16x32_bf16 v[120:123], v[192:195], a[88:91], v[120:123]
    ds_read_b64_tr_b16 v[214:215], v223 offset:45568
    v_mfma_f32_16x16x32_bf16 v[124:127], v[192:195], a[92:95], v[124:127]
    s_waitcnt lgkmcnt(8)
    v_mfma_f32_16x16x32_bf16 v[156:159], v[196:199], a[92:95], v[156:159]
    s_barrier
    ds_read_b64_tr_b16 v[216:217], v220 offset:49152
    v_mfma_f32_16x16x32_bf16 v[152:155], v[196:199], a[88:91], v[152:155]
    buffer_load_dwordx4 a[168:171], v3, s[8:11], s30 offen offset:2048 sc1
    v_mfma_f32_16x16x32_bf16 v[148:151], v[196:199], a[84:87], v[148:151]
    ds_read_b64_tr_b16 v[218:219], v220 offset:49664
    v_mfma_f32_16x16x32_bf16 v[144:147], v[196:199], a[80:83], v[144:147]
    s_waitcnt lgkmcnt(8)
    v_mfma_f32_16x16x32_bf16 v[64:67], v[200:203], a[80:83], v[64:67]
    ds_read_b64_tr_b16 v[192:193], v221 offset:49152
    v_mfma_f32_16x16x32_bf16 v[68:71], v[200:203], a[84:87], v[68:71]
    buffer_load_dwordx4 a[172:175], v4, s[8:11], s30 offen offset:2048 sc1
    v_mfma_f32_16x16x32_bf16 v[72:75], v[200:203], a[88:91], v[72:75]
    ds_read_b64_tr_b16 v[194:195], v221 offset:49664
    v_mfma_f32_16x16x32_bf16 v[76:79], v[200:203], a[92:95], v[76:79]
    s_waitcnt lgkmcnt(8)
    v_mfma_f32_16x16x32_bf16 v[108:111], v[204:207], a[92:95], v[108:111]
    ds_read_b64_tr_b16 v[196:197], v222 offset:49152
    s_add_u32 m0, s38, 114688
    v_mfma_f32_16x16x32_bf16 v[104:107], v[204:207], a[88:91], v[104:107]
    s_add_u32 s28, s33, 4128768
    buffer_load_dwordx4 v5, s[12:15], s28 offen lds
    v_mfma_f32_16x16x32_bf16 v[100:103], v[204:207], a[84:87], v[100:103]
    ds_read_b64_tr_b16 v[198:199], v222 offset:49664
    v_mfma_f32_16x16x32_bf16 v[96:99], v[204:207], a[80:83], v[96:99]
    s_waitcnt lgkmcnt(8)
    v_mfma_f32_16x16x32_bf16 v[128:131], v[208:211], a[80:83], v[128:131]
    ds_read_b64_tr_b16 v[200:201], v223 offset:49152
    v_mfma_f32_16x16x32_bf16 v[132:135], v[208:211], a[84:87], v[132:135]
    buffer_load_dwordx4 a[176:179], v1, s[8:11], s30 offen offset:3072 sc1
    v_mfma_f32_16x16x32_bf16 v[136:139], v[208:211], a[88:91], v[136:139]
    ds_read_b64_tr_b16 v[202:203], v223 offset:49664
    v_mfma_f32_16x16x32_bf16 v[140:143], v[208:211], a[92:95], v[140:143]
    s_waitcnt lgkmcnt(8)
    v_mfma_f32_16x16x32_bf16 v[172:175], v[212:215], a[92:95], v[172:175]
    ds_read_b64_tr_b16 v[204:205], v220 offset:53248
    v_mfma_f32_16x16x32_bf16 v[168:171], v[212:215], a[88:91], v[168:171]
    buffer_load_dwordx4 a[180:183], v2, s[8:11], s30 offen offset:3072 sc1
    v_mfma_f32_16x16x32_bf16 v[164:167], v[212:215], a[84:87], v[164:167]
    ds_read_b64_tr_b16 v[206:207], v220 offset:53760
    v_mfma_f32_16x16x32_bf16 v[160:163], v[212:215], a[80:83], v[160:163]
    s_waitcnt vmcnt(23)
    s_waitcnt lgkmcnt(8)
    v_mfma_f32_16x16x32_bf16 v[48:51], v[216:219], a[96:99], v[48:51]
    ds_read_b64_tr_b16 v[208:209], v221 offset:53248
    s_add_u32 m0, s38, 118784
    v_mfma_f32_16x16x32_bf16 v[52:55], v[216:219], a[100:103], v[52:55]
    s_add_u32 s28, s33, 4128768
    buffer_load_dwordx4 v5, s[44:47], s28 offen lds
    v_mfma_f32_16x16x32_bf16 v[56:59], v[216:219], a[104:107], v[56:59]
    ds_read_b64_tr_b16 v[210:211], v221 offset:53760
    v_mfma_f32_16x16x32_bf16 v[60:63], v[216:219], a[108:111], v[60:63]
    s_waitcnt lgkmcnt(8)
    v_mfma_f32_16x16x32_bf16 v[92:95], v[192:195], a[108:111], v[92:95]
    ds_read_b64_tr_b16 v[212:213], v222 offset:53248
    v_mfma_f32_16x16x32_bf16 v[88:91], v[192:195], a[104:107], v[88:91]
    v_mfma_f32_16x16x32_bf16 v[84:87], v[192:195], a[100:103], v[84:87]
    ds_read_b64_tr_b16 v[214:215], v222 offset:53760
    v_mfma_f32_16x16x32_bf16 v[80:83], v[192:195], a[96:99], v[80:83]
    s_waitcnt lgkmcnt(8)
    v_mfma_f32_16x16x32_bf16 v[112:115], v[196:199], a[96:99], v[112:115]
    ds_read_b64_tr_b16 v[216:217], v223 offset:53248
    v_mfma_f32_16x16x32_bf16 v[116:119], v[196:199], a[100:103], v[116:119]
    buffer_load_dwordx4 a[184:187], v3, s[8:11], s30 offen offset:3072 sc1
    v_mfma_f32_16x16x32_bf16 v[120:123], v[196:199], a[104:107], v[120:123]
    ds_read_b64_tr_b16 v[218:219], v223 offset:53760
    v_mfma_f32_16x16x32_bf16 v[124:127], v[196:199], a[108:111], v[124:127]
    s_waitcnt lgkmcnt(8)
    v_mfma_f32_16x16x32_bf16 v[156:159], v[200:203], a[108:111], v[156:159]
    ds_read_b64_tr_b16 v[192:193], v220 offset:57344
    s_add_u32 m0, s38, 122880
    v_mfma_f32_16x16x32_bf16 v[152:155], v[200:203], a[104:107], v[152:155]
    s_add_u32 s28, s33, 4423680
    buffer_load_dwordx4 v5, s[12:15], s28 offen lds
    v_mfma_f32_16x16x32_bf16 v[148:151], v[200:203], a[100:103], v[148:151]
    ds_read_b64_tr_b16 v[194:195], v220 offset:57856
    v_mfma_f32_16x16x32_bf16 v[144:147], v[200:203], a[96:99], v[144:147]
    s_waitcnt lgkmcnt(8)
    v_mfma_f32_16x16x32_bf16 v[64:67], v[204:207], a[96:99], v[64:67]
    ds_read_b64_tr_b16 v[196:197], v221 offset:57344
    v_mfma_f32_16x16x32_bf16 v[68:71], v[204:207], a[100:103], v[68:71]
    buffer_load_dwordx4 a[188:191], v4, s[8:11], s30 offen offset:3072 sc1
    v_mfma_f32_16x16x32_bf16 v[72:75], v[204:207], a[104:107], v[72:75]
    ds_read_b64_tr_b16 v[198:199], v221 offset:57856
    v_mfma_f32_16x16x32_bf16 v[76:79], v[204:207], a[108:111], v[76:79]
    s_waitcnt lgkmcnt(8)
    v_mfma_f32_16x16x32_bf16 v[108:111], v[208:211], a[108:111], v[108:111]
    ds_read_b64_tr_b16 v[200:201], v222 offset:57344
    v_mfma_f32_16x16x32_bf16 v[104:107], v[208:211], a[104:107], v[104:107]
    buffer_load_dwordx4 a[192:195], v1, s[8:11], s31 offen offset:0 sc1
    v_mfma_f32_16x16x32_bf16 v[100:103], v[208:211], a[100:103], v[100:103]
    ds_read_b64_tr_b16 v[202:203], v222 offset:57856
    v_mfma_f32_16x16x32_bf16 v[96:99], v[208:211], a[96:99], v[96:99]
    s_waitcnt lgkmcnt(8)
    v_mfma_f32_16x16x32_bf16 v[128:131], v[212:215], a[96:99], v[128:131]
    ds_read_b64_tr_b16 v[204:205], v223 offset:57344
    s_add_u32 m0, s38, 126976
    v_mfma_f32_16x16x32_bf16 v[132:135], v[212:215], a[100:103], v[132:135]
    s_add_u32 s28, s33, 4423680
    buffer_load_dwordx4 v5, s[44:47], s28 offen lds
    v_mfma_f32_16x16x32_bf16 v[136:139], v[212:215], a[104:107], v[136:139]
    ds_read_b64_tr_b16 v[206:207], v223 offset:57856
    v_mfma_f32_16x16x32_bf16 v[140:143], v[212:215], a[108:111], v[140:143]
    s_waitcnt lgkmcnt(8)
    v_mfma_f32_16x16x32_bf16 v[172:175], v[216:219], a[108:111], v[172:175]
    ds_read_b64_tr_b16 v[208:209], v220 offset:61440
    v_mfma_f32_16x16x32_bf16 v[168:171], v[216:219], a[104:107], v[168:171]
    buffer_load_dwordx4 a[196:199], v2, s[8:11], s31 offen offset:0 sc1
    v_mfma_f32_16x16x32_bf16 v[164:167], v[216:219], a[100:103], v[164:167]
    ds_read_b64_tr_b16 v[210:211], v220 offset:61952
    v_mfma_f32_16x16x32_bf16 v[160:163], v[216:219], a[96:99], v[160:163]
    s_waitcnt vmcnt(26)
    s_waitcnt lgkmcnt(8)
    v_mfma_f32_16x16x32_bf16 v[48:51], v[192:195], a[112:115], v[48:51]
    ds_read_b64_tr_b16 v[212:213], v221 offset:61440
    v_mfma_f32_16x16x32_bf16 v[52:55], v[192:195], a[116:119], v[52:55]
    buffer_load_dwordx4 a[200:203], v3, s[8:11], s31 offen offset:0 sc1
    v_mfma_f32_16x16x32_bf16 v[56:59], v[192:195], a[120:123], v[56:59]
    ds_read_b64_tr_b16 v[214:215], v221 offset:61952
    v_mfma_f32_16x16x32_bf16 v[60:63], v[192:195], a[124:127], v[60:63]
    s_waitcnt lgkmcnt(8)
    v_mfma_f32_16x16x32_bf16 v[92:95], v[196:199], a[124:127], v[92:95]
    ds_read_b64_tr_b16 v[216:217], v222 offset:61440
    v_mfma_f32_16x16x32_bf16 v[88:91], v[196:199], a[120:123], v[88:91]
    buffer_load_dwordx4 a[204:207], v4, s[8:11], s31 offen offset:0 sc1
    v_mfma_f32_16x16x32_bf16 v[84:87], v[196:199], a[116:119], v[84:87]
    ds_read_b64_tr_b16 v[218:219], v222 offset:61952
    v_mfma_f32_16x16x32_bf16 v[80:83], v[196:199], a[112:115], v[80:83]
    s_waitcnt lgkmcnt(8)
    v_mfma_f32_16x16x32_bf16 v[112:115], v[200:203], a[112:115], v[112:115]
    ds_read_b64_tr_b16 v[192:193], v223 offset:61440
    s_add_u32 m0, s38, 0
    v_mfma_f32_16x16x32_bf16 v[116:119], v[200:203], a[116:119], v[116:119]
    s_add_u32 s28, s33, 4718592
    buffer_load_dwordx4 v5, s[12:15], s28 offen lds
    v_mfma_f32_16x16x32_bf16 v[120:123], v[200:203], a[120:123], v[120:123]
    ds_read_b64_tr_b16 v[194:195], v223 offset:61952
    v_mfma_f32_16x16x32_bf16 v[124:127], v[200:203], a[124:127], v[124:127]
    s_waitcnt lgkmcnt(8)
    v_mfma_f32_16x16x32_bf16 v[156:159], v[204:207], a[124:127], v[156:159]
    ds_read_b64_tr_b16 v[196:197], v231 offset:0
    v_mfma_f32_16x16x32_bf16 v[152:155], v[204:207], a[120:123], v[152:155]
    v_mfma_f32_16x16x32_bf16 v[148:151], v[204:207], a[116:119], v[148:151]
    ds_read_b64_tr_b16 v[198:199], v231 offset:512
    v_mfma_f32_16x16x32_bf16 v[144:147], v[204:207], a[112:115], v[144:147]
    s_waitcnt lgkmcnt(8)
    v_mfma_f32_16x16x32_bf16 v[64:67], v[208:211], a[112:115], v[64:67]
    ds_read_b64_tr_b16 v[200:201], v245 offset:0
    v_mfma_f32_16x16x32_bf16 v[68:71], v[208:211], a[116:119], v[68:71]
    buffer_load_dwordx4 a[208:211], v1, s[8:11], s31 offen offset:1024 sc1
    v_mfma_f32_16x16x32_bf16 v[72:75], v[208:211], a[120:123], v[72:75]
    ds_read_b64_tr_b16 v[202:203], v245 offset:512
    v_mfma_f32_16x16x32_bf16 v[76:79], v[208:211], a[124:127], v[76:79]
    s_waitcnt lgkmcnt(8)
    v_mfma_f32_16x16x32_bf16 v[108:111], v[212:215], a[124:127], v[108:111]
    ds_read_b64_tr_b16 v[204:205], v252 offset:0
    s_add_u32 m0, s38, 4096
    v_mfma_f32_16x16x32_bf16 v[104:107], v[212:215], a[120:123], v[104:107]
    s_add_u32 s28, s33, 4718592
    buffer_load_dwordx4 v5, s[44:47], s28 offen lds
    v_mfma_f32_16x16x32_bf16 v[100:103], v[212:215], a[116:119], v[100:103]
    ds_read_b64_tr_b16 v[206:207], v252 offset:512
    v_mfma_f32_16x16x32_bf16 v[96:99], v[212:215], a[112:115], v[96:99]
    s_waitcnt lgkmcnt(8)
    v_mfma_f32_16x16x32_bf16 v[128:131], v[216:219], a[112:115], v[128:131]
    ds_read_b64_tr_b16 v[208:209], v0 offset:0
    v_mfma_f32_16x16x32_bf16 v[132:135], v[216:219], a[116:119], v[132:135]
    buffer_load_dwordx4 a[212:215], v2, s[8:11], s31 offen offset:1024 sc1
    v_mfma_f32_16x16x32_bf16 v[136:139], v[216:219], a[120:123], v[136:139]
    ds_read_b64_tr_b16 v[210:211], v0 offset:512
    v_mfma_f32_16x16x32_bf16 v[140:143], v[216:219], a[124:127], v[140:143]
    s_waitcnt lgkmcnt(8)
    v_mfma_f32_16x16x32_bf16 v[172:175], v[192:195], a[124:127], v[172:175]
    ds_read_b64_tr_b16 v[212:213], v231 offset:4096
    v_mfma_f32_16x16x32_bf16 v[168:171], v[192:195], a[120:123], v[168:171]
    buffer_load_dwordx4 a[216:219], v3, s[8:11], s31 offen offset:1024 sc1
    v_mfma_f32_16x16x32_bf16 v[164:167], v[192:195], a[116:119], v[164:167]
    ds_read_b64_tr_b16 v[214:215], v231 offset:4608
    v_mfma_f32_16x16x32_bf16 v[160:163], v[192:195], a[112:115], v[160:163]
    s_waitcnt vmcnt(29)
    s_waitcnt lgkmcnt(8)
    v_mfma_f32_16x16x32_bf16 v[48:51], v[196:199], a[128:131], v[48:51]
    ds_read_b64_tr_b16 v[216:217], v245 offset:4096
    s_add_u32 m0, s38, 8192
    v_mfma_f32_16x16x32_bf16 v[52:55], v[196:199], a[132:135], v[52:55]
    s_add_u32 s28, s33, 5013504
    buffer_load_dwordx4 v5, s[12:15], s28 offen lds
    v_mfma_f32_16x16x32_bf16 v[56:59], v[196:199], a[136:139], v[56:59]
    ds_read_b64_tr_b16 v[218:219], v245 offset:4608
    v_mfma_f32_16x16x32_bf16 v[60:63], v[196:199], a[140:143], v[60:63]
    s_waitcnt lgkmcnt(8)
    v_mfma_f32_16x16x32_bf16 v[92:95], v[200:203], a[140:143], v[92:95]
    ds_read_b64_tr_b16 v[192:193], v252 offset:4096
    v_mfma_f32_16x16x32_bf16 v[88:91], v[200:203], a[136:139], v[88:91]
    buffer_load_dwordx4 a[220:223], v4, s[8:11], s31 offen offset:1024 sc1
    v_mfma_f32_16x16x32_bf16 v[84:87], v[200:203], a[132:135], v[84:87]
    ds_read_b64_tr_b16 v[194:195], v252 offset:4608
    v_mfma_f32_16x16x32_bf16 v[80:83], v[200:203], a[128:131], v[80:83]
    s_waitcnt lgkmcnt(8)
    v_mfma_f32_16x16x32_bf16 v[112:115], v[204:207], a[128:131], v[112:115]
    ds_read_b64_tr_b16 v[196:197], v0 offset:4096
    v_mfma_f32_16x16x32_bf16 v[116:119], v[204:207], a[132:135], v[116:119]
    buffer_load_dwordx4 a[224:227], v1, s[8:11], s31 offen offset:2048 sc1
    v_mfma_f32_16x16x32_bf16 v[120:123], v[204:207], a[136:139], v[120:123]
    ds_read_b64_tr_b16 v[198:199], v0 offset:4608
    v_mfma_f32_16x16x32_bf16 v[124:127], v[204:207], a[140:143], v[124:127]
    s_waitcnt lgkmcnt(8)
    v_mfma_f32_16x16x32_bf16 v[156:159], v[208:211], a[140:143], v[156:159]
    s_barrier
    ds_read_b64_tr_b16 v[200:201], v231 offset:8192
    s_add_u32 m0, s38, 12288
    v_mfma_f32_16x16x32_bf16 v[152:155], v[208:211], a[136:139], v[152:155]
    s_add_u32 s28, s33, 5013504
    buffer_load_dwordx4 v5, s[44:47], s28 offen lds
    v_mfma_f32_16x16x32_bf16 v[148:151], v[208:211], a[132:135], v[148:151]
    ds_read_b64_tr_b16 v[202:203], v231 offset:8704
    v_mfma_f32_16x16x32_bf16 v[144:147], v[208:211], a[128:131], v[144:147]
    s_waitcnt lgkmcnt(8)
    v_mfma_f32_16x16x32_bf16 v[64:67], v[212:215], a[128:131], v[64:67]
    ds_read_b64_tr_b16 v[204:205], v245 offset:8192
    v_mfma_f32_16x16x32_bf16 v[68:71], v[212:215], a[132:135], v[68:71]
    buffer_load_dwordx4 a[228:231], v2, s[8:11], s31 offen offset:2048 sc1
    v_mfma_f32_16x16x32_bf16 v[72:75], v[212:215], a[136:139], v[72:75]
    ds_read_b64_tr_b16 v[206:207], v245 offset:8704
    v_mfma_f32_16x16x32_bf16 v[76:79], v[212:215], a[140:143], v[76:79]
    s_waitcnt lgkmcnt(8)
    v_mfma_f32_16x16x32_bf16 v[108:111], v[216:219], a[140:143], v[108:111]
    ds_read_b64_tr_b16 v[208:209], v252 offset:8192
    v_mfma_f32_16x16x32_bf16 v[104:107], v[216:219], a[136:139], v[104:107]
    v_mfma_f32_16x16x32_bf16 v[100:103], v[216:219], a[132:135], v[100:103]
    ds_read_b64_tr_b16 v[210:211], v252 offset:8704
    v_mfma_f32_16x16x32_bf16 v[96:99], v[216:219], a[128:131], v[96:99]
    s_waitcnt lgkmcnt(8)
    v_mfma_f32_16x16x32_bf16 v[128:131], v[192:195], a[128:131], v[128:131]
    ds_read_b64_tr_b16 v[212:213], v0 offset:8192
    v_mfma_f32_16x16x32_bf16 v[132:135], v[192:195], a[132:135], v[132:135]
    buffer_load_dwordx4 a[232:235], v3, s[8:11], s31 offen offset:2048 sc1
    v_mfma_f32_16x16x32_bf16 v[136:139], v[192:195], a[136:139], v[136:139]
    ds_read_b64_tr_b16 v[214:215], v0 offset:8704
    v_mfma_f32_16x16x32_bf16 v[140:143], v[192:195], a[140:143], v[140:143]
    s_waitcnt lgkmcnt(8)
    v_mfma_f32_16x16x32_bf16 v[172:175], v[196:199], a[140:143], v[172:175]
    ds_read_b64_tr_b16 v[216:217], v231 offset:12288
    v_mfma_f32_16x16x32_bf16 v[168:171], v[196:199], a[136:139], v[168:171]
    buffer_load_dwordx4 a[236:239], v4, s[8:11], s31 offen offset:2048 sc1
    v_mfma_f32_16x16x32_bf16 v[164:167], v[196:199], a[132:135], v[164:167]
    ds_read_b64_tr_b16 v[218:219], v231 offset:12800
    v_mfma_f32_16x16x32_bf16 v[160:163], v[196:199], a[128:131], v[160:163]
    s_waitcnt vmcnt(30)
    s_waitcnt lgkmcnt(8)
    v_mfma_f32_16x16x32_bf16 v[48:51], v[200:203], a[144:147], v[48:51]
    ds_read_b64_tr_b16 v[192:193], v245 offset:12288
    s_add_u32 m0, s38, 16384
    v_mfma_f32_16x16x32_bf16 v[52:55], v[200:203], a[148:151], v[52:55]
    s_add_u32 s28, s34, 0
    buffer_load_dwordx4 v6, s[24:27], s28 offen lds
    v_mfma_f32_16x16x32_bf16 v[56:59], v[200:203], a[152:155], v[56:59]
    ds_read_b64_tr_b16 v[194:195], v245 offset:12800
    v_mfma_f32_16x16x32_bf16 v[60:63], v[200:203], a[156:159], v[60:63]
    s_waitcnt lgkmcnt(8)
    v_mfma_f32_16x16x32_bf16 v[92:95], v[204:207], a[156:159], v[92:95]
    ds_read_b64_tr_b16 v[196:197], v252 offset:12288
    v_mfma_f32_16x16x32_bf16 v[88:91], v[204:207], a[152:155], v[88:91]
    buffer_load_dwordx4 a[240:243], v1, s[8:11], s31 offen offset:3072 sc1
    v_mfma_f32_16x16x32_bf16 v[84:87], v[204:207], a[148:151], v[84:87]
    ds_read_b64_tr_b16 v[198:199], v252 offset:12800
    v_mfma_f32_16x16x32_bf16 v[80:83], v[204:207], a[144:147], v[80:83]
    s_waitcnt lgkmcnt(8)
    v_mfma_f32_16x16x32_bf16 v[112:115], v[208:211], a[144:147], v[112:115]
    ds_read_b64_tr_b16 v[200:201], v0 offset:12288
    v_mfma_f32_16x16x32_bf16 v[116:119], v[208:211], a[148:151], v[116:119]
    buffer_load_dwordx4 a[244:247], v2, s[8:11], s31 offen offset:3072 sc1
    v_mfma_f32_16x16x32_bf16 v[120:123], v[208:211], a[152:155], v[120:123]
    ds_read_b64_tr_b16 v[202:203], v0 offset:12800
    v_mfma_f32_16x16x32_bf16 v[124:127], v[208:211], a[156:159], v[124:127]
    s_waitcnt lgkmcnt(8)
    v_mfma_f32_16x16x32_bf16 v[156:159], v[212:215], a[156:159], v[156:159]
    ds_read_b64_tr_b16 v[204:205], v231 offset:16384
    s_add_u32 m0, s38, 20480
    v_mfma_f32_16x16x32_bf16 v[152:155], v[212:215], a[152:155], v[152:155]
    s_add_u32 s28, s34, 4096
    buffer_load_dwordx4 v6, s[24:27], s28 offen lds
    v_mfma_f32_16x16x32_bf16 v[148:151], v[212:215], a[148:151], v[148:151]
    ds_read_b64_tr_b16 v[206:207], v231 offset:16896
    v_mfma_f32_16x16x32_bf16 v[144:147], v[212:215], a[144:147], v[144:147]
    s_waitcnt lgkmcnt(8)
    v_mfma_f32_16x16x32_bf16 v[64:67], v[216:219], a[144:147], v[64:67]
    ds_read_b64_tr_b16 v[208:209], v245 offset:16384
    v_mfma_f32_16x16x32_bf16 v[68:71], v[216:219], a[148:151], v[68:71]
    buffer_load_dwordx4 a[248:251], v3, s[8:11], s31 offen offset:3072 sc1
    v_mfma_f32_16x16x32_bf16 v[72:75], v[216:219], a[152:155], v[72:75]
    ds_read_b64_tr_b16 v[210:211], v245 offset:16896
    v_mfma_f32_16x16x32_bf16 v[76:79], v[216:219], a[156:159], v[76:79]
    s_waitcnt lgkmcnt(8)
    v_mfma_f32_16x16x32_bf16 v[108:111], v[192:195], a[156:159], v[108:111]
    ds_read_b64_tr_b16 v[212:213], v252 offset:16384
    v_mfma_f32_16x16x32_bf16 v[104:107], v[192:195], a[152:155], v[104:107]
    buffer_load_dwordx4 a[252:255], v4, s[8:11], s31 offen offset:3072 sc1
    v_mfma_f32_16x16x32_bf16 v[100:103], v[192:195], a[148:151], v[100:103]
    ds_read_b64_tr_b16 v[214:215], v252 offset:16896
    v_mfma_f32_16x16x32_bf16 v[96:99], v[192:195], a[144:147], v[96:99]
    s_waitcnt lgkmcnt(8)
    v_mfma_f32_16x16x32_bf16 v[128:131], v[196:199], a[144:147], v[128:131]
    ds_read_b64_tr_b16 v[216:217], v0 offset:16384
    s_add_u32 m0, s38, 24576
    v_mfma_f32_16x16x32_bf16 v[132:135], v[196:199], a[148:151], v[132:135]
    s_add_u32 s28, s34, 8192
    buffer_load_dwordx4 v6, s[24:27], s28 offen lds
    v_mfma_f32_16x16x32_bf16 v[136:139], v[196:199], a[152:155], v[136:139]
    ds_read_b64_tr_b16 v[218:219], v0 offset:16896
    v_mfma_f32_16x16x32_bf16 v[140:143], v[196:199], a[156:159], v[140:143]
    s_waitcnt lgkmcnt(8)
    v_mfma_f32_16x16x32_bf16 v[172:175], v[200:203], a[156:159], v[172:175]
    ds_read_b64_tr_b16 v[192:193], v231 offset:20480
    v_mfma_f32_16x16x32_bf16 v[168:171], v[200:203], a[152:155], v[168:171]
    v_mfma_f32_16x16x32_bf16 v[164:167], v[200:203], a[148:151], v[164:167]
    ds_read_b64_tr_b16 v[194:195], v231 offset:20992
    v_mfma_f32_16x16x32_bf16 v[160:163], v[200:203], a[144:147], v[160:163]
    s_waitcnt vmcnt(31)
    s_waitcnt lgkmcnt(8)
    v_mfma_f32_16x16x32_bf16 v[48:51], v[204:207], a[160:163], v[48:51]
    ds_read_b64_tr_b16 v[196:197], v245 offset:20480
    v_mfma_f32_16x16x32_bf16 v[52:55], v[204:207], a[164:167], v[52:55]
    buffer_load_dwordx4 v[16:19], v1, s[8:11], s32 offen offset:0 sc1
    v_mfma_f32_16x16x32_bf16 v[56:59], v[204:207], a[168:171], v[56:59]
    ds_read_b64_tr_b16 v[198:199], v245 offset:20992
    v_mfma_f32_16x16x32_bf16 v[60:63], v[204:207], a[172:175], v[60:63]
    s_waitcnt lgkmcnt(8)
    v_mfma_f32_16x16x32_bf16 v[92:95], v[208:211], a[172:175], v[92:95]
    ds_read_b64_tr_b16 v[200:201], v252 offset:20480
    s_add_u32 m0, s38, 28672
    v_mfma_f32_16x16x32_bf16 v[88:91], v[208:211], a[168:171], v[88:91]
    s_add_u32 s28, s34, 12288
    buffer_load_dwordx4 v6, s[24:27], s28 offen lds
    v_mfma_f32_16x16x32_bf16 v[84:87], v[208:211], a[164:167], v[84:87]
    ds_read_b64_tr_b16 v[202:203], v252 offset:20992
    v_mfma_f32_16x16x32_bf16 v[80:83], v[208:211], a[160:163], v[80:83]
    s_waitcnt lgkmcnt(8)
    v_mfma_f32_16x16x32_bf16 v[112:115], v[212:215], a[160:163], v[112:115]
    ds_read_b64_tr_b16 v[204:205], v0 offset:20480
    v_mfma_f32_16x16x32_bf16 v[116:119], v[212:215], a[164:167], v[116:119]
    buffer_load_dwordx4 v[20:23], v2, s[8:11], s32 offen offset:0 sc1
    v_mfma_f32_16x16x32_bf16 v[120:123], v[212:215], a[168:171], v[120:123]
    ds_read_b64_tr_b16 v[206:207], v0 offset:20992
    v_mfma_f32_16x16x32_bf16 v[124:127], v[212:215], a[172:175], v[124:127]
    s_waitcnt lgkmcnt(8)
    v_mfma_f32_16x16x32_bf16 v[156:159], v[216:219], a[172:175], v[156:159]
    ds_read_b64_tr_b16 v[208:209], v231 offset:24576
    v_mfma_f32_16x16x32_bf16 v[152:155], v[216:219], a[168:171], v[152:155]
    buffer_load_dwordx4 v[24:27], v3, s[8:11], s32 offen offset:0 sc1
    v_mfma_f32_16x16x32_bf16 v[148:151], v[216:219], a[164:167], v[148:151]
    ds_read_b64_tr_b16 v[210:211], v231 offset:25088
    v_mfma_f32_16x16x32_bf16 v[144:147], v[216:219], a[160:163], v[144:147]
    s_waitcnt lgkmcnt(8)
    v_mfma_f32_16x16x32_bf16 v[64:67], v[192:195], a[160:163], v[64:67]
    ds_read_b64_tr_b16 v[212:213], v245 offset:24576
    s_add_u32 m0, s38, 32768
    v_mfma_f32_16x16x32_bf16 v[68:71], v[192:195], a[164:167], v[68:71]
    s_add_u32 s28, s34, 16384
    buffer_load_dwordx4 v6, s[24:27], s28 offen lds
    v_mfma_f32_16x16x32_bf16 v[72:75], v[192:195], a[168:171], v[72:75]
    ds_read_b64_tr_b16 v[214:215], v245 offset:25088
    v_mfma_f32_16x16x32_bf16 v[76:79], v[192:195], a[172:175], v[76:79]
    s_waitcnt lgkmcnt(8)
    v_mfma_f32_16x16x32_bf16 v[108:111], v[196:199], a[172:175], v[108:111]
    ds_read_b64_tr_b16 v[216:217], v252 offset:24576
    v_mfma_f32_16x16x32_bf16 v[104:107], v[196:199], a[168:171], v[104:107]
    buffer_load_dwordx4 v[28:31], v4, s[8:11], s32 offen offset:0 sc1
    v_mfma_f32_16x16x32_bf16 v[100:103], v[196:199], a[164:167], v[100:103]
    ds_read_b64_tr_b16 v[218:219], v252 offset:25088
    v_mfma_f32_16x16x32_bf16 v[96:99], v[196:199], a[160:163], v[96:99]
    s_waitcnt lgkmcnt(8)
    v_mfma_f32_16x16x32_bf16 v[128:131], v[200:203], a[160:163], v[128:131]
    ds_read_b64_tr_b16 v[192:193], v0 offset:24576
    v_mfma_f32_16x16x32_bf16 v[132:135], v[200:203], a[164:167], v[132:135]
    buffer_load_dwordx4 v[32:35], v1, s[8:11], s32 offen offset:1024 sc1
    v_mfma_f32_16x16x32_bf16 v[136:139], v[200:203], a[168:171], v[136:139]
    ds_read_b64_tr_b16 v[194:195], v0 offset:25088
    v_mfma_f32_16x16x32_bf16 v[140:143], v[200:203], a[172:175], v[140:143]
    s_waitcnt lgkmcnt(8)
    v_mfma_f32_16x16x32_bf16 v[172:175], v[204:207], a[172:175], v[172:175]
    ds_read_b64_tr_b16 v[196:197], v231 offset:28672
    v_mfma_f32_16x16x32_bf16 v[168:171], v[204:207], a[168:171], v[168:171]
    buffer_load_dwordx4 v[36:39], v2, s[8:11], s32 offen offset:1024 sc1
    v_mfma_f32_16x16x32_bf16 v[164:167], v[204:207], a[164:167], v[164:167]
    ds_read_b64_tr_b16 v[198:199], v231 offset:29184
    v_mfma_f32_16x16x32_bf16 v[160:163], v[204:207], a[160:163], v[160:163]
    s_waitcnt vmcnt(32)
    s_waitcnt lgkmcnt(8)
    v_mfma_f32_16x16x32_bf16 v[48:51], v[208:211], a[176:179], v[48:51]
    ds_read_b64_tr_b16 v[200:201], v245 offset:28672
    v_mfma_f32_16x16x32_bf16 v[52:55], v[208:211], a[180:183], v[52:55]
    buffer_load_dwordx4 v[40:43], v3, s[8:11], s32 offen offset:1024 sc1
    v_mfma_f32_16x16x32_bf16 v[56:59], v[208:211], a[184:187], v[56:59]
    ds_read_b64_tr_b16 v[202:203], v245 offset:29184
    v_mfma_f32_16x16x32_bf16 v[60:63], v[208:211], a[188:191], v[60:63]
    s_waitcnt lgkmcnt(8)
    v_mfma_f32_16x16x32_bf16 v[92:95], v[212:215], a[188:191], v[92:95]
    ds_read_b64_tr_b16 v[204:205], v252 offset:28672
    v_mfma_f32_16x16x32_bf16 v[88:91], v[212:215], a[184:187], v[88:91]
    v_mfma_f32_16x16x32_bf16 v[84:87], v[212:215], a[180:183], v[84:87]
    ds_read_b64_tr_b16 v[206:207], v252 offset:29184
    v_mfma_f32_16x16x32_bf16 v[80:83], v[212:215], a[176:179], v[80:83]
    s_waitcnt lgkmcnt(8)
    v_mfma_f32_16x16x32_bf16 v[112:115], v[216:219], a[176:179], v[112:115]
    ds_read_b64_tr_b16 v[208:209], v0 offset:28672
    v_mfma_f32_16x16x32_bf16 v[116:119], v[216:219], a[180:183], v[116:119]
    buffer_load_dwordx4 v[44:47], v4, s[8:11], s32 offen offset:1024 sc1
    v_mfma_f32_16x16x32_bf16 v[120:123], v[216:219], a[184:187], v[120:123]
    ds_read_b64_tr_b16 v[210:211], v0 offset:29184
    s_add_u32 m0, s72, 0
    s_add_u32 s28, s73, 0
    buffer_load_dwordx4 v249, s[68:71], s28 offen nt lds
    v_mfma_f32_16x16x32_bf16 v[124:127], v[216:219], a[188:191], v[124:127]
    s_waitcnt lgkmcnt(8)
    v_mfma_f32_16x16x32_bf16 v[156:159], v[192:195], a[188:191], v[156:159]
    s_waitcnt vmcnt(45)
    s_barrier
    ds_read_b64_tr_b16 v[212:213], v231 offset:32768
    v_mfma_f32_16x16x32_bf16 v[152:155], v[192:195], a[184:187], v[152:155]
    s_add_u32 m0, s72, 1024
    s_add_u32 s28, s73, 9216
    buffer_load_dwordx4 v249, s[68:71], s28 offen nt lds
    v_mfma_f32_16x16x32_bf16 v[148:151], v[192:195], a[180:183], v[148:151]
    ds_read_b64_tr_b16 v[214:215], v231 offset:33280
    s_add_u32 m0, s72, 2048
    s_add_u32 s28, s73, 18432
    buffer_load_dwordx4 v249, s[68:71], s28 offen nt lds
    v_mfma_f32_16x16x32_bf16 v[144:147], v[192:195], a[176:179], v[144:147]
    s_waitcnt lgkmcnt(8)
    v_mfma_f32_16x16x32_bf16 v[64:67], v[196:199], a[176:179], v[64:67]
    ds_read_b64_tr_b16 v[216:217], v245 offset:32768
    v_mfma_f32_16x16x32_bf16 v[68:71], v[196:199], a[180:183], v[68:71]
    s_add_u32 m0, s72, 3072
    s_add_u32 s28, s73, 27648
    buffer_load_dwordx4 v249, s[68:71], s28 offen nt lds
    v_mfma_f32_16x16x32_bf16 v[72:75], v[196:199], a[184:187], v[72:75]
    ds_read_b64_tr_b16 v[218:219], v245 offset:33280
    s_add_u32 m0, s72, 4096
    s_add_u32 s28, s76, 0
    buffer_load_dwordx4 v249, s[68:71], s28 offen nt lds
    v_mfma_f32_16x16x32_bf16 v[76:79], v[196:199], a[188:191], v[76:79]
    s_waitcnt lgkmcnt(8)
    v_mfma_f32_16x16x32_bf16 v[108:111], v[200:203], a[188:191], v[108:111]
    ds_read_b64_tr_b16 v[192:193], v252 offset:32768
    v_mfma_f32_16x16x32_bf16 v[104:107], v[200:203], a[184:187], v[104:107]
    s_add_u32 m0, s72, 5120
    s_add_u32 s28, s76, 9216
    buffer_load_dwordx4 v249, s[68:71], s28 offen nt lds
    v_mfma_f32_16x16x32_bf16 v[100:103], v[200:203], a[180:183], v[100:103]
    ds_read_b64_tr_b16 v[194:195], v252 offset:33280
    s_add_u32 m0, s72, 6144
    s_add_u32 s28, s76, 18432
    buffer_load_dwordx4 v249, s[68:71], s28 offen nt lds
    v_mfma_f32_16x16x32_bf16 v[96:99], v[200:203], a[176:179], v[96:99]
    s_waitcnt lgkmcnt(8)
    v_mfma_f32_16x16x32_bf16 v[128:131], v[204:207], a[176:179], v[128:131]
    ds_read_b64_tr_b16 v[196:197], v0 offset:32768
    v_mfma_f32_16x16x32_bf16 v[132:135], v[204:207], a[180:183], v[132:135]
    s_add_u32 m0, s72, 7168
    s_add_u32 s28, s76, 27648
    buffer_load_dwordx4 v249, s[68:71], s28 offen nt lds
    v_mfma_f32_16x16x32_bf16 v[136:139], v[204:207], a[184:187], v[136:139]
    ds_read_b64_tr_b16 v[198:199], v0 offset:33280
    v_mfma_f32_16x16x32_bf16 v[140:143], v[204:207], a[188:191], v[140:143]
    s_waitcnt lgkmcnt(8)
    v_mfma_f32_16x16x32_bf16 v[172:175], v[208:211], a[188:191], v[172:175]
    ds_read_b64_tr_b16 v[200:201], v231 offset:36864
    v_mfma_f32_16x16x32_bf16 v[168:171], v[208:211], a[184:187], v[168:171]
    v_mfma_f32_16x16x32_bf16 v[164:167], v[208:211], a[180:183], v[164:167]
    ds_read_b64_tr_b16 v[202:203], v231 offset:37376
    v_mfma_f32_16x16x32_bf16 v[160:163], v[208:211], a[176:179], v[160:163]
    s_waitcnt vmcnt(37)
    s_waitcnt lgkmcnt(8)
    v_mfma_f32_16x16x32_bf16 v[48:51], v[212:215], a[192:195], v[48:51]
    ds_read_b64_tr_b16 v[204:205], v245 offset:36864
    v_mfma_f32_16x16x32_bf16 v[52:55], v[212:215], a[196:199], v[52:55]
    v_mfma_f32_16x16x32_bf16 v[56:59], v[212:215], a[200:203], v[56:59]
    ds_read_b64_tr_b16 v[206:207], v245 offset:37376
    v_mfma_f32_16x16x32_bf16 v[60:63], v[212:215], a[204:207], v[60:63]
    s_waitcnt lgkmcnt(8)
    v_mfma_f32_16x16x32_bf16 v[92:95], v[216:219], a[204:207], v[92:95]
    ds_read_b64_tr_b16 v[208:209], v252 offset:36864
    v_mfma_f32_16x16x32_bf16 v[88:91], v[216:219], a[200:203], v[88:91]
    v_mfma_f32_16x16x32_bf16 v[84:87], v[216:219], a[196:199], v[84:87]
    ds_read_b64_tr_b16 v[210:211], v252 offset:37376
    v_mfma_f32_16x16x32_bf16 v[80:83], v[216:219], a[192:195], v[80:83]
    s_waitcnt lgkmcnt(8)
    v_mfma_f32_16x16x32_bf16 v[112:115], v[192:195], a[192:195], v[112:115]
    ds_read_b64_tr_b16 v[212:213], v0 offset:36864
    v_mfma_f32_16x16x32_bf16 v[116:119], v[192:195], a[196:199], v[116:119]
    v_mfma_f32_16x16x32_bf16 v[120:123], v[192:195], a[200:203], v[120:123]
    ds_read_b64_tr_b16 v[214:215], v0 offset:37376
    v_mfma_f32_16x16x32_bf16 v[124:127], v[192:195], a[204:207], v[124:127]
    s_waitcnt lgkmcnt(8)
    v_mfma_f32_16x16x32_bf16 v[156:159], v[196:199], a[204:207], v[156:159]
    ds_read_b64_tr_b16 v[216:217], v231 offset:40960
    v_mfma_f32_16x16x32_bf16 v[152:155], v[196:199], a[200:203], v[152:155]
    v_mfma_f32_16x16x32_bf16 v[148:151], v[196:199], a[196:199], v[148:151]
    ds_read_b64_tr_b16 v[218:219], v231 offset:41472
    v_mfma_f32_16x16x32_bf16 v[144:147], v[196:199], a[192:195], v[144:147]
    s_waitcnt lgkmcnt(8)
    v_mfma_f32_16x16x32_bf16 v[64:67], v[200:203], a[192:195], v[64:67]
    ds_read_b64_tr_b16 v[192:193], v245 offset:40960
    v_mfma_f32_16x16x32_bf16 v[68:71], v[200:203], a[196:199], v[68:71]
    v_mfma_f32_16x16x32_bf16 v[72:75], v[200:203], a[200:203], v[72:75]
    ds_read_b64_tr_b16 v[194:195], v245 offset:41472
    v_mfma_f32_16x16x32_bf16 v[76:79], v[200:203], a[204:207], v[76:79]
    s_waitcnt lgkmcnt(8)
    v_mfma_f32_16x16x32_bf16 v[108:111], v[204:207], a[204:207], v[108:111]
    ds_read_b64_tr_b16 v[196:197], v252 offset:40960
    v_mfma_f32_16x16x32_bf16 v[104:107], v[204:207], a[200:203], v[104:107]
    v_mfma_f32_16x16x32_bf16 v[100:103], v[204:207], a[196:199], v[100:103]
    ds_read_b64_tr_b16 v[198:199], v252 offset:41472
    v_mfma_f32_16x16x32_bf16 v[96:99], v[204:207], a[192:195], v[96:99]
    s_waitcnt lgkmcnt(8)
    v_mfma_f32_16x16x32_bf16 v[128:131], v[208:211], a[192:195], v[128:131]
    ds_read_b64_tr_b16 v[200:201], v0 offset:40960
    v_mfma_f32_16x16x32_bf16 v[132:135], v[208:211], a[196:199], v[132:135]
    v_mfma_f32_16x16x32_bf16 v[136:139], v[208:211], a[200:203], v[136:139]
    ds_read_b64_tr_b16 v[202:203], v0 offset:41472
    v_mfma_f32_16x16x32_bf16 v[140:143], v[208:211], a[204:207], v[140:143]
    s_waitcnt lgkmcnt(8)
    v_mfma_f32_16x16x32_bf16 v[172:175], v[212:215], a[204:207], v[172:175]
    ds_read_b64_tr_b16 v[204:205], v231 offset:45056
    v_mfma_f32_16x16x32_bf16 v[168:171], v[212:215], a[200:203], v[168:171]
    v_mfma_f32_16x16x32_bf16 v[164:167], v[212:215], a[196:199], v[164:167]
    ds_read_b64_tr_b16 v[206:207], v231 offset:45568
    v_mfma_f32_16x16x32_bf16 v[160:163], v[212:215], a[192:195], v[160:163]
    s_waitcnt vmcnt(30)
    s_waitcnt lgkmcnt(8)
    v_mfma_f32_16x16x32_bf16 v[48:51], v[216:219], a[208:211], v[48:51]
    ds_read_b64_tr_b16 v[208:209], v245 offset:45056
    v_mfma_f32_16x16x32_bf16 v[52:55], v[216:219], a[212:215], v[52:55]
    v_mfma_f32_16x16x32_bf16 v[56:59], v[216:219], a[216:219], v[56:59]
    ds_read_b64_tr_b16 v[210:211], v245 offset:45568
    v_mfma_f32_16x16x32_bf16 v[60:63], v[216:219], a[220:223], v[60:63]
    s_waitcnt lgkmcnt(8)
    v_mfma_f32_16x16x32_bf16 v[92:95], v[192:195], a[220:223], v[92:95]
    ds_read_b64_tr_b16 v[212:213], v252 offset:45056
    v_mfma_f32_16x16x32_bf16 v[88:91], v[192:195], a[216:219], v[88:91]
    v_mfma_f32_16x16x32_bf16 v[84:87], v[192:195], a[212:215], v[84:87]
    ds_read_b64_tr_b16 v[214:215], v252 offset:45568
    v_mfma_f32_16x16x32_bf16 v[80:83], v[192:195], a[208:211], v[80:83]
    s_waitcnt lgkmcnt(8)
    v_mfma_f32_16x16x32_bf16 v[112:115], v[196:199], a[208:211], v[112:115]
    ds_read_b64_tr_b16 v[216:217], v0 offset:45056
    v_mfma_f32_16x16x32_bf16 v[116:119], v[196:199], a[212:215], v[116:119]
    v_mfma_f32_16x16x32_bf16 v[120:123], v[196:199], a[216:219], v[120:123]
    ds_read_b64_tr_b16 v[218:219], v0 offset:45568
    v_mfma_f32_16x16x32_bf16 v[124:127], v[196:199], a[220:223], v[124:127]
    s_waitcnt lgkmcnt(8)
    v_mfma_f32_16x16x32_bf16 v[156:159], v[200:203], a[220:223], v[156:159]
    s_waitcnt vmcnt(40)
    s_barrier
    ds_read_b64_tr_b16 v[192:193], v231 offset:49152
    v_mfma_f32_16x16x32_bf16 v[152:155], v[200:203], a[216:219], v[152:155]
    v_mfma_f32_16x16x32_bf16 v[148:151], v[200:203], a[212:215], v[148:151]
    ds_read_b64_tr_b16 v[194:195], v231 offset:49664
    v_mfma_f32_16x16x32_bf16 v[144:147], v[200:203], a[208:211], v[144:147]
    s_waitcnt lgkmcnt(8)
    v_mfma_f32_16x16x32_bf16 v[64:67], v[204:207], a[208:211], v[64:67]
    ds_read_b64_tr_b16 v[196:197], v245 offset:49152
    v_mfma_f32_16x16x32_bf16 v[68:71], v[204:207], a[212:215], v[68:71]
    v_mfma_f32_16x16x32_bf16 v[72:75], v[204:207], a[216:219], v[72:75]
    ds_read_b64_tr_b16 v[198:199], v245 offset:49664
    v_mfma_f32_16x16x32_bf16 v[76:79], v[204:207], a[220:223], v[76:79]
    s_waitcnt lgkmcnt(8)
    v_mfma_f32_16x16x32_bf16 v[108:111], v[208:211], a[220:223], v[108:111]
    ds_read_b64_tr_b16 v[200:201], v252 offset:49152
    v_mfma_f32_16x16x32_bf16 v[104:107], v[208:211], a[216:219], v[104:107]
    v_mfma_f32_16x16x32_bf16 v[100:103], v[208:211], a[212:215], v[100:103]
    ds_read_b64_tr_b16 v[202:203], v252 offset:49664
    v_mfma_f32_16x16x32_bf16 v[96:99], v[208:211], a[208:211], v[96:99]
    s_waitcnt lgkmcnt(8)
    v_mfma_f32_16x16x32_bf16 v[128:131], v[212:215], a[208:211], v[128:131]
    ds_read_b64_tr_b16 v[204:205], v0 offset:49152
    v_mfma_f32_16x16x32_bf16 v[132:135], v[212:215], a[212:215], v[132:135]
    v_mfma_f32_16x16x32_bf16 v[136:139], v[212:215], a[216:219], v[136:139]
    ds_read_b64_tr_b16 v[206:207], v0 offset:49664
    v_mfma_f32_16x16x32_bf16 v[140:143], v[212:215], a[220:223], v[140:143]
    s_waitcnt lgkmcnt(8)
    v_mfma_f32_16x16x32_bf16 v[172:175], v[216:219], a[220:223], v[172:175]
    ds_read_b64_tr_b16 v[208:209], v231 offset:53248
    v_mfma_f32_16x16x32_bf16 v[168:171], v[216:219], a[216:219], v[168:171]
    v_mfma_f32_16x16x32_bf16 v[164:167], v[216:219], a[212:215], v[164:167]
    ds_read_b64_tr_b16 v[210:211], v231 offset:53760
    v_mfma_f32_16x16x32_bf16 v[160:163], v[216:219], a[208:211], v[160:163]
    s_waitcnt vmcnt(25)
    s_waitcnt lgkmcnt(8)
    v_mfma_f32_16x16x32_bf16 v[48:51], v[192:195], a[224:227], v[48:51]
    ds_read_b64_tr_b16 v[212:213], v245 offset:53248
    v_mfma_f32_16x16x32_bf16 v[52:55], v[192:195], a[228:231], v[52:55]
    v_mfma_f32_16x16x32_bf16 v[56:59], v[192:195], a[232:235], v[56:59]
    ds_read_b64_tr_b16 v[214:215], v245 offset:53760
    v_mfma_f32_16x16x32_bf16 v[60:63], v[192:195], a[236:239], v[60:63]
    s_waitcnt lgkmcnt(8)
    v_mfma_f32_16x16x32_bf16 v[92:95], v[196:199], a[236:239], v[92:95]
    ds_read_b64_tr_b16 v[216:217], v252 offset:53248
    v_mfma_f32_16x16x32_bf16 v[88:91], v[196:199], a[232:235], v[88:91]
    v_mfma_f32_16x16x32_bf16 v[84:87], v[196:199], a[228:231], v[84:87]
    ds_read_b64_tr_b16 v[218:219], v252 offset:53760
    v_mfma_f32_16x16x32_bf16 v[80:83], v[196:199], a[224:227], v[80:83]
    s_waitcnt lgkmcnt(8)
    v_mfma_f32_16x16x32_bf16 v[112:115], v[200:203], a[224:227], v[112:115]
    ds_read_b64_tr_b16 v[192:193], v0 offset:53248
    s_add_u32 m0, s38, 36864
    v_mfma_f32_16x16x32_bf16 v[116:119], v[200:203], a[228:231], v[116:119]
    s_add_u32 s28, s34, 20480
    buffer_load_dwordx4 v6, s[24:27], s28 offen lds
    v_mfma_f32_16x16x32_bf16 v[120:123], v[200:203], a[232:235], v[120:123]
    ds_read_b64_tr_b16 v[194:195], v0 offset:53760
    v_mfma_f32_16x16x32_bf16 v[124:127], v[200:203], a[236:239], v[124:127]
    s_waitcnt lgkmcnt(8)
    v_mfma_f32_16x16x32_bf16 v[156:159], v[204:207], a[236:239], v[156:159]
    ds_read_b64_tr_b16 v[196:197], v231 offset:57344
    v_mfma_f32_16x16x32_bf16 v[152:155], v[204:207], a[232:235], v[152:155]
    v_mfma_f32_16x16x32_bf16 v[148:151], v[204:207], a[228:231], v[148:151]
    ds_read_b64_tr_b16 v[198:199], v231 offset:57856
    v_mfma_f32_16x16x32_bf16 v[144:147], v[204:207], a[224:227], v[144:147]
    s_waitcnt lgkmcnt(8)
    v_mfma_f32_16x16x32_bf16 v[64:67], v[208:211], a[224:227], v[64:67]
    ds_read_b64_tr_b16 v[200:201], v245 offset:57344
    v_mfma_f32_16x16x32_bf16 v[68:71], v[208:211], a[228:231], v[68:71]
    v_mfma_f32_16x16x32_bf16 v[72:75], v[208:211], a[232:235], v[72:75]
    ds_read_b64_tr_b16 v[202:203], v245 offset:57856
    v_mfma_f32_16x16x32_bf16 v[76:79], v[208:211], a[236:239], v[76:79]
    s_waitcnt lgkmcnt(8)
    v_mfma_f32_16x16x32_bf16 v[108:111], v[212:215], a[236:239], v[108:111]
    ds_read_b64_tr_b16 v[204:205], v252 offset:57344
    s_add_u32 m0, s38, 40960
    v_mfma_f32_16x16x32_bf16 v[104:107], v[212:215], a[232:235], v[104:107]
    s_add_u32 s28, s34, 24576
    buffer_load_dwordx4 v6, s[24:27], s28 offen lds
    v_mfma_f32_16x16x32_bf16 v[100:103], v[212:215], a[228:231], v[100:103]
    ds_read_b64_tr_b16 v[206:207], v252 offset:57856
    v_mfma_f32_16x16x32_bf16 v[96:99], v[212:215], a[224:227], v[96:99]
    s_waitcnt lgkmcnt(8)
    v_mfma_f32_16x16x32_bf16 v[128:131], v[216:219], a[224:227], v[128:131]
    ds_read_b64_tr_b16 v[208:209], v0 offset:57344
    v_mfma_f32_16x16x32_bf16 v[132:135], v[216:219], a[228:231], v[132:135]
    v_mfma_f32_16x16x32_bf16 v[136:139], v[216:219], a[232:235], v[136:139]
    ds_read_b64_tr_b16 v[210:211], v0 offset:57856
    v_mfma_f32_16x16x32_bf16 v[140:143], v[216:219], a[236:239], v[140:143]
    s_waitcnt lgkmcnt(8)
    v_mfma_f32_16x16x32_bf16 v[172:175], v[192:195], a[236:239], v[172:175]
    ds_read_b64_tr_b16 v[212:213], v231 offset:61440
    v_mfma_f32_16x16x32_bf16 v[168:171], v[192:195], a[232:235], v[168:171]
    v_mfma_f32_16x16x32_bf16 v[164:167], v[192:195], a[228:231], v[164:167]
    ds_read_b64_tr_b16 v[214:215], v231 offset:61952
    v_mfma_f32_16x16x32_bf16 v[160:163], v[192:195], a[224:227], v[160:163]
    s_waitcnt vmcnt(21)
    s_waitcnt lgkmcnt(8)
    v_mfma_f32_16x16x32_bf16 v[48:51], v[196:199], a[240:243], v[48:51]
    ds_read_b64_tr_b16 v[216:217], v245 offset:61440
    s_add_u32 m0, s38, 45056
    v_mfma_f32_16x16x32_bf16 v[52:55], v[196:199], a[244:247], v[52:55]
    s_add_u32 s28, s34, 28672
    buffer_load_dwordx4 v6, s[24:27], s28 offen lds
    v_mfma_f32_16x16x32_bf16 v[56:59], v[196:199], a[248:251], v[56:59]
    ds_read_b64_tr_b16 v[218:219], v245 offset:61952
    v_mfma_f32_16x16x32_bf16 v[60:63], v[196:199], a[252:255], v[60:63]
    s_waitcnt lgkmcnt(8)
    v_mfma_f32_16x16x32_bf16 v[92:95], v[200:203], a[252:255], v[92:95]
    ds_read_b64_tr_b16 v[192:193], v252 offset:61440
    v_mfma_f32_16x16x32_bf16 v[88:91], v[200:203], a[248:251], v[88:91]
    v_mfma_f32_16x16x32_bf16 v[84:87], v[200:203], a[244:247], v[84:87]
    ds_read_b64_tr_b16 v[194:195], v252 offset:61952
    v_mfma_f32_16x16x32_bf16 v[80:83], v[200:203], a[240:243], v[80:83]
    s_waitcnt lgkmcnt(8)
    v_mfma_f32_16x16x32_bf16 v[112:115], v[204:207], a[240:243], v[112:115]
    ds_read_b64_tr_b16 v[196:197], v0 offset:61440
    v_mfma_f32_16x16x32_bf16 v[116:119], v[204:207], a[244:247], v[116:119]
    v_mfma_f32_16x16x32_bf16 v[120:123], v[204:207], a[248:251], v[120:123]
    ds_read_b64_tr_b16 v[198:199], v0 offset:61952
    v_mfma_f32_16x16x32_bf16 v[124:127], v[204:207], a[252:255], v[124:127]
    s_waitcnt lgkmcnt(8)
    v_mfma_f32_16x16x32_bf16 v[156:159], v[208:211], a[252:255], v[156:159]
    s_waitcnt vmcnt(31)
    s_barrier
    ds_read_b64_tr_b16 v[200:201], v220 offset:0
    s_add_u32 m0, s38, 49152
    v_mfma_f32_16x16x32_bf16 v[152:155], v[208:211], a[248:251], v[152:155]
    s_add_u32 s28, s34, 32768
    buffer_load_dwordx4 v6, s[24:27], s28 offen lds
    v_mfma_f32_16x16x32_bf16 v[148:151], v[208:211], a[244:247], v[148:151]
    ds_read_b64_tr_b16 v[202:203], v220 offset:512
    v_mfma_f32_16x16x32_bf16 v[144:147], v[208:211], a[240:243], v[144:147]
    s_waitcnt lgkmcnt(8)
    v_mfma_f32_16x16x32_bf16 v[64:67], v[212:215], a[240:243], v[64:67]
    ds_read_b64_tr_b16 v[204:205], v220 offset:4096
    v_mfma_f32_16x16x32_bf16 v[68:71], v[212:215], a[244:247], v[68:71]
    v_mfma_f32_16x16x32_bf16 v[72:75], v[212:215], a[248:251], v[72:75]
    ds_read_b64_tr_b16 v[206:207], v220 offset:4608
    v_mfma_f32_16x16x32_bf16 v[76:79], v[212:215], a[252:255], v[76:79]
    s_waitcnt lgkmcnt(8)
    v_mfma_f32_16x16x32_bf16 v[108:111], v[216:219], a[252:255], v[108:111]
    ds_read_b64_tr_b16 v[208:209], v220 offset:8192
    v_mfma_f32_16x16x32_bf16 v[104:107], v[216:219], a[248:251], v[104:107]
    v_mfma_f32_16x16x32_bf16 v[100:103], v[216:219], a[244:247], v[100:103]
    ds_read_b64_tr_b16 v[210:211], v220 offset:8704
    v_mfma_f32_16x16x32_bf16 v[96:99], v[216:219], a[240:243], v[96:99]
    s_waitcnt lgkmcnt(8)
    v_mfma_f32_16x16x32_bf16 v[128:131], v[192:195], a[240:243], v[128:131]
    ds_read_b64_tr_b16 v[212:213], v220 offset:12288
    s_add_u32 m0, s38, 53248
    v_mfma_f32_16x16x32_bf16 v[132:135], v[192:195], a[244:247], v[132:135]
    s_add_u32 s28, s33, 4096
    buffer_load_dwordx4 v5, s[12:15], s28 offen lds
    v_mfma_f32_16x16x32_bf16 v[136:139], v[192:195], a[248:251], v[136:139]
    ds_read_b64_tr_b16 v[214:215], v220 offset:12800
    v_mfma_f32_16x16x32_bf16 v[140:143], v[192:195], a[252:255], v[140:143]
    s_waitcnt lgkmcnt(8)
    v_mfma_f32_16x16x32_bf16 v[172:175], v[196:199], a[252:255], v[172:175]
    ds_read_b64_tr_b16 v[216:217], v221 offset:0
    v_mfma_f32_16x16x32_bf16 v[168:171], v[196:199], a[248:251], v[168:171]
    v_mfma_f32_16x16x32_bf16 v[164:167], v[196:199], a[244:247], v[164:167]
    ds_read_b64_tr_b16 v[218:219], v221 offset:512
    v_mfma_f32_16x16x32_bf16 v[160:163], v[196:199], a[240:243], v[160:163]
    s_waitcnt vmcnt(17)
    s_waitcnt lgkmcnt(8)
    v_mfma_f32_16x16x32_bf16 v[48:51], v[200:203], v[16:19], v[48:51]
    ds_read_b64_tr_b16 v[192:193], v221 offset:4096
    v_mfma_f32_16x16x32_bf16 v[52:55], v[200:203], v[20:23], v[52:55]
    v_mfma_f32_16x16x32_bf16 v[56:59], v[200:203], v[24:27], v[56:59]
    ds_read_b64_tr_b16 v[194:195], v221 offset:4608
    v_mfma_f32_16x16x32_bf16 v[60:63], v[200:203], v[28:31], v[60:63]
    s_waitcnt lgkmcnt(8)
    v_mfma_f32_16x16x32_bf16 v[76:79], v[204:207], v[28:31], v[76:79]
    ds_read_b64_tr_b16 v[196:197], v221 offset:8192
    s_add_u32 m0, s38, 57344
    v_mfma_f32_16x16x32_bf16 v[72:75], v[204:207], v[24:27], v[72:75]
    s_add_u32 s28, s33, 4096
    buffer_load_dwordx4 v5, s[44:47], s28 offen lds
    v_mfma_f32_16x16x32_bf16 v[68:71], v[204:207], v[20:23], v[68:71]
    ds_read_b64_tr_b16 v[198:199], v221 offset:8704
    v_mfma_f32_16x16x32_bf16 v[64:67], v[204:207], v[16:19], v[64:67]
    s_waitcnt vmcnt(14)
    s_waitcnt vmcnt(6)
    s_waitcnt lgkmcnt(8)
    v_mfma_f32_16x16x32_bf16 v[48:51], v[208:211], v[32:35], v[48:51]
    ds_read_b64_tr_b16 v[200:201], v221 offset:12288
    v_xor_b32 v230, 0, v229
    v_mfma_f32_16x16x32_bf16 v[52:55], v[208:211], v[36:39], v[52:55]
    ds_read_b64_tr_b16 v[176:177], v230 offset:0
    ds_read_b64_tr_b16 v[178:179], v230 offset:2048
    v_mfma_f32_16x16x32_bf16 v[56:59], v[208:211], v[40:43], v[56:59]
    ds_read_b64_tr_b16 v[202:203], v221 offset:12800
    v_xor_b32 v230, 32, v229
    v_mfma_f32_16x16x32_bf16 v[60:63], v[208:211], v[44:47], v[60:63]
    ds_read_b64_tr_b16 v[180:181], v230 offset:0
    s_waitcnt lgkmcnt(11)
    v_mfma_f32_16x16x32_bf16 v[76:79], v[212:215], v[44:47], v[76:79]
    ds_read_b64_tr_b16 v[204:205], v222 offset:0
    ds_read_b64_tr_b16 v[182:183], v230 offset:2048
    v_mfma_f32_16x16x32_bf16 v[72:75], v[212:215], v[40:43], v[72:75]
    v_xor_b32 v230, 64, v229
    ds_read_b64_tr_b16 v[184:185], v230 offset:0
    v_mfma_f32_16x16x32_bf16 v[68:71], v[212:215], v[36:39], v[68:71]
    ds_read_b64_tr_b16 v[206:207], v222 offset:512
    ds_read_b64_tr_b16 v[186:187], v230 offset:2048
    v_mfma_f32_16x16x32_bf16 v[64:67], v[212:215], v[32:35], v[64:67]
    v_xor_b32 v230, 96, v229
    s_waitcnt lgkmcnt(14)
    v_mfma_f32_16x16x32_bf16 v[80:83], v[216:219], v[16:19], v[80:83]
    ds_read_b64_tr_b16 v[208:209], v222 offset:4096
    s_add_u32 m0, s38, 61440
    v_mfma_f32_16x16x32_bf16 v[84:87], v[216:219], v[20:23], v[84:87]
    s_add_u32 s28, s33, 299008
    buffer_load_dwordx4 v5, s[12:15], s28 offen lds
    v_mfma_f32_16x16x32_bf16 v[88:91], v[216:219], v[24:27], v[88:91]
    ds_read_b64_tr_b16 v[210:211], v222 offset:4608
    ds_read_b64_tr_b16 v[188:189], v230 offset:0
    v_mfma_f32_16x16x32_bf16 v[92:95], v[216:219], v[28:31], v[92:95]
    ds_read_b64_tr_b16 v[190:191], v230 offset:2048
    s_waitcnt lgkmcnt(15)
    v_mfma_f32_16x16x32_bf16 v[108:111], v[192:195], v[28:31], v[108:111]
    ds_read_b64_tr_b16 v[212:213], v222 offset:8192
    s_waitcnt lgkmcnt(12)
    v_mfma_f32_16x16x32_bf16 v[104:107], v[192:195], v[24:27], v[104:107]
    buffer_store_dwordx4 v[176:179], v1, s[24:27], s77 offen sc1
    s_waitcnt lgkmcnt(8)
    v_mfma_f32_16x16x32_bf16 v[100:103], v[192:195], v[20:23], v[100:103]
    ds_read_b64_tr_b16 v[214:215], v222 offset:8704
    v_mfma_f32_16x16x32_bf16 v[96:99], v[192:195], v[16:19], v[96:99]
    s_waitcnt lgkmcnt(15)
    v_mfma_f32_16x16x32_bf16 v[80:83], v[196:199], v[32:35], v[80:83]
    ds_read_b64_tr_b16 v[216:217], v222 offset:12288
    v_mfma_f32_16x16x32_bf16 v[84:87], v[196:199], v[36:39], v[84:87]
    v_mfma_f32_16x16x32_bf16 v[88:91], v[196:199], v[40:43], v[88:91]
    ds_read_b64_tr_b16 v[218:219], v222 offset:12800
    v_mfma_f32_16x16x32_bf16 v[92:95], v[196:199], v[44:47], v[92:95]
    s_waitcnt lgkmcnt(14)
    v_mfma_f32_16x16x32_bf16 v[108:111], v[200:203], v[44:47], v[108:111]
    ds_read_b64_tr_b16 v[192:193], v223 offset:0
    s_add_u32 m0, s38, 65536
    v_mfma_f32_16x16x32_bf16 v[104:107], v[200:203], v[40:43], v[104:107]
    s_add_u32 s28, s33, 299008
    buffer_load_dwordx4 v5, s[44:47], s28 offen lds
    v_mfma_f32_16x16x32_bf16 v[100:103], v[200:203], v[36:39], v[100:103]
    ds_read_b64_tr_b16 v[194:195], v223 offset:512
    buffer_store_dwordx4 v[180:183], v1, s[24:27], s57 offen sc1
    v_mfma_f32_16x16x32_bf16 v[96:99], v[200:203], v[32:35], v[96:99]
    s_waitcnt lgkmcnt(10)
    s_waitcnt lgkmcnt(11)
    v_mfma_f32_16x16x32_bf16 v[112:115], v[204:207], v[16:19], v[112:115]
    ds_read_b64_tr_b16 v[196:197], v223 offset:4096
    v_mfma_f32_16x16x32_bf16 v[116:119], v[204:207], v[20:23], v[116:119]
    v_mfma_f32_16x16x32_bf16 v[120:123], v[204:207], v[24:27], v[120:123]
    ds_read_b64_tr_b16 v[198:199], v223 offset:4608
    v_mfma_f32_16x16x32_bf16 v[124:127], v[204:207], v[28:31], v[124:127]
    s_waitcnt lgkmcnt(10)
    v_mfma_f32_16x16x32_bf16 v[140:143], v[208:211], v[28:31], v[140:143]
    ds_read_b64_tr_b16 v[200:201], v223 offset:8192
    buffer_store_dwordx4 v[184:187], v1, s[24:27], s58 offen sc1
    v_mfma_f32_16x16x32_bf16 v[136:139], v[208:211], v[24:27], v[136:139]
    s_waitcnt lgkmcnt(9)
    v_mfma_f32_16x16x32_bf16 v[132:135], v[208:211], v[20:23], v[132:135]
    ds_read_b64_tr_b16 v[202:203], v223 offset:8704
    v_mfma_f32_16x16x32_bf16 v[128:131], v[208:211], v[16:19], v[128:131]
    s_waitcnt lgkmcnt(8)
    v_mfma_f32_16x16x32_bf16 v[112:115], v[212:215], v[32:35], v[112:115]
    ds_read_b64_tr_b16 v[204:205], v223 offset:12288
    s_add_u32 m0, s38, 69632
    v_mfma_f32_16x16x32_bf16 v[116:119], v[212:215], v[36:39], v[116:119]
    s_add_u32 s28, s33, 593920
    buffer_load_dwordx4 v5, s[12:15], s28 offen lds
    v_mfma_f32_16x16x32_bf16 v[120:123], v[212:215], v[40:43], v[120:123]
    ds_read_b64_tr_b16 v[206:207], v223 offset:12800
    v_mfma_f32_16x16x32_bf16 v[124:127], v[212:215], v[44:47], v[124:127]
    s_waitcnt lgkmcnt(8)
    v_mfma_f32_16x16x32_bf16 v[140:143], v[216:219], v[44:47], v[140:143]
    s_waitcnt vmcnt(25)
    s_barrier
    ds_read_b128 v[208:211], v1 offset:16384
    buffer_store_dwordx4 v[188:191], v1, s[24:27], s39 offen sc1
    v_mfma_f32_16x16x32_bf16 v[136:139], v[216:219], v[40:43], v[136:139]
    v_xor_b32 v230, 0, v229
    ds_read_b64_tr_b16 v[176:177], v230 offset:4096
    v_mfma_f32_16x16x32_bf16 v[132:135], v[216:219], v[36:39], v[132:135]
    ds_read_b64_tr_b16 v[178:179], v230 offset:6144
    v_xor_b32 v230, 32, v229
    v_mfma_f32_16x16x32_bf16 v[128:131], v[216:219], v[32:35], v[128:131]
    ds_read_b64_tr_b16 v[180:181], v230 offset:4096
    s_waitcnt lgkmcnt(10)
    v_mfma_f32_16x16x32_bf16 v[144:147], v[192:195], v[16:19], v[144:147]
    ds_read_b128 v[212:215], v1 offset:17408
    ds_read_b64_tr_b16 v[182:183], v230 offset:6144
    v_mfma_f32_16x16x32_bf16 v[148:151], v[192:195], v[20:23], v[148:151]
    v_xor_b32 v230, 64, v229
    ds_read_b64_tr_b16 v[184:185], v230 offset:4096
    v_mfma_f32_16x16x32_bf16 v[152:155], v[192:195], v[24:27], v[152:155]
    ds_read_b64_tr_b16 v[186:187], v230 offset:6144
    v_xor_b32 v230, 96, v229
    v_mfma_f32_16x16x32_bf16 v[156:159], v[192:195], v[28:31], v[156:159]
    ds_read_b64_tr_b16 v[188:189], v230 offset:4096
    s_waitcnt lgkmcnt(13)
    v_mfma_f32_16x16x32_bf16 v[172:175], v[196:199], v[28:31], v[172:175]
    ds_read_b128 v[216:219], v1 offset:18432
    s_add_u32 m0, s38, 73728
    v_mfma_f32_16x16x32_bf16 v[168:171], v[196:199], v[24:27], v[168:171]
    s_add_u32 s28, s33, 593920
    buffer_load_dwordx4 v5, s[44:47], s28 offen lds
    v_mfma_f32_16x16x32_bf16 v[164:167], v[196:199], v[20:23], v[164:167]
    ds_read_b64_tr_b16 v[190:191], v230 offset:6144
    s_waitcnt lgkmcnt(8)
    v_mfma_f32_16x16x32_bf16 v[160:163], v[196:199], v[16:19], v[160:163]
    buffer_store_dwordx4 v[176:179], v1, s[24:27], s42 offen sc1
    s_waitcnt lgkmcnt(13)
    v_mfma_f32_16x16x32_bf16 v[144:147], v[200:203], v[32:35], v[144:147]
    ds_read_b128 v[192:195], v1 offset:19456
    s_waitcnt lgkmcnt(6)
    v_mfma_f32_16x16x32_bf16 v[148:151], v[200:203], v[36:39], v[148:151]
    v_mfma_f32_16x16x32_bf16 v[152:155], v[200:203], v[40:43], v[152:155]
    v_mfma_f32_16x16x32_bf16 v[156:159], v[200:203], v[44:47], v[156:159]
    s_waitcnt lgkmcnt(12)
    v_mfma_f32_16x16x32_bf16 v[172:175], v[204:207], v[44:47], v[172:175]
    ds_read_b128 v[196:199], v1 offset:20480
    buffer_store_dwordx4 v[180:183], v1, s[24:27], s43 offen sc1
    v_mfma_f32_16x16x32_bf16 v[168:171], v[204:207], v[40:43], v[168:171]
    s_waitcnt lgkmcnt(5)
    v_mfma_f32_16x16x32_bf16 v[164:167], v[204:207], v[36:39], v[164:167]
    v_mfma_f32_16x16x32_bf16 v[160:163], v[204:207], v[32:35], v[160:163]
    buffer_store_dwordx4 v[184:187], v1, s[24:27], s5 offen sc1
    s_waitcnt lgkmcnt(2)
    buffer_store_dwordx4 v[188:191], v1, s[24:27], s7 offen sc1
    v_max_f32 v232, 0, v48
    v_max_f32 v233, 0, v49
    v_max_f32 v234, 0, v50
    v_max_f32 v235, 0, v51
    v_mul_f32 v232, v232, v64
    v_mul_f32 v233, v233, v65
    v_mul_f32 v234, v234, v66
    v_mul_f32 v235, v235, v67
    v_cvt_pk_bf16_f32 v176, v232, v233
    v_cvt_pk_bf16_f32 v177, v234, v235
    v_max_f32 v232, 0, v52
    v_max_f32 v233, 0, v53
    v_max_f32 v234, 0, v54
    v_max_f32 v235, 0, v55
    v_mul_f32 v232, v232, v68
    v_mul_f32 v233, v233, v69
    v_mul_f32 v234, v234, v70
    v_mul_f32 v235, v235, v71
    v_cvt_pk_bf16_f32 v180, v232, v233
    v_cvt_pk_bf16_f32 v181, v234, v235
    v_max_f32 v232, 0, v56
    v_max_f32 v233, 0, v57
    v_max_f32 v234, 0, v58
    v_max_f32 v235, 0, v59
    v_mul_f32 v232, v232, v72
    v_mul_f32 v233, v233, v73
    v_mul_f32 v234, v234, v74
    v_mul_f32 v235, v235, v75
    v_cvt_pk_bf16_f32 v184, v232, v233
    v_cvt_pk_bf16_f32 v185, v234, v235
    v_max_f32 v232, 0, v60
    v_max_f32 v233, 0, v61
    v_max_f32 v234, 0, v62
    v_max_f32 v235, 0, v63
    v_mul_f32 v232, v232, v76
    v_mul_f32 v233, v233, v77
    v_mul_f32 v234, v234, v78
    v_mul_f32 v235, v235, v79
    v_cvt_pk_bf16_f32 v188, v232, v233
    v_cvt_pk_bf16_f32 v189, v234, v235
    s_waitcnt lgkmcnt(12)
    v_mfma_f32_16x16x32_bf16 v[48:51], v[208:211], a[0:3], 0
    ds_read_b128 v[200:203], v1 offset:21504
    s_add_u32 m0, s38, 77824
    v_mfma_f32_16x16x32_bf16 v[52:55], v[208:211], a[4:7], 0
    s_add_u32 s28, s33, 888832
    buffer_load_dwordx4 v5, s[12:15], s28 offen lds
    v_mfma_f32_16x16x32_bf16 v[56:59], v[208:211], a[8:11], 0
    v_max_f32 v232, 0, v80
    v_max_f32 v233, 0, v81
    v_mfma_f32_16x16x32_bf16 v[60:63], v[208:211], a[12:15], 0
    v_max_f32 v234, 0, v82
    s_waitcnt lgkmcnt(9)
    v_mfma_f32_16x16x32_bf16 v[76:79], v[212:215], a[12:15], 0
    ds_read_b128 v[204:207], v1 offset:22528
    v_max_f32 v235, 0, v83
    v_mfma_f32_16x16x32_bf16 v[72:75], v[212:215], a[8:11], 0
    v_mul_f32 v232, v232, v96
    v_mul_f32 v233, v233, v97
    v_mfma_f32_16x16x32_bf16 v[68:71], v[212:215], a[4:7], 0
    v_mul_f32 v234, v234, v98
    v_mul_f32 v235, v235, v99
    v_mfma_f32_16x16x32_bf16 v[64:67], v[212:215], a[0:3], 0
    v_cvt_pk_bf16_f32 v178, v232, v233
    s_waitcnt lgkmcnt(5)
    v_mfma_f32_16x16x32_bf16 v[48:51], v[216:219], a[16:19], v[48:51]
    ds_read_b128 v[208:211], v1 offset:23552
    v_cvt_pk_bf16_f32 v179, v234, v235
    v_mfma_f32_16x16x32_bf16 v[52:55], v[216:219], a[20:23], v[52:55]
    buffer_store_dwordx4 v[176:179], v9, s[16:19], 0 offen offset:0 sc1
    v_max_f32 v232, 0, v84
    v_mfma_f32_16x16x32_bf16 v[56:59], v[216:219], a[24:27], v[56:59]
    v_max_f32 v233, 0, v85
    v_max_f32 v234, 0, v86
    v_mfma_f32_16x16x32_bf16 v[60:63], v[216:219], a[28:31], v[60:63]
    v_max_f32 v235, 0, v87
    s_waitcnt lgkmcnt(4)
    v_mfma_f32_16x16x32_bf16 v[76:79], v[192:195], a[28:31], v[76:79]
    ds_read_b128 v[212:215], v1 offset:24576
    s_add_u32 m0, s38, 81920
    v_mfma_f32_16x16x32_bf16 v[72:75], v[192:195], a[24:27], v[72:75]
    s_add_u32 s28, s33, 888832
    buffer_load_dwordx4 v5, s[44:47], s28 offen lds
    v_mfma_f32_16x16x32_bf16 v[68:71], v[192:195], a[20:23], v[68:71]
    v_mul_f32 v232, v232, v100
    v_mul_f32 v233, v233, v101
    v_mfma_f32_16x16x32_bf16 v[64:67], v[192:195], a[16:19], v[64:67]
    v_mul_f32 v234, v234, v102
    s_waitcnt lgkmcnt(4)
    v_mfma_f32_16x16x32_bf16 v[48:51], v[196:199], a[32:35], v[48:51]
    ds_read_b128 v[216:219], v1 offset:25600
    v_mul_f32 v235, v235, v103
    v_mfma_f32_16x16x32_bf16 v[52:55], v[196:199], a[36:39], v[52:55]
    v_cvt_pk_bf16_f32 v182, v232, v233
    v_cvt_pk_bf16_f32 v183, v234, v235
    v_mfma_f32_16x16x32_bf16 v[56:59], v[196:199], a[40:43], v[56:59]
    buffer_store_dwordx4 v[180:183], v10, s[16:19], 0 offen offset:0 sc1
    v_max_f32 v232, 0, v88
    v_mfma_f32_16x16x32_bf16 v[60:63], v[196:199], a[44:47], v[60:63]
    v_max_f32 v233, 0, v89
    s_waitcnt lgkmcnt(4)
    v_mfma_f32_16x16x32_bf16 v[76:79], v[200:203], a[44:47], v[76:79]
    ds_read_b128 v[192:195], v1 offset:26624
    v_max_f32 v234, 0, v90
    v_mfma_f32_16x16x32_bf16 v[72:75], v[200:203], a[40:43], v[72:75]
    v_max_f32 v235, 0, v91
    v_mul_f32 v232, v232, v104
    v_mfma_f32_16x16x32_bf16 v[68:71], v[200:203], a[36:39], v[68:71]
    v_mul_f32 v233, v233, v105
    v_mul_f32 v234, v234, v106
    v_mfma_f32_16x16x32_bf16 v[64:67], v[200:203], a[32:35], v[64:67]
    v_mul_f32 v235, v235, v107
    s_waitcnt lgkmcnt(4)
    v_mfma_f32_16x16x32_bf16 v[48:51], v[204:207], a[48:51], v[48:51]
    ds_read_b128 v[196:199], v1 offset:27648
    s_add_u32 m0, s38, 86016
    v_mfma_f32_16x16x32_bf16 v[52:55], v[204:207], a[52:55], v[52:55]
    s_add_u32 s28, s33, 1183744
    buffer_load_dwordx4 v5, s[12:15], s28 offen lds
    v_mfma_f32_16x16x32_bf16 v[56:59], v[204:207], a[56:59], v[56:59]
    v_cvt_pk_bf16_f32 v186, v232, v233
    v_cvt_pk_bf16_f32 v187, v234, v235
    v_mfma_f32_16x16x32_bf16 v[60:63], v[204:207], a[60:63], v[60:63]
    buffer_store_dwordx4 v[184:187], v11, s[16:19], 0 offen offset:0 sc1
    s_waitcnt lgkmcnt(4)
    v_mfma_f32_16x16x32_bf16 v[76:79], v[208:211], a[60:63], v[76:79]
    ds_read_b128 v[200:203], v1 offset:28672
    v_max_f32 v232, 0, v92
    v_mfma_f32_16x16x32_bf16 v[72:75], v[208:211], a[56:59], v[72:75]
    v_max_f32 v233, 0, v93
    v_max_f32 v234, 0, v94
    v_mfma_f32_16x16x32_bf16 v[68:71], v[208:211], a[52:55], v[68:71]
    v_max_f32 v235, 0, v95
    v_mul_f32 v232, v232, v108
    v_mfma_f32_16x16x32_bf16 v[64:67], v[208:211], a[48:51], v[64:67]
    v_mul_f32 v233, v233, v109
    s_waitcnt lgkmcnt(4)
    v_mfma_f32_16x16x32_bf16 v[48:51], v[212:215], a[64:67], v[48:51]
    ds_read_b128 v[204:207], v1 offset:29696
    v_mul_f32 v234, v234, v110
    v_mfma_f32_16x16x32_bf16 v[52:55], v[212:215], a[68:71], v[52:55]
    v_mul_f32 v235, v235, v111
    v_cvt_pk_bf16_f32 v190, v232, v233
    v_mfma_f32_16x16x32_bf16 v[56:59], v[212:215], a[72:75], v[56:59]
    v_cvt_pk_bf16_f32 v191, v234, v235
    buffer_store_dwordx4 v[188:191], v12, s[16:19], 0 offen offset:0 sc1
    v_mfma_f32_16x16x32_bf16 v[60:63], v[212:215], a[76:79], v[60:63]
    v_max_f32 v232, 0, v112
    s_waitcnt lgkmcnt(4)
    v_mfma_f32_16x16x32_bf16 v[76:79], v[216:219], a[76:79], v[76:79]
    ds_read_b128 v[208:211], v1 offset:30720
    s_add_u32 m0, s38, 90112
    v_mfma_f32_16x16x32_bf16 v[72:75], v[216:219], a[72:75], v[72:75]
    s_add_u32 s28, s33, 1183744
    buffer_load_dwordx4 v5, s[44:47], s28 offen lds
    v_mfma_f32_16x16x32_bf16 v[68:71], v[216:219], a[68:71], v[68:71]
    v_max_f32 v233, 0, v113
    v_max_f32 v234, 0, v114
    v_mfma_f32_16x16x32_bf16 v[64:67], v[216:219], a[64:67], v[64:67]
    v_max_f32 v235, 0, v115
    s_waitcnt lgkmcnt(4)
    v_mfma_f32_16x16x32_bf16 v[48:51], v[192:195], a[80:83], v[48:51]
    ds_read_b128 v[212:215], v1 offset:31744
    v_mul_f32 v232, v232, v128
    v_mfma_f32_16x16x32_bf16 v[52:55], v[192:195], a[84:87], v[52:55]
    v_mul_f32 v233, v233, v129
    v_mul_f32 v234, v234, v130
    v_mfma_f32_16x16x32_bf16 v[56:59], v[192:195], a[88:91], v[56:59]
    v_mul_f32 v235, v235, v131
    v_cvt_pk_bf16_f32 v176, v232, v233
    v_mfma_f32_16x16x32_bf16 v[60:63], v[192:195], a[92:95], v[60:63]
    v_cvt_pk_bf16_f32 v177, v234, v235
    s_waitcnt lgkmcnt(4)
    v_mfma_f32_16x16x32_bf16 v[76:79], v[196:199], a[92:95], v[76:79]
    ds_read_b128 v[216:219], v1 offset:32768
    v_max_f32 v232, 0, v116
    v_mfma_f32_16x16x32_bf16 v[72:75], v[196:199], a[88:91], v[72:75]
    v_max_f32 v233, 0, v117
    v_max_f32 v234, 0, v118
    v_mfma_f32_16x16x32_bf16 v[68:71], v[196:199], a[84:87], v[68:71]
    v_max_f32 v235, 0, v119
    v_mul_f32 v232, v232, v132
    v_mfma_f32_16x16x32_bf16 v[64:67], v[196:199], a[80:83], v[64:67]
    v_mul_f32 v233, v233, v133
    s_waitcnt lgkmcnt(4)
    v_mfma_f32_16x16x32_bf16 v[48:51], v[200:203], a[96:99], v[48:51]
    ds_read_b128 v[192:195], v1 offset:33792
    s_add_u32 m0, s38, 94208
    v_mfma_f32_16x16x32_bf16 v[52:55], v[200:203], a[100:103], v[52:55]
    s_add_u32 s28, s33, 1478656
    buffer_load_dwordx4 v5, s[12:15], s28 offen lds
    v_mfma_f32_16x16x32_bf16 v[56:59], v[200:203], a[104:107], v[56:59]
    v_mul_f32 v234, v234, v134
    v_mul_f32 v235, v235, v135
    v_mfma_f32_16x16x32_bf16 v[60:63], v[200:203], a[108:111], v[60:63]
    v_cvt_pk_bf16_f32 v180, v232, v233
    s_waitcnt lgkmcnt(4)
    v_mfma_f32_16x16x32_bf16 v[76:79], v[204:207], a[108:111], v[76:79]
    ds_read_b128 v[196:199], v1 offset:34816
    v_cvt_pk_bf16_f32 v181, v234, v235
    v_mfma_f32_16x16x32_bf16 v[72:75], v[204:207], a[104:107], v[72:75]
    v_max_f32 v232, 0, v120
    v_max_f32 v233, 0, v121
    v_mfma_f32_16x16x32_bf16 v[68:71], v[204:207], a[100:103], v[68:71]
    v_max_f32 v234, 0, v122
    v_max_f32 v235, 0, v123
    v_mfma_f32_16x16x32_bf16 v[64:67], v[204:207], a[96:99], v[64:67]
    v_mul_f32 v232, v232, v136
    s_waitcnt lgkmcnt(4)
    v_mfma_f32_16x16x32_bf16 v[48:51], v[208:211], a[112:115], v[48:51]
    ds_read_b128 v[200:203], v1 offset:35840
    v_mul_f32 v233, v233, v137
    v_mfma_f32_16x16x32_bf16 v[52:55], v[208:211], a[116:119], v[52:55]
    v_mul_f32 v234, v234, v138
    v_mul_f32 v235, v235, v139
    v_mfma_f32_16x16x32_bf16 v[56:59], v[208:211], a[120:123], v[56:59]
    v_cvt_pk_bf16_f32 v184, v232, v233
    v_cvt_pk_bf16_f32 v185, v234, v235
    v_mfma_f32_16x16x32_bf16 v[60:63], v[208:211], a[124:127], v[60:63]
    v_max_f32 v232, 0, v124
    s_waitcnt lgkmcnt(4)
    v_mfma_f32_16x16x32_bf16 v[76:79], v[212:215], a[124:127], v[76:79]
    s_waitcnt vmcnt(23)
    s_barrier
    ds_read_b128 v[204:207], v1 offset:36864
    s_add_u32 m0, s38, 98304
    v_mfma_f32_16x16x32_bf16 v[72:75], v[212:215], a[120:123], v[72:75]
    s_add_u32 s28, s33, 1478656
    buffer_load_dwordx4 v5, s[44:47], s28 offen lds
    v_mfma_f32_16x16x32_bf16 v[68:71], v[212:215], a[116:119], v[68:71]
    v_max_f32 v233, 0, v125
    v_max_f32 v234, 0, v126
    v_mfma_f32_16x16x32_bf16 v[64:67], v[212:215], a[112:115], v[64:67]
    v_max_f32 v235, 0, v127
    s_waitcnt lgkmcnt(4)
    v_mfma_f32_16x16x32_bf16 v[48:51], v[216:219], a[128:131], v[48:51]
    ds_read_b128 v[208:211], v1 offset:37888
    v_mul_f32 v232, v232, v140
    v_mfma_f32_16x16x32_bf16 v[52:55], v[216:219], a[132:135], v[52:55]
    v_mul_f32 v233, v233, v141
    v_mul_f32 v234, v234, v142
    v_mfma_f32_16x16x32_bf16 v[56:59], v[216:219], a[136:139], v[56:59]
    v_mul_f32 v235, v235, v143
    v_cvt_pk_bf16_f32 v188, v232, v233
    v_mfma_f32_16x16x32_bf16 v[60:63], v[216:219], a[140:143], v[60:63]
    v_cvt_pk_bf16_f32 v189, v234, v235
    s_waitcnt lgkmcnt(4)
    v_mfma_f32_16x16x32_bf16 v[76:79], v[192:195], a[140:143], v[76:79]
    ds_read_b128 v[212:215], v1 offset:38912
    v_max_f32 v232, 0, v144
    v_mfma_f32_16x16x32_bf16 v[72:75], v[192:195], a[136:139], v[72:75]
    v_max_f32 v233, 0, v145
    v_max_f32 v234, 0, v146
    v_mfma_f32_16x16x32_bf16 v[68:71], v[192:195], a[132:135], v[68:71]
    v_max_f32 v235, 0, v147
    v_mul_f32 v232, v232, v160
    v_mfma_f32_16x16x32_bf16 v[64:67], v[192:195], a[128:131], v[64:67]
    v_mul_f32 v233, v233, v161
    s_waitcnt lgkmcnt(4)
    v_mfma_f32_16x16x32_bf16 v[48:51], v[196:199], a[144:147], v[48:51]
    ds_read_b128 v[216:219], v1 offset:39936
    s_add_u32 m0, s38, 102400
    v_mfma_f32_16x16x32_bf16 v[52:55], v[196:199], a[148:151], v[52:55]
    s_add_u32 s28, s33, 1773568
    buffer_load_dwordx4 v5, s[12:15], s28 offen lds
    v_mfma_f32_16x16x32_bf16 v[56:59], v[196:199], a[152:155], v[56:59]
    v_mul_f32 v234, v234, v162
    v_mul_f32 v235, v235, v163
    v_mfma_f32_16x16x32_bf16 v[60:63], v[196:199], a[156:159], v[60:63]
    v_cvt_pk_bf16_f32 v178, v232, v233
    s_waitcnt lgkmcnt(4)
    v_mfma_f32_16x16x32_bf16 v[76:79], v[200:203], a[156:159], v[76:79]
    ds_read_b128 v[192:195], v1 offset:40960
    v_cvt_pk_bf16_f32 v179, v234, v235
    v_mfma_f32_16x16x32_bf16 v[72:75], v[200:203], a[152:155], v[72:75]
    buffer_store_dwordx4 v[176:179], v9, s[16:19], 0 offen offset:1024 sc1
    v_max_f32 v232, 0, v148
    v_mfma_f32_16x16x32_bf16 v[68:71], v[200:203], a[148:151], v[68:71]
    v_max_f32 v233, 0, v149
    v_max_f32 v234, 0, v150
    v_mfma_f32_16x16x32_bf16 v[64:67], v[200:203], a[144:147], v[64:67]
    v_max_f32 v235, 0, v151
    s_waitcnt lgkmcnt(4)
    v_mfma_f32_16x16x32_bf16 v[48:51], v[204:207], a[160:163], v[48:51]
    ds_read_b128 v[196:199], v1 offset:41984
    v_mul_f32 v232, v232, v164
    v_mfma_f32_16x16x32_bf16 v[52:55], v[204:207], a[164:167], v[52:55]
    v_mul_f32 v233, v233, v165
    v_mul_f32 v234, v234, v166
    v_mfma_f32_16x16x32_bf16 v[56:59], v[204:207], a[168:171], v[56:59]
    v_mul_f32 v235, v235, v167
    v_cvt_pk_bf16_f32 v182, v232, v233
    v_mfma_f32_16x16x32_bf16 v[60:63], v[204:207], a[172:175], v[60:63]
    v_cvt_pk_bf16_f32 v183, v234, v235
    s_waitcnt lgkmcnt(4)
    v_mfma_f32_16x16x32_bf16 v[76:79], v[208:211], a[172:175], v[76:79]
    ds_read_b128 v[200:203], v1 offset:43008
    s_add_u32 m0, s38, 106496
    v_mfma_f32_16x16x32_bf16 v[72:75], v[208:211], a[168:171], v[72:75]
    s_add_u32 s28, s33, 1773568
    buffer_load_dwordx4 v5, s[44:47], s28 offen lds
    v_mfma_f32_16x16x32_bf16 v[68:71], v[208:211], a[164:167], v[68:71]
    buffer_store_dwordx4 v[180:183], v10, s[16:19], 0 offen offset:1024 sc1
    v_max_f32 v232, 0, v152
    v_mfma_f32_16x16x32_bf16 v[64:67], v[208:211], a[160:163], v[64:67]
    v_max_f32 v233, 0, v153
    s_waitcnt lgkmcnt(4)
    v_mfma_f32_16x16x32_bf16 v[48:51], v[212:215], a[176:179], v[48:51]
    ds_read_b128 v[204:207], v1 offset:44032
    v_max_f32 v234, 0, v154
    v_mfma_f32_16x16x32_bf16 v[52:55], v[212:215], a[180:183], v[52:55]
    v_max_f32 v235, 0, v155
    v_mul_f32 v232, v232, v168
    v_mfma_f32_16x16x32_bf16 v[56:59], v[212:215], a[184:187], v[56:59]
    v_mul_f32 v233, v233, v169
    v_mul_f32 v234, v234, v170
    v_mfma_f32_16x16x32_bf16 v[60:63], v[212:215], a[188:191], v[60:63]
    v_mul_f32 v235, v235, v171
    s_waitcnt lgkmcnt(4)
    v_mfma_f32_16x16x32_bf16 v[76:79], v[216:219], a[188:191], v[76:79]
    ds_read_b128 v[208:211], v1 offset:45056
    v_cvt_pk_bf16_f32 v186, v232, v233
    v_mfma_f32_16x16x32_bf16 v[72:75], v[216:219], a[184:187], v[72:75]
    v_cvt_pk_bf16_f32 v187, v234, v235
    buffer_store_dwordx4 v[184:187], v11, s[16:19], 0 offen offset:1024 sc1
    v_mfma_f32_16x16x32_bf16 v[68:71], v[216:219], a[180:183], v[68:71]
    v_max_f32 v232, 0, v156
    v_max_f32 v233, 0, v157
    v_mfma_f32_16x16x32_bf16 v[64:67], v[216:219], a[176:179], v[64:67]
    v_max_f32 v234, 0, v158
    s_waitcnt lgkmcnt(4)
    v_mfma_f32_16x16x32_bf16 v[48:51], v[192:195], a[192:195], v[48:51]
    ds_read_b128 v[212:215], v1 offset:46080
    s_add_u32 m0, s38, 110592
    v_mfma_f32_16x16x32_bf16 v[52:55], v[192:195], a[196:199], v[52:55]
    s_add_u32 s28, s33, 2068480
    buffer_load_dwordx4 v5, s[12:15], s28 offen lds
    v_mfma_f32_16x16x32_bf16 v[56:59], v[192:195], a[200:203], v[56:59]
    v_max_f32 v235, 0, v159
    v_mul_f32 v232, v232, v172
    v_mfma_f32_16x16x32_bf16 v[60:63], v[192:195], a[204:207], v[60:63]
    v_mul_f32 v233, v233, v173
    s_waitcnt lgkmcnt(4)
    v_mfma_f32_16x16x32_bf16 v[76:79], v[196:199], a[204:207], v[76:79]
    ds_read_b128 v[216:219], v1 offset:47104
    v_mul_f32 v234, v234, v174
    v_mfma_f32_16x16x32_bf16 v[72:75], v[196:199], a[200:203], v[72:75]
    v_mul_f32 v235, v235, v175
    v_cvt_pk_bf16_f32 v190, v232, v233
    v_mfma_f32_16x16x32_bf16 v[68:71], v[196:199], a[196:199], v[68:71]
    v_cvt_pk_bf16_f32 v191, v234, v235
    buffer_store_dwordx4 v[188:191], v12, s[16:19], 0 offen offset:1024 sc1
    v_mfma_f32_16x16x32_bf16 v[64:67], v[196:199], a[192:195], v[64:67]
    s_waitcnt lgkmcnt(4)
    v_mfma_f32_16x16x32_bf16 v[48:51], v[200:203], a[208:211], v[48:51]
    ds_read_b128 v[192:195], v1 offset:48128
    v_mfma_f32_16x16x32_bf16 v[52:55], v[200:203], a[212:215], v[52:55]
    v_mfma_f32_16x16x32_bf16 v[56:59], v[200:203], a[216:219], v[56:59]
    v_mfma_f32_16x16x32_bf16 v[60:63], v[200:203], a[220:223], v[60:63]
    s_waitcnt lgkmcnt(4)
    v_mfma_f32_16x16x32_bf16 v[76:79], v[204:207], a[220:223], v[76:79]
    ds_read_b128 v[196:199], v7 offset:0
    s_add_u32 m0, s38, 114688
    v_mfma_f32_16x16x32_bf16 v[72:75], v[204:207], a[216:219], v[72:75]
    s_add_u32 s28, s33, 2068480
    buffer_load_dwordx4 v5, s[44:47], s28 offen lds
    v_mfma_f32_16x16x32_bf16 v[68:71], v[204:207], a[212:215], v[68:71]
    v_mfma_f32_16x16x32_bf16 v[64:67], v[204:207], a[208:211], v[64:67]
    s_waitcnt lgkmcnt(4)
    v_mfma_f32_16x16x32_bf16 v[48:51], v[208:211], a[224:227], v[48:51]
    ds_read_b128 v[200:203], v7 offset:1024
    v_mfma_f32_16x16x32_bf16 v[52:55], v[208:211], a[228:231], v[52:55]
    v_mfma_f32_16x16x32_bf16 v[56:59], v[208:211], a[232:235], v[56:59]
    v_mfma_f32_16x16x32_bf16 v[60:63], v[208:211], a[236:239], v[60:63]
    s_waitcnt lgkmcnt(4)
    v_mfma_f32_16x16x32_bf16 v[76:79], v[212:215], a[236:239], v[76:79]
    ds_read_b128 v[204:207], v7 offset:2048
    v_mfma_f32_16x16x32_bf16 v[72:75], v[212:215], a[232:235], v[72:75]
    v_mfma_f32_16x16x32_bf16 v[68:71], v[212:215], a[228:231], v[68:71]
    v_mfma_f32_16x16x32_bf16 v[64:67], v[212:215], a[224:227], v[64:67]
    s_waitcnt lgkmcnt(4)
    v_mfma_f32_16x16x32_bf16 v[48:51], v[216:219], a[240:243], v[48:51]
    ds_read_b128 v[208:211], v7 offset:3072
    s_add_u32 m0, s38, 118784
    v_mfma_f32_16x16x32_bf16 v[52:55], v[216:219], a[244:247], v[52:55]
    s_add_u32 s28, s33, 2363392
    buffer_load_dwordx4 v5, s[12:15], s28 offen lds
    v_mfma_f32_16x16x32_bf16 v[56:59], v[216:219], a[248:251], v[56:59]
    v_mfma_f32_16x16x32_bf16 v[60:63], v[216:219], a[252:255], v[60:63]
    s_waitcnt lgkmcnt(4)
    v_mfma_f32_16x16x32_bf16 v[76:79], v[192:195], a[252:255], v[76:79]
    s_waitcnt vmcnt(19)
    s_barrier
    v_add_u32 v240, s53, v240
    v_mov_b32 v254, s64
    s_mov_b64 exec, 1
    global_store_dword v240, v254, s[78:79] sc1
    s_mov_b64 exec, -1
    ds_read_b64_tr_b16 v[212:213], v220 offset:53248
    v_mfma_f32_16x16x32_bf16 v[72:75], v[192:195], a[248:251], v[72:75]
    v_mfma_f32_16x16x32_bf16 v[68:71], v[192:195], a[244:247], v[68:71]
    ds_read_b64_tr_b16 v[214:215], v220 offset:53760
    v_mfma_f32_16x16x32_bf16 v[64:67], v[192:195], a[240:243], v[64:67]
    s_waitcnt lgkmcnt(5)
    v_mfma_f32_16x16x32_bf16 v[48:51], v[196:199], v[16:19], v[48:51]
    ds_read_b64_tr_b16 v[216:217], v221 offset:53248
    v_mfma_f32_16x16x32_bf16 v[52:55], v[196:199], v[20:23], v[52:55]
    v_mfma_f32_16x16x32_bf16 v[56:59], v[196:199], v[24:27], v[56:59]
    ds_read_b64_tr_b16 v[218:219], v221 offset:53760
    v_mfma_f32_16x16x32_bf16 v[60:63], v[196:199], v[28:31], v[60:63]
    s_waitcnt lgkmcnt(6)
    v_mfma_f32_16x16x32_bf16 v[76:79], v[200:203], v[28:31], v[76:79]
    ds_read_b64_tr_b16 v[192:193], v222 offset:53248
    s_add_u32 m0, s38, 122880
    v_mfma_f32_16x16x32_bf16 v[72:75], v[200:203], v[24:27], v[72:75]
    s_add_u32 s28, s33, 2363392
    buffer_load_dwordx4 v5, s[44:47], s28 offen lds
    v_mfma_f32_16x16x32_bf16 v[68:71], v[200:203], v[20:23], v[68:71]
    ds_read_b64_tr_b16 v[194:195], v222 offset:53760
    v_mfma_f32_16x16x32_bf16 v[64:67], v[200:203], v[16:19], v[64:67]
    s_waitcnt lgkmcnt(7)
    v_mfma_f32_16x16x32_bf16 v[48:51], v[204:207], v[32:35], v[48:51]
    ds_read_b64_tr_b16 v[196:197], v220 offset:57344
    v_mfma_f32_16x16x32_bf16 v[52:55], v[204:207], v[36:39], v[52:55]
    v_mfma_f32_16x16x32_bf16 v[56:59], v[204:207], v[40:43], v[56:59]
    ds_read_b64_tr_b16 v[198:199], v220 offset:57856
    v_mfma_f32_16x16x32_bf16 v[60:63], v[204:207], v[44:47], v[60:63]
    s_waitcnt lgkmcnt(8)
    v_mfma_f32_16x16x32_bf16 v[76:79], v[208:211], v[44:47], v[76:79]
    ds_read_b64_tr_b16 v[200:201], v221 offset:57344
    v_mfma_f32_16x16x32_bf16 v[72:75], v[208:211], v[40:43], v[72:75]
    v_mfma_f32_16x16x32_bf16 v[68:71], v[208:211], v[36:39], v[68:71]
    ds_read_b64_tr_b16 v[202:203], v221 offset:57856
    v_mfma_f32_16x16x32_bf16 v[64:67], v[208:211], v[32:35], v[64:67]
    s_waitcnt lgkmcnt(8)
    v_mfma_f32_16x16x32_bf16 v[80:83], v[212:215], a[0:3], 0
    ds_read_b64_tr_b16 v[204:205], v222 offset:57344
    s_add_u32 m0, s38, 126976
    v_mfma_f32_16x16x32_bf16 v[84:87], v[212:215], a[4:7], 0
    s_add_u32 s28, s33, 2658304
    buffer_load_dwordx4 v5, s[12:15], s28 offen lds
    v_mfma_f32_16x16x32_bf16 v[88:91], v[212:215], a[8:11], 0
    ds_read_b64_tr_b16 v[206:207], v222 offset:57856
    v_mfma_f32_16x16x32_bf16 v[92:95], v[212:215], a[12:15], 0
    s_waitcnt lgkmcnt(8)
    v_mfma_f32_16x16x32_bf16 v[124:127], v[216:219], a[12:15], 0
    ds_read_b64_tr_b16 v[208:209], v220 offset:61440
    v_max_f32 v232, 0, v48
    v_mfma_f32_16x16x32_bf16 v[120:123], v[216:219], a[8:11], 0
    v_max_f32 v233, 0, v49
    v_max_f32 v234, 0, v50
    v_mfma_f32_16x16x32_bf16 v[116:119], v[216:219], a[4:7], 0
    ds_read_b64_tr_b16 v[210:211], v220 offset:61952
    v_max_f32 v235, 0, v51
    v_mfma_f32_16x16x32_bf16 v[112:115], v[216:219], a[0:3], 0
    v_mul_f32 v232, v232, v64
    s_waitcnt lgkmcnt(8)
    v_mfma_f32_16x16x32_bf16 v[144:147], v[192:195], a[0:3], 0
    ds_read_b64_tr_b16 v[212:213], v221 offset:61440
    v_mul_f32 v233, v233, v65
    v_mfma_f32_16x16x32_bf16 v[148:151], v[192:195], a[4:7], 0
    v_mul_f32 v234, v234, v66
    v_mul_f32 v235, v235, v67
    v_mfma_f32_16x16x32_bf16 v[152:155], v[192:195], a[8:11], 0
    ds_read_b64_tr_b16 v[214:215], v221 offset:61952
    v_cvt_pk_bf16_f32 v176, v232, v233
    v_mfma_f32_16x16x32_bf16 v[156:159], v[192:195], a[12:15], 0
    v_cvt_pk_bf16_f32 v177, v234, v235
    s_waitcnt lgkmcnt(8)
    v_mfma_f32_16x16x32_bf16 v[108:111], v[196:199], a[12:15], 0
    ds_read_b64_tr_b16 v[216:217], v222 offset:61440
    s_add_u32 m0, s38, 0
    v_mfma_f32_16x16x32_bf16 v[104:107], v[196:199], a[8:11], 0
    s_add_u32 s28, s33, 2658304
    buffer_load_dwordx4 v5, s[44:47], s28 offen lds
    v_mfma_f32_16x16x32_bf16 v[100:103], v[196:199], a[4:7], 0
    ds_read_b64_tr_b16 v[218:219], v222 offset:61952
    v_sub_u32 v255, v9, v241
    v_mfma_f32_16x16x32_bf16 v[96:99], v[196:199], a[0:3], 0
    buffer_store_dwordx2 v[176:177], v255, s[16:19], 0 offen sc1
    s_waitcnt lgkmcnt(8)
    v_mfma_f32_16x16x32_bf16 v[128:131], v[200:203], a[0:3], 0
    ds_read_b64_tr_b16 v[192:193], v231 offset:0
    v_max_f32 v232, 0, v52
    v_mfma_f32_16x16x32_bf16 v[132:135], v[200:203], a[4:7], 0
    v_max_f32 v233, 0, v53
    v_max_f32 v234, 0, v54
    v_mfma_f32_16x16x32_bf16 v[136:139], v[200:203], a[8:11], 0
    ds_read_b64_tr_b16 v[194:195], v231 offset:512
    v_max_f32 v235, 0, v55
    v_mfma_f32_16x16x32_bf16 v[140:143], v[200:203], a[12:15], 0
    v_mul_f32 v232, v232, v68
    s_waitcnt lgkmcnt(8)
    v_mfma_f32_16x16x32_bf16 v[172:175], v[204:207], a[12:15], 0
    ds_read_b64_tr_b16 v[196:197], v245 offset:0
    v_mul_f32 v233, v233, v69
    v_mfma_f32_16x16x32_bf16 v[168:171], v[204:207], a[8:11], 0
    v_mul_f32 v234, v234, v70
    v_mul_f32 v235, v235, v71
    v_mfma_f32_16x16x32_bf16 v[164:167], v[204:207], a[4:7], 0
    ds_read_b64_tr_b16 v[198:199], v245 offset:512
    v_cvt_pk_bf16_f32 v180, v232, v233
    v_mfma_f32_16x16x32_bf16 v[160:163], v[204:207], a[0:3], 0
    v_cvt_pk_bf16_f32 v181, v234, v235
    s_waitcnt lgkmcnt(8)
    v_mfma_f32_16x16x32_bf16 v[80:83], v[208:211], a[16:19], v[80:83]
    ds_read_b64_tr_b16 v[200:201], v252 offset:0
    s_add_u32 m0, s38, 4096
    v_mfma_f32_16x16x32_bf16 v[84:87], v[208:211], a[20:23], v[84:87]
    s_add_u32 s28, s33, 2953216
    buffer_load_dwordx4 v5, s[12:15], s28 offen lds
    v_mfma_f32_16x16x32_bf16 v[88:91], v[208:211], a[24:27], v[88:91]
    ds_read_b64_tr_b16 v[202:203], v252 offset:512
    v_sub_u32 v255, v10, v241
    v_mfma_f32_16x16x32_bf16 v[92:95], v[208:211], a[28:31], v[92:95]
    buffer_store_dwordx2 v[180:181], v255, s[16:19], 0 offen sc1
    s_waitcnt lgkmcnt(8)
    v_mfma_f32_16x16x32_bf16 v[124:127], v[212:215], a[28:31], v[124:127]
    ds_read_b64_tr_b16 v[204:205], v223 offset:53248
    v_max_f32 v232, 0, v56
    v_mfma_f32_16x16x32_bf16 v[120:123], v[212:215], a[24:27], v[120:123]
    v_max_f32 v233, 0, v57
    v_max_f32 v234, 0, v58
    v_mfma_f32_16x16x32_bf16 v[116:119], v[212:215], a[20:23], v[116:119]
    ds_read_b64_tr_b16 v[206:207], v223 offset:53760
    v_max_f32 v235, 0, v59
    v_mfma_f32_16x16x32_bf16 v[112:115], v[212:215], a[16:19], v[112:115]
    v_mul_f32 v232, v232, v72
    s_waitcnt lgkmcnt(8)
    v_mfma_f32_16x16x32_bf16 v[144:147], v[216:219], a[16:19], v[144:147]
    ds_read_b64_tr_b16 v[208:209], v223 offset:57344
    v_mul_f32 v233, v233, v73
    v_mfma_f32_16x16x32_bf16 v[148:151], v[216:219], a[20:23], v[148:151]
    v_mul_f32 v234, v234, v74
    v_mul_f32 v235, v235, v75
    v_mfma_f32_16x16x32_bf16 v[152:155], v[216:219], a[24:27], v[152:155]
    ds_read_b64_tr_b16 v[210:211], v223 offset:57856
    v_cvt_pk_bf16_f32 v184, v232, v233
    v_mfma_f32_16x16x32_bf16 v[156:159], v[216:219], a[28:31], v[156:159]
    v_cvt_pk_bf16_f32 v185, v234, v235
    s_waitcnt lgkmcnt(8)
    v_mfma_f32_16x16x32_bf16 v[108:111], v[192:195], a[28:31], v[108:111]
    ds_read_b64_tr_b16 v[212:213], v223 offset:61440
    s_add_u32 m0, s38, 8192
    v_mfma_f32_16x16x32_bf16 v[104:107], v[192:195], a[24:27], v[104:107]
    s_add_u32 s28, s33, 2953216
    buffer_load_dwordx4 v5, s[44:47], s28 offen lds
    v_mfma_f32_16x16x32_bf16 v[100:103], v[192:195], a[20:23], v[100:103]
    ds_read_b64_tr_b16 v[214:215], v223 offset:61952
    v_sub_u32 v255, v11, v241
    v_mfma_f32_16x16x32_bf16 v[96:99], v[192:195], a[16:19], v[96:99]
    buffer_store_dwordx2 v[184:185], v255, s[16:19], 0 offen sc1
    s_waitcnt lgkmcnt(8)
    v_mfma_f32_16x16x32_bf16 v[128:131], v[196:199], a[16:19], v[128:131]
    ds_read_b64_tr_b16 v[216:217], v0 offset:0
    v_max_f32 v232, 0, v60
    v_mfma_f32_16x16x32_bf16 v[132:135], v[196:199], a[20:23], v[132:135]
    v_max_f32 v233, 0, v61
    v_max_f32 v234, 0, v62
    v_mfma_f32_16x16x32_bf16 v[136:139], v[196:199], a[24:27], v[136:139]
    ds_read_b64_tr_b16 v[218:219], v0 offset:512
    v_max_f32 v235, 0, v63
    v_mfma_f32_16x16x32_bf16 v[140:143], v[196:199], a[28:31], v[140:143]
    v_mul_f32 v232, v232, v76
    s_waitcnt lgkmcnt(8)
    v_mfma_f32_16x16x32_bf16 v[172:175], v[200:203], a[28:31], v[172:175]
    s_waitcnt vmcnt(11)
    s_barrier
    v_add_u32 v240, s53, v240
    v_mov_b32 v254, s64
    s_mov_b64 exec, 1
    global_store_dword v240, v254, s[78:79] sc1
    s_mov_b64 exec, -1
    ds_read_b64_tr_b16 v[192:193], v231 offset:4096
    v_mul_f32 v233, v233, v77
    v_mfma_f32_16x16x32_bf16 v[168:171], v[200:203], a[24:27], v[168:171]
    v_mul_f32 v234, v234, v78
    v_mul_f32 v235, v235, v79
    v_mfma_f32_16x16x32_bf16 v[164:167], v[200:203], a[20:23], v[164:167]
    ds_read_b64_tr_b16 v[194:195], v231 offset:4608
    v_cvt_pk_bf16_f32 v188, v232, v233
    v_mfma_f32_16x16x32_bf16 v[160:163], v[200:203], a[16:19], v[160:163]
    v_cvt_pk_bf16_f32 v189, v234, v235
    v_sub_u32 v255, v12, v241
    s_waitcnt lgkmcnt(8)
    v_mfma_f32_16x16x32_bf16 v[48:51], v[204:207], a[0:3], 0
    ds_read_b64_tr_b16 v[196:197], v245 offset:4096
    s_add_u32 m0, s38, 12288
    v_mfma_f32_16x16x32_bf16 v[52:55], v[204:207], a[4:7], 0
    s_add_u32 s28, s33, 3248128
    buffer_load_dwordx4 v5, s[12:15], s28 offen lds
    v_mfma_f32_16x16x32_bf16 v[56:59], v[204:207], a[8:11], 0
    ds_read_b64_tr_b16 v[198:199], v245 offset:4608
    buffer_store_dwordx2 v[188:189], v255, s[16:19], 0 offen sc1
    v_mfma_f32_16x16x32_bf16 v[60:63], v[204:207], a[12:15], 0
    s_waitcnt lgkmcnt(8)
    v_mfma_f32_16x16x32_bf16 v[76:79], v[208:211], a[12:15], 0
    ds_read_b64_tr_b16 v[200:201], v252 offset:4096
    v_mfma_f32_16x16x32_bf16 v[72:75], v[208:211], a[8:11], 0
    v_mfma_f32_16x16x32_bf16 v[68:71], v[208:211], a[4:7], 0
    ds_read_b64_tr_b16 v[202:203], v252 offset:4608
    v_mfma_f32_16x16x32_bf16 v[64:67], v[208:211], a[0:3], 0
    s_waitcnt lgkmcnt(8)
    v_mfma_f32_16x16x32_bf16 v[48:51], v[212:215], a[16:19], v[48:51]
    ds_read_b64_tr_b16 v[204:205], v0 offset:4096
    v_mfma_f32_16x16x32_bf16 v[52:55], v[212:215], a[20:23], v[52:55]
    v_mfma_f32_16x16x32_bf16 v[56:59], v[212:215], a[24:27], v[56:59]
    ds_read_b64_tr_b16 v[206:207], v0 offset:4608
    v_mfma_f32_16x16x32_bf16 v[60:63], v[212:215], a[28:31], v[60:63]
    s_waitcnt lgkmcnt(8)
    v_mfma_f32_16x16x32_bf16 v[76:79], v[216:219], a[28:31], v[76:79]
    ds_read_b64_tr_b16 v[208:209], v231 offset:8192
    s_add_u32 m0, s38, 16384
    v_mfma_f32_16x16x32_bf16 v[72:75], v[216:219], a[24:27], v[72:75]
    s_add_u32 s28, s33, 3248128
    buffer_load_dwordx4 v5, s[44:47], s28 offen lds
    v_mfma_f32_16x16x32_bf16 v[68:71], v[216:219], a[20:23], v[68:71]
    ds_read_b64_tr_b16 v[210:211], v231 offset:8704
    v_mfma_f32_16x16x32_bf16 v[64:67], v[216:219], a[16:19], v[64:67]
    s_waitcnt lgkmcnt(8)
    v_mfma_f32_16x16x32_bf16 v[80:83], v[192:195], a[32:35], v[80:83]
    ds_read_b64_tr_b16 v[212:213], v245 offset:8192
    v_mfma_f32_16x16x32_bf16 v[84:87], v[192:195], a[36:39], v[84:87]
    v_mfma_f32_16x16x32_bf16 v[88:91], v[192:195], a[40:43], v[88:91]
    ds_read_b64_tr_b16 v[214:215], v245 offset:8704
    v_mfma_f32_16x16x32_bf16 v[92:95], v[192:195], a[44:47], v[92:95]
    s_waitcnt lgkmcnt(8)
    v_mfma_f32_16x16x32_bf16 v[124:127], v[196:199], a[44:47], v[124:127]
    ds_read_b64_tr_b16 v[216:217], v252 offset:8192
    v_mfma_f32_16x16x32_bf16 v[120:123], v[196:199], a[40:43], v[120:123]
    v_mfma_f32_16x16x32_bf16 v[116:119], v[196:199], a[36:39], v[116:119]
    ds_read_b64_tr_b16 v[218:219], v252 offset:8704
    v_mfma_f32_16x16x32_bf16 v[112:115], v[196:199], a[32:35], v[112:115]
    s_waitcnt lgkmcnt(8)
    v_mfma_f32_16x16x32_bf16 v[144:147], v[200:203], a[32:35], v[144:147]
    ds_read_b64_tr_b16 v[192:193], v0 offset:8192
    s_add_u32 m0, s38, 20480
    v_mfma_f32_16x16x32_bf16 v[148:151], v[200:203], a[36:39], v[148:151]
    s_add_u32 s28, s33, 3543040
    buffer_load_dwordx4 v5, s[12:15], s28 offen lds
    v_mfma_f32_16x16x32_bf16 v[152:155], v[200:203], a[40:43], v[152:155]
    ds_read_b64_tr_b16 v[194:195], v0 offset:8704
    v_mfma_f32_16x16x32_bf16 v[156:159], v[200:203], a[44:47], v[156:159]
    s_waitcnt lgkmcnt(8)
    v_mfma_f32_16x16x32_bf16 v[60:63], v[204:207], a[44:47], v[60:63]
    ds_read_b64_tr_b16 v[196:197], v231 offset:12288
    v_mfma_f32_16x16x32_bf16 v[56:59], v[204:207], a[40:43], v[56:59]
    v_mfma_f32_16x16x32_bf16 v[52:55], v[204:207], a[36:39], v[52:55]
    ds_read_b64_tr_b16 v[198:199], v231 offset:12800
    v_mfma_f32_16x16x32_bf16 v[48:51], v[204:207], a[32:35], v[48:51]
    s_waitcnt lgkmcnt(8)
    v_mfma_f32_16x16x32_bf16 v[96:99], v[208:211], a[32:35], v[96:99]
    ds_read_b64_tr_b16 v[200:201], v245 offset:12288
    v_mfma_f32_16x16x32_bf16 v[100:103], v[208:211], a[36:39], v[100:103]
    v_mfma_f32_16x16x32_bf16 v[104:107], v[208:211], a[40:43], v[104:107]
    ds_read_b64_tr_b16 v[202:203], v245 offset:12800
    v_mfma_f32_16x16x32_bf16 v[108:111], v[208:211], a[44:47], v[108:111]
    s_waitcnt lgkmcnt(8)
    v_mfma_f32_16x16x32_bf16 v[140:143], v[212:215], a[44:47], v[140:143]
    ds_read_b64_tr_b16 v[204:205], v252 offset:12288
    s_add_u32 m0, s38, 24576
    v_mfma_f32_16x16x32_bf16 v[136:139], v[212:215], a[40:43], v[136:139]
    s_add_u32 s28, s33, 3543040
    buffer_load_dwordx4 v5, s[44:47], s28 offen lds
    v_mfma_f32_16x16x32_bf16 v[132:135], v[212:215], a[36:39], v[132:135]
    ds_read_b64_tr_b16 v[206:207], v252 offset:12800
    v_mfma_f32_16x16x32_bf16 v[128:131], v[212:215], a[32:35], v[128:131]
    s_waitcnt lgkmcnt(8)
    v_mfma_f32_16x16x32_bf16 v[160:163], v[216:219], a[32:35], v[160:163]
    ds_read_b64_tr_b16 v[208:209], v0 offset:12288
    v_mfma_f32_16x16x32_bf16 v[164:167], v[216:219], a[36:39], v[164:167]
    v_mfma_f32_16x16x32_bf16 v[168:171], v[216:219], a[40:43], v[168:171]
    ds_read_b64_tr_b16 v[210:211], v0 offset:12800
    v_mfma_f32_16x16x32_bf16 v[172:175], v[216:219], a[44:47], v[172:175]
    s_waitcnt lgkmcnt(8)
    v_mfma_f32_16x16x32_bf16 v[76:79], v[192:195], a[44:47], v[76:79]
    ds_read_b64_tr_b16 v[212:213], v231 offset:16384
    v_mfma_f32_16x16x32_bf16 v[72:75], v[192:195], a[40:43], v[72:75]
    v_mfma_f32_16x16x32_bf16 v[68:71], v[192:195], a[36:39], v[68:71]
    ds_read_b64_tr_b16 v[214:215], v231 offset:16896
    v_mfma_f32_16x16x32_bf16 v[64:67], v[192:195], a[32:35], v[64:67]
    s_waitcnt lgkmcnt(8)
    v_mfma_f32_16x16x32_bf16 v[80:83], v[196:199], a[48:51], v[80:83]
    ds_read_b64_tr_b16 v[216:217], v245 offset:16384
    s_add_u32 m0, s38, 28672
    v_mfma_f32_16x16x32_bf16 v[84:87], v[196:199], a[52:55], v[84:87]
    s_add_u32 s28, s33, 3837952
    buffer_load_dwordx4 v5, s[12:15], s28 offen lds
    v_mfma_f32_16x16x32_bf16 v[88:91], v[196:199], a[56:59], v[88:91]
    ds_read_b64_tr_b16 v[218:219], v245 offset:16896
    v_mfma_f32_16x16x32_bf16 v[92:95], v[196:199], a[60:63], v[92:95]
    s_waitcnt lgkmcnt(8)
    v_mfma_f32_16x16x32_bf16 v[124:127], v[200:203], a[60:63], v[124:127]
    ds_read_b64_tr_b16 v[192:193], v252 offset:16384
    v_mfma_f32_16x16x32_bf16 v[120:123], v[200:203], a[56:59], v[120:123]
    v_mfma_f32_16x16x32_bf16 v[116:119], v[200:203], a[52:55], v[116:119]
    ds_read_b64_tr_b16 v[194:195], v252 offset:16896
    v_mfma_f32_16x16x32_bf16 v[112:115], v[200:203], a[48:51], v[112:115]
    s_waitcnt lgkmcnt(8)
    v_mfma_f32_16x16x32_bf16 v[144:147], v[204:207], a[48:51], v[144:147]
    ds_read_b64_tr_b16 v[196:197], v0 offset:16384
    v_mfma_f32_16x16x32_bf16 v[148:151], v[204:207], a[52:55], v[148:151]
    v_mfma_f32_16x16x32_bf16 v[152:155], v[204:207], a[56:59], v[152:155]
    ds_read_b64_tr_b16 v[198:199], v0 offset:16896
    v_mfma_f32_16x16x32_bf16 v[156:159], v[204:207], a[60:63], v[156:159]
    s_waitcnt lgkmcnt(8)
    v_mfma_f32_16x16x32_bf16 v[60:63], v[208:211], a[60:63], v[60:63]
    s_waitcnt vmcnt(25)
    s_barrier
    ds_read_b64_tr_b16 v[200:201], v231 offset:20480
    s_add_u32 m0, s38, 32768
    v_mfma_f32_16x16x32_bf16 v[56:59], v[208:211], a[56:59], v[56:59]
    s_add_u32 s28, s33, 3837952
    buffer_load_dwordx4 v5, s[44:47], s28 offen lds
    v_mfma_f32_16x16x32_bf16 v[52:55], v[208:211], a[52:55], v[52:55]
    ds_read_b64_tr_b16 v[202:203], v231 offset:20992
    v_mfma_f32_16x16x32_bf16 v[48:51], v[208:211], a[48:51], v[48:51]
    s_waitcnt lgkmcnt(8)
    v_mfma_f32_16x16x32_bf16 v[96:99], v[212:215], a[48:51], v[96:99]
    ds_read_b64_tr_b16 v[204:205], v245 offset:20480
    v_mfma_f32_16x16x32_bf16 v[100:103], v[212:215], a[52:55], v[100:103]
    v_mfma_f32_16x16x32_bf16 v[104:107], v[212:215], a[56:59], v[104:107]
    ds_read_b64_tr_b16 v[206:207], v245 offset:20992
    v_mfma_f32_16x16x32_bf16 v[108:111], v[212:215], a[60:63], v[108:111]
    s_waitcnt lgkmcnt(8)
    v_mfma_f32_16x16x32_bf16 v[140:143], v[216:219], a[60:63], v[140:143]
    ds_read_b64_tr_b16 v[208:209], v252 offset:20480
    v_mfma_f32_16x16x32_bf16 v[136:139], v[216:219], a[56:59], v[136:139]
    v_mfma_f32_16x16x32_bf16 v[132:135], v[216:219], a[52:55], v[132:135]
    ds_read_b64_tr_b16 v[210:211], v252 offset:20992
    v_mfma_f32_16x16x32_bf16 v[128:131], v[216:219], a[48:51], v[128:131]
    s_waitcnt lgkmcnt(8)
    v_mfma_f32_16x16x32_bf16 v[160:163], v[192:195], a[48:51], v[160:163]
    ds_read_b64_tr_b16 v[212:213], v0 offset:20480
    s_add_u32 m0, s38, 36864
    v_mfma_f32_16x16x32_bf16 v[164:167], v[192:195], a[52:55], v[164:167]
    s_add_u32 s28, s33, 4132864
    buffer_load_dwordx4 v5, s[12:15], s28 offen lds
    v_mfma_f32_16x16x32_bf16 v[168:171], v[192:195], a[56:59], v[168:171]
    ds_read_b64_tr_b16 v[214:215], v0 offset:20992
    v_mfma_f32_16x16x32_bf16 v[172:175], v[192:195], a[60:63], v[172:175]
    s_waitcnt lgkmcnt(8)
    v_mfma_f32_16x16x32_bf16 v[76:79], v[196:199], a[60:63], v[76:79]
    ds_read_b64_tr_b16 v[216:217], v231 offset:24576
    v_mfma_f32_16x16x32_bf16 v[72:75], v[196:199], a[56:59], v[72:75]
    v_mfma_f32_16x16x32_bf16 v[68:71], v[196:199], a[52:55], v[68:71]
    ds_read_b64_tr_b16 v[218:219], v231 offset:25088
    v_mfma_f32_16x16x32_bf16 v[64:67], v[196:199], a[48:51], v[64:67]
    s_mov_b64 exec, -1
    global_load_dword v15, v246, s[78:79] sc1
    s_mov_b64 exec, -1
    s_waitcnt lgkmcnt(8)
    v_mfma_f32_16x16x32_bf16 v[80:83], v[200:203], a[64:67], v[80:83]
    ds_read_b64_tr_b16 v[192:193], v245 offset:24576
    v_mfma_f32_16x16x32_bf16 v[84:87], v[200:203], a[68:71], v[84:87]
    v_mfma_f32_16x16x32_bf16 v[88:91], v[200:203], a[72:75], v[88:91]
    ds_read_b64_tr_b16 v[194:195], v245 offset:25088
    v_mfma_f32_16x16x32_bf16 v[92:95], v[200:203], a[76:79], v[92:95]
    s_waitcnt lgkmcnt(8)
    v_mfma_f32_16x16x32_bf16 v[124:127], v[204:207], a[76:79], v[124:127]
    ds_read_b64_tr_b16 v[196:197], v252 offset:24576
    s_add_u32 m0, s38, 40960
    v_mfma_f32_16x16x32_bf16 v[120:123], v[204:207], a[72:75], v[120:123]
    s_add_u32 s28, s33, 4132864
    buffer_load_dwordx4 v5, s[44:47], s28 offen lds
    v_mfma_f32_16x16x32_bf16 v[116:119], v[204:207], a[68:71], v[116:119]
    ds_read_b64_tr_b16 v[198:199], v252 offset:25088
    v_mfma_f32_16x16x32_bf16 v[112:115], v[204:207], a[64:67], v[112:115]
    s_waitcnt lgkmcnt(8)
    v_mfma_f32_16x16x32_bf16 v[144:147], v[208:211], a[64:67], v[144:147]
    ds_read_b64_tr_b16 v[200:201], v0 offset:24576
    v_mfma_f32_16x16x32_bf16 v[148:151], v[208:211], a[68:71], v[148:151]
    v_mfma_f32_16x16x32_bf16 v[152:155], v[208:211], a[72:75], v[152:155]
    ds_read_b64_tr_b16 v[202:203], v0 offset:25088
    v_mfma_f32_16x16x32_bf16 v[156:159], v[208:211], a[76:79], v[156:159]
    s_waitcnt lgkmcnt(8)
    v_mfma_f32_16x16x32_bf16 v[60:63], v[212:215], a[76:79], v[60:63]
    ds_read_b64_tr_b16 v[204:205], v231 offset:28672
    v_mfma_f32_16x16x32_bf16 v[56:59], v[212:215], a[72:75], v[56:59]
    v_mfma_f32_16x16x32_bf16 v[52:55], v[212:215], a[68:71], v[52:55]
    ds_read_b64_tr_b16 v[206:207], v231 offset:29184
    v_mfma_f32_16x16x32_bf16 v[48:51], v[212:215], a[64:67], v[48:51]
    s_waitcnt lgkmcnt(8)
    v_mfma_f32_16x16x32_bf16 v[96:99], v[216:219], a[64:67], v[96:99]
    ds_read_b64_tr_b16 v[208:209], v245 offset:28672
    s_add_u32 m0, s38, 45056
    v_mfma_f32_16x16x32_bf16 v[100:103], v[216:219], a[68:71], v[100:103]
    s_add_u32 s28, s33, 4427776
    buffer_load_dwordx4 v5, s[12:15], s28 offen lds
    v_mfma_f32_16x16x32_bf16 v[104:107], v[216:219], a[72:75], v[104:107]
    ds_read_b64_tr_b16 v[210:211], v245 offset:29184
    v_mfma_f32_16x16x32_bf16 v[108:111], v[216:219], a[76:79], v[108:111]
    s_waitcnt lgkmcnt(8)
    v_mfma_f32_16x16x32_bf16 v[140:143], v[192:195], a[76:79], v[140:143]
    ds_read_b64_tr_b16 v[212:213], v252 offset:28672
    v_mfma_f32_16x16x32_bf16 v[136:139], v[192:195], a[72:75], v[136:139]
    v_mfma_f32_16x16x32_bf16 v[132:135], v[192:195], a[68:71], v[132:135]
    ds_read_b64_tr_b16 v[214:215], v252 offset:29184
    v_mfma_f32_16x16x32_bf16 v[128:131], v[192:195], a[64:67], v[128:131]
    s_waitcnt lgkmcnt(8)
    v_mfma_f32_16x16x32_bf16 v[160:163], v[196:199], a[64:67], v[160:163]
    ds_read_b64_tr_b16 v[216:217], v0 offset:28672
    v_mfma_f32_16x16x32_bf16 v[164:167], v[196:199], a[68:71], v[164:167]
    v_mfma_f32_16x16x32_bf16 v[168:171], v[196:199], a[72:75], v[168:171]
    ds_read_b64_tr_b16 v[218:219], v0 offset:29184
    v_mfma_f32_16x16x32_bf16 v[172:175], v[196:199], a[76:79], v[172:175]
    s_waitcnt lgkmcnt(8)
    v_mfma_f32_16x16x32_bf16 v[76:79], v[200:203], a[76:79], v[76:79]
    ds_read_b64_tr_b16 v[192:193], v231 offset:32768
    s_add_u32 m0, s38, 49152
    v_mfma_f32_16x16x32_bf16 v[72:75], v[200:203], a[72:75], v[72:75]
    s_add_u32 s28, s33, 4427776
    buffer_load_dwordx4 v5, s[44:47], s28 offen lds
    v_mfma_f32_16x16x32_bf16 v[68:71], v[200:203], a[68:71], v[68:71]
    ds_read_b64_tr_b16 v[194:195], v231 offset:33280
    v_mfma_f32_16x16x32_bf16 v[64:67], v[200:203], a[64:67], v[64:67]
    s_waitcnt lgkmcnt(8)
    v_mfma_f32_16x16x32_bf16 v[80:83], v[204:207], a[80:83], v[80:83]
    ds_read_b64_tr_b16 v[196:197], v245 offset:32768
    v_mfma_f32_16x16x32_bf16 v[84:87], v[204:207], a[84:87], v[84:87]
    v_mfma_f32_16x16x32_bf16 v[88:91], v[204:207], a[88:91], v[88:91]
    ds_read_b64_tr_b16 v[198:199], v245 offset:33280
    v_mfma_f32_16x16x32_bf16 v[92:95], v[204:207], a[92:95], v[92:95]
    s_waitcnt lgkmcnt(8)
    v_mfma_f32_16x16x32_bf16 v[124:127], v[208:211], a[92:95], v[124:127]
    ds_read_b64_tr_b16 v[200:201], v252 offset:32768
    v_mfma_f32_16x16x32_bf16 v[120:123], v[208:211], a[88:91], v[120:123]
    v_mfma_f32_16x16x32_bf16 v[116:119], v[208:211], a[84:87], v[116:119]
    ds_read_b64_tr_b16 v[202:203], v252 offset:33280
    v_mfma_f32_16x16x32_bf16 v[112:115], v[208:211], a[80:83], v[112:115]
    s_waitcnt lgkmcnt(8)
    v_mfma_f32_16x16x32_bf16 v[144:147], v[212:215], a[80:83], v[144:147]
    ds_read_b64_tr_b16 v[204:205], v0 offset:32768
    s_add_u32 m0, s38, 53248
    v_mfma_f32_16x16x32_bf16 v[148:151], v[212:215], a[84:87], v[148:151]
    s_add_u32 s28, s33, 4722688
    buffer_load_dwordx4 v5, s[12:15], s28 offen lds
    v_mfma_f32_16x16x32_bf16 v[152:155], v[212:215], a[88:91], v[152:155]
    ds_read_b64_tr_b16 v[206:207], v0 offset:33280
    v_mfma_f32_16x16x32_bf16 v[156:159], v[212:215], a[92:95], v[156:159]
    s_waitcnt lgkmcnt(8)
    v_mfma_f32_16x16x32_bf16 v[60:63], v[216:219], a[92:95], v[60:63]
    s_waitcnt vmcnt(11)
    s_barrier
    v_add_u32 v240, s53, v240
    v_mov_b32 v254, s64
    s_mov_b64 exec, 1
    global_store_dword v240, v254, s[78:79] sc1
    s_mov_b64 exec, -1
    ds_read_b64_tr_b16 v[208:209], v231 offset:36864
    v_mfma_f32_16x16x32_bf16 v[56:59], v[216:219], a[88:91], v[56:59]
    v_mfma_f32_16x16x32_bf16 v[52:55], v[216:219], a[84:87], v[52:55]
    ds_read_b64_tr_b16 v[210:211], v231 offset:37376
    v_mfma_f32_16x16x32_bf16 v[48:51], v[216:219], a[80:83], v[48:51]
    s_waitcnt lgkmcnt(8)
    v_mfma_f32_16x16x32_bf16 v[96:99], v[192:195], a[80:83], v[96:99]
    ds_read_b64_tr_b16 v[212:213], v245 offset:36864
    v_mfma_f32_16x16x32_bf16 v[100:103], v[192:195], a[84:87], v[100:103]
    v_mfma_f32_16x16x32_bf16 v[104:107], v[192:195], a[88:91], v[104:107]
    ds_read_b64_tr_b16 v[214:215], v245 offset:37376
    v_mfma_f32_16x16x32_bf16 v[108:111], v[192:195], a[92:95], v[108:111]
    s_waitcnt lgkmcnt(8)
    v_mfma_f32_16x16x32_bf16 v[140:143], v[196:199], a[92:95], v[140:143]
    ds_read_b64_tr_b16 v[216:217], v252 offset:36864
    s_add_u32 m0, s38, 57344
    v_mfma_f32_16x16x32_bf16 v[136:139], v[196:199], a[88:91], v[136:139]
    s_add_u32 s28, s33, 4722688
    buffer_load_dwordx4 v5, s[44:47], s28 offen lds
    v_mfma_f32_16x16x32_bf16 v[132:135], v[196:199], a[84:87], v[132:135]
    ds_read_b64_tr_b16 v[218:219], v252 offset:37376
    v_mfma_f32_16x16x32_bf16 v[128:131], v[196:199], a[80:83], v[128:131]
    s_waitcnt vmcnt(6)
    v_cmp_ne_u32 vcc, s64, v15
    s_nop 4
    s_cbranch_vccnz L_g_slow1
L_g_back1:
    s_waitcnt lgkmcnt(8)
    v_mfma_f32_16x16x32_bf16 v[160:163], v[200:203], a[80:83], v[160:163]
    ds_read_b64_tr_b16 v[192:193], v0 offset:36864
    s_add_u32 m0, s48, 135168
    v_mfma_f32_16x16x32_bf16 v[164:167], v[200:203], a[84:87], v[164:167]
    s_add_u32 s50, s1, 0
    buffer_load_dwordx4 v224, s[24:27], s50 offen offset:0 sc1 lds
    v_mfma_f32_16x16x32_bf16 v[168:171], v[200:203], a[88:91], v[168:171]
    ds_read_b64_tr_b16 v[194:195], v0 offset:37376
    v_mfma_f32_16x16x32_bf16 v[172:175], v[200:203], a[92:95], v[172:175]
    s_waitcnt lgkmcnt(8)
    v_mfma_f32_16x16x32_bf16 v[76:79], v[204:207], a[92:95], v[76:79]
    ds_read_b64_tr_b16 v[196:197], v231 offset:40960
    s_add_u32 m0, s48, 136192
    v_mfma_f32_16x16x32_bf16 v[72:75], v[204:207], a[88:91], v[72:75]
    buffer_load_dwordx4 v225, s[24:27], s50 offen offset:0 sc1 lds
    v_mfma_f32_16x16x32_bf16 v[68:71], v[204:207], a[84:87], v[68:71]
    ds_read_b64_tr_b16 v[198:199], v231 offset:41472
    v_mfma_f32_16x16x32_bf16 v[64:67], v[204:207], a[80:83], v[64:67]
    s_waitcnt lgkmcnt(8)
    v_mfma_f32_16x16x32_bf16 v[80:83], v[208:211], a[96:99], v[80:83]
    ds_read_b64_tr_b16 v[200:201], v245 offset:40960
    s_add_u32 m0, s38, 61440
    v_mfma_f32_16x16x32_bf16 v[84:87], v[208:211], a[100:103], v[84:87]
    s_add_u32 s28, s33, 5017600
    buffer_load_dwordx4 v5, s[12:15], s28 offen lds
    v_mfma_f32_16x16x32_bf16 v[88:91], v[208:211], a[104:107], v[88:91]
    ds_read_b64_tr_b16 v[202:203], v245 offset:41472
    v_mfma_f32_16x16x32_bf16 v[92:95], v[208:211], a[108:111], v[92:95]
    s_waitcnt lgkmcnt(8)
    v_mfma_f32_16x16x32_bf16 v[124:127], v[212:215], a[108:111], v[124:127]
    ds_read_b64_tr_b16 v[204:205], v252 offset:40960
    s_add_u32 m0, s48, 136192
    v_mfma_f32_16x16x32_bf16 v[120:123], v[212:215], a[104:107], v[120:123]
    buffer_load_dwordx4 v225, s[24:27], s50 offen offset:1024 sc1 lds
    v_mfma_f32_16x16x32_bf16 v[116:119], v[212:215], a[100:103], v[116:119]
    ds_read_b64_tr_b16 v[206:207], v252 offset:41472
    v_mfma_f32_16x16x32_bf16 v[112:115], v[212:215], a[96:99], v[112:115]
    v_add_u32 v253, 0x4000, v253
    s_mov_b64 exec, 255
    global_load_dword v15, v253, s[78:79] sc1
    s_mov_b64 exec, -1
    s_waitcnt lgkmcnt(8)
    v_mfma_f32_16x16x32_bf16 v[144:147], v[216:219], a[96:99], v[144:147]
    ds_read_b64_tr_b16 v[208:209], v0 offset:40960
    s_add_u32 m0, s48, 138240
    v_mfma_f32_16x16x32_bf16 v[148:151], v[216:219], a[100:103], v[148:151]
    buffer_load_dwordx4 v226, s[24:27], s50 offen offset:0 sc1 lds
    v_mfma_f32_16x16x32_bf16 v[152:155], v[216:219], a[104:107], v[152:155]
    ds_read_b64_tr_b16 v[210:211], v0 offset:41472
    v_mfma_f32_16x16x32_bf16 v[156:159], v[216:219], a[108:111], v[156:159]
    s_waitcnt lgkmcnt(8)
    v_mfma_f32_16x16x32_bf16 v[60:63], v[192:195], a[108:111], v[60:63]
    ds_read_b64_tr_b16 v[212:213], v231 offset:45056
    v_mfma_f32_16x16x32_bf16 v[56:59], v[192:195], a[104:107], v[56:59]
    v_mfma_f32_16x16x32_bf16 v[52:55], v[192:195], a[100:103], v[52:55]
    ds_read_b64_tr_b16 v[214:215], v231 offset:45568
    v_mfma_f32_16x16x32_bf16 v[48:51], v[192:195], a[96:99], v[48:51]
    s_waitcnt lgkmcnt(8)
    v_mfma_f32_16x16x32_bf16 v[96:99], v[196:199], a[96:99], v[96:99]
    ds_read_b64_tr_b16 v[216:217], v245 offset:45056
    s_add_u32 m0, s38, 65536
    v_mfma_f32_16x16x32_bf16 v[100:103], v[196:199], a[100:103], v[100:103]
    s_add_u32 s28, s33, 5017600
    buffer_load_dwordx4 v5, s[44:47], s28 offen lds
    v_mfma_f32_16x16x32_bf16 v[104:107], v[196:199], a[104:107], v[104:107]
    ds_read_b64_tr_b16 v[218:219], v245 offset:45568
    v_mfma_f32_16x16x32_bf16 v[108:111], v[196:199], a[108:111], v[108:111]
    s_waitcnt lgkmcnt(8)
    v_mfma_f32_16x16x32_bf16 v[140:143], v[200:203], a[108:111], v[140:143]
    ds_read_b64_tr_b16 v[192:193], v252 offset:45056
    s_add_u32 m0, s48, 138240
    v_mfma_f32_16x16x32_bf16 v[136:139], v[200:203], a[104:107], v[136:139]
    buffer_load_dwordx4 v226, s[24:27], s50 offen offset:1024 sc1 lds
    v_mfma_f32_16x16x32_bf16 v[132:135], v[200:203], a[100:103], v[132:135]
    ds_read_b64_tr_b16 v[194:195], v252 offset:45568
    v_mfma_f32_16x16x32_bf16 v[128:131], v[200:203], a[96:99], v[128:131]
    s_waitcnt lgkmcnt(8)
    v_mfma_f32_16x16x32_bf16 v[160:163], v[204:207], a[96:99], v[160:163]
    ds_read_b64_tr_b16 v[196:197], v0 offset:45056
    s_add_u32 m0, s48, 140288
    v_mfma_f32_16x16x32_bf16 v[164:167], v[204:207], a[100:103], v[164:167]
    buffer_load_dwordx4 v227, s[24:27], s50 offen offset:0 sc1 lds
    v_mfma_f32_16x16x32_bf16 v[168:171], v[204:207], a[104:107], v[168:171]
    ds_read_b64_tr_b16 v[198:199], v0 offset:45568
    v_mfma_f32_16x16x32_bf16 v[172:175], v[204:207], a[108:111], v[172:175]
    s_waitcnt lgkmcnt(8)
    v_mfma_f32_16x16x32_bf16 v[76:79], v[208:211], a[108:111], v[76:79]
    ds_read_b64_tr_b16 v[200:201], v231 offset:49152
    s_add_u32 m0, s48, 140288
    v_mfma_f32_16x16x32_bf16 v[72:75], v[208:211], a[104:107], v[72:75]
    buffer_load_dwordx4 v227, s[24:27], s50 offen offset:1024 sc1 lds
    v_mfma_f32_16x16x32_bf16 v[68:71], v[208:211], a[100:103], v[68:71]
    ds_read_b64_tr_b16 v[202:203], v231 offset:49664
    v_mfma_f32_16x16x32_bf16 v[64:67], v[208:211], a[96:99], v[64:67]
    s_waitcnt lgkmcnt(8)
    v_mfma_f32_16x16x32_bf16 v[80:83], v[212:215], a[112:115], v[80:83]
    ds_read_b64_tr_b16 v[204:205], v245 offset:49152
    v_mfma_f32_16x16x32_bf16 v[84:87], v[212:215], a[116:119], v[84:87]
    v_mfma_f32_16x16x32_bf16 v[88:91], v[212:215], a[120:123], v[88:91]
    ds_read_b64_tr_b16 v[206:207], v245 offset:49664
    v_mfma_f32_16x16x32_bf16 v[92:95], v[212:215], a[124:127], v[92:95]
    s_waitcnt lgkmcnt(8)
    v_mfma_f32_16x16x32_bf16 v[124:127], v[216:219], a[124:127], v[124:127]
    ds_read_b64_tr_b16 v[208:209], v252 offset:49152
    v_mfma_f32_16x16x32_bf16 v[120:123], v[216:219], a[120:123], v[120:123]
    v_mfma_f32_16x16x32_bf16 v[116:119], v[216:219], a[116:119], v[116:119]
    ds_read_b64_tr_b16 v[210:211], v252 offset:49664
    v_mfma_f32_16x16x32_bf16 v[112:115], v[216:219], a[112:115], v[112:115]
    s_waitcnt lgkmcnt(8)
    v_mfma_f32_16x16x32_bf16 v[144:147], v[192:195], a[112:115], v[144:147]
    ds_read_b64_tr_b16 v[212:213], v0 offset:49152
    v_mfma_f32_16x16x32_bf16 v[148:151], v[192:195], a[116:119], v[148:151]
    v_mfma_f32_16x16x32_bf16 v[152:155], v[192:195], a[120:123], v[152:155]
    ds_read_b64_tr_b16 v[214:215], v0 offset:49664
    v_mfma_f32_16x16x32_bf16 v[156:159], v[192:195], a[124:127], v[156:159]
    s_waitcnt lgkmcnt(8)
    v_mfma_f32_16x16x32_bf16 v[60:63], v[196:199], a[124:127], v[60:63]
    s_waitcnt vmcnt(31)
    s_barrier
    ds_read_b64_tr_b16 v[216:217], v231 offset:53248
    s_add_u32 m0, s48, 69632
    v_mfma_f32_16x16x32_bf16 v[56:59], v[196:199], a[120:123], v[56:59]
    s_add_u32 s50, s1, 165888
    buffer_load_dwordx4 v224, s[24:27], s50 offen offset:0 sc1 lds
    v_mfma_f32_16x16x32_bf16 v[52:55], v[196:199], a[116:119], v[52:55]
    ds_read_b64_tr_b16 v[218:219], v231 offset:53760
    v_mfma_f32_16x16x32_bf16 v[48:51], v[196:199], a[112:115], v[48:51]
    s_waitcnt lgkmcnt(8)
    v_mfma_f32_16x16x32_bf16 v[96:99], v[200:203], a[112:115], v[96:99]
    ds_read_b64_tr_b16 v[192:193], v245 offset:53248
    s_add_u32 m0, s48, 70656
    v_mfma_f32_16x16x32_bf16 v[100:103], v[200:203], a[116:119], v[100:103]
    buffer_load_dwordx4 v225, s[24:27], s50 offen offset:0 sc1 lds
    v_mfma_f32_16x16x32_bf16 v[104:107], v[200:203], a[120:123], v[104:107]
    ds_read_b64_tr_b16 v[194:195], v245 offset:53760
    v_mfma_f32_16x16x32_bf16 v[108:111], v[200:203], a[124:127], v[108:111]
    s_waitcnt lgkmcnt(8)
    v_mfma_f32_16x16x32_bf16 v[140:143], v[204:207], a[124:127], v[140:143]
    ds_read_b64_tr_b16 v[196:197], v252 offset:53248
    s_add_u32 m0, s48, 70656
    v_mfma_f32_16x16x32_bf16 v[136:139], v[204:207], a[120:123], v[136:139]
    buffer_load_dwordx4 v225, s[24:27], s50 offen offset:1024 sc1 lds
    v_mfma_f32_16x16x32_bf16 v[132:135], v[204:207], a[116:119], v[132:135]
    ds_read_b64_tr_b16 v[198:199], v252 offset:53760
    v_mfma_f32_16x16x32_bf16 v[128:131], v[204:207], a[112:115], v[128:131]
    s_waitcnt lgkmcnt(8)
    v_mfma_f32_16x16x32_bf16 v[160:163], v[208:211], a[112:115], v[160:163]
    ds_read_b64_tr_b16 v[200:201], v0 offset:53248
    s_add_u32 m0, s48, 72704
    v_mfma_f32_16x16x32_bf16 v[164:167], v[208:211], a[116:119], v[164:167]
    buffer_load_dwordx4 v226, s[24:27], s50 offen offset:0 sc1 lds
    v_mfma_f32_16x16x32_bf16 v[168:171], v[208:211], a[120:123], v[168:171]
    ds_read_b64_tr_b16 v[202:203], v0 offset:53760
    v_mfma_f32_16x16x32_bf16 v[172:175], v[208:211], a[124:127], v[172:175]
    s_waitcnt lgkmcnt(8)
    v_mfma_f32_16x16x32_bf16 v[76:79], v[212:215], a[124:127], v[76:79]
    ds_read_b64_tr_b16 v[204:205], v231 offset:57344
    s_add_u32 m0, s48, 72704
    v_mfma_f32_16x16x32_bf16 v[72:75], v[212:215], a[120:123], v[72:75]
    buffer_load_dwordx4 v226, s[24:27], s50 offen offset:1024 sc1 lds
    v_mfma_f32_16x16x32_bf16 v[68:71], v[212:215], a[116:119], v[68:71]
    ds_read_b64_tr_b16 v[206:207], v231 offset:57856
    v_mfma_f32_16x16x32_bf16 v[64:67], v[212:215], a[112:115], v[64:67]
    s_waitcnt vmcnt(10)
    v_cmp_ne_u32 vcc, s64, v15
    s_nop 4
    s_cbranch_vccnz L_g_slow2
L_g_back2:
    s_waitcnt lgkmcnt(8)
    v_mfma_f32_16x16x32_bf16 v[80:83], v[216:219], a[128:131], v[80:83]
    ds_read_b64_tr_b16 v[208:209], v245 offset:57344
    s_mov_b32 s51, 0
    v_mfma_f32_16x16x32_bf16 v[84:87], v[216:219], a[132:135], v[84:87]
    buffer_load_dwordx4 a[0:3], v1, s[20:23], s51 offen sc1
    v_mfma_f32_16x16x32_bf16 v[88:91], v[216:219], a[136:139], v[88:91]
    ds_read_b64_tr_b16 v[210:211], v245 offset:57856
    v_mfma_f32_16x16x32_bf16 v[92:95], v[216:219], a[140:143], v[92:95]
    s_waitcnt lgkmcnt(8)
    v_mfma_f32_16x16x32_bf16 v[124:127], v[192:195], a[140:143], v[124:127]
    ds_read_b64_tr_b16 v[212:213], v252 offset:57344
    v_mfma_f32_16x16x32_bf16 v[120:123], v[192:195], a[136:139], v[120:123]
    v_mfma_f32_16x16x32_bf16 v[116:119], v[192:195], a[132:135], v[116:119]
    ds_read_b64_tr_b16 v[214:215], v252 offset:57856
    v_mfma_f32_16x16x32_bf16 v[112:115], v[192:195], a[128:131], v[112:115]
    s_waitcnt lgkmcnt(8)
    v_mfma_f32_16x16x32_bf16 v[144:147], v[196:199], a[128:131], v[144:147]
    ds_read_b64_tr_b16 v[216:217], v0 offset:57344
    v_mfma_f32_16x16x32_bf16 v[148:151], v[196:199], a[132:135], v[148:151]
    buffer_load_dwordx4 a[4:7], v242, s[20:23], s51 offen sc1
    v_mfma_f32_16x16x32_bf16 v[152:155], v[196:199], a[136:139], v[152:155]
    ds_read_b64_tr_b16 v[218:219], v0 offset:57856
    v_mfma_f32_16x16x32_bf16 v[156:159], v[196:199], a[140:143], v[156:159]
    s_waitcnt lgkmcnt(8)
    v_mfma_f32_16x16x32_bf16 v[60:63], v[200:203], a[140:143], v[60:63]
    ds_read_b64_tr_b16 v[192:193], v231 offset:61440
    s_mov_b32 s51, 5120
    v_mfma_f32_16x16x32_bf16 v[56:59], v[200:203], a[136:139], v[56:59]
    buffer_load_dwordx4 a[8:11], v1, s[20:23], s51 offen sc1
    v_mfma_f32_16x16x32_bf16 v[52:55], v[200:203], a[132:135], v[52:55]
    ds_read_b64_tr_b16 v[194:195], v231 offset:61952
    v_mfma_f32_16x16x32_bf16 v[48:51], v[200:203], a[128:131], v[48:51]
    s_waitcnt lgkmcnt(8)
    v_mfma_f32_16x16x32_bf16 v[96:99], v[204:207], a[128:131], v[96:99]
    ds_read_b64_tr_b16 v[196:197], v245 offset:61440
    v_mfma_f32_16x16x32_bf16 v[100:103], v[204:207], a[132:135], v[100:103]
    buffer_load_dwordx4 a[12:15], v242, s[20:23], s51 offen sc1
    v_mfma_f32_16x16x32_bf16 v[104:107], v[204:207], a[136:139], v[104:107]
    ds_read_b64_tr_b16 v[198:199], v245 offset:61952
    v_mfma_f32_16x16x32_bf16 v[108:111], v[204:207], a[140:143], v[108:111]
    s_waitcnt lgkmcnt(8)
    v_mfma_f32_16x16x32_bf16 v[140:143], v[208:211], a[140:143], v[140:143]
    ds_read_b64_tr_b16 v[200:201], v252 offset:61440
    s_add_u32 m0, s48, 74752
    v_mfma_f32_16x16x32_bf16 v[136:139], v[208:211], a[136:139], v[136:139]
    buffer_load_dwordx4 v227, s[24:27], s50 offen offset:0 sc1 lds
    v_mfma_f32_16x16x32_bf16 v[132:135], v[208:211], a[132:135], v[132:135]
    ds_read_b64_tr_b16 v[202:203], v252 offset:61952
    v_mfma_f32_16x16x32_bf16 v[128:131], v[208:211], a[128:131], v[128:131]
    s_waitcnt lgkmcnt(8)
    v_mfma_f32_16x16x32_bf16 v[160:163], v[212:215], a[128:131], v[160:163]
    ds_read_b64_tr_b16 v[204:205], v0 offset:61440
    v_mfma_f32_16x16x32_bf16 v[164:167], v[212:215], a[132:135], v[164:167]
    v_mfma_f32_16x16x32_bf16 v[168:171], v[212:215], a[136:139], v[168:171]
    ds_read_b64_tr_b16 v[206:207], v0 offset:61952
    v_mfma_f32_16x16x32_bf16 v[172:175], v[212:215], a[140:143], v[172:175]
    s_waitcnt lgkmcnt(8)
    v_mfma_f32_16x16x32_bf16 v[76:79], v[216:219], a[140:143], v[76:79]
    ds_read_b64_tr_b16 v[208:209], v220 offset:0
    s_add_u32 m0, s48, 74752
    v_mfma_f32_16x16x32_bf16 v[72:75], v[216:219], a[136:139], v[72:75]
    buffer_load_dwordx4 v227, s[24:27], s50 offen offset:1024 sc1 lds
    v_mfma_f32_16x16x32_bf16 v[68:71], v[216:219], a[132:135], v[68:71]
    ds_read_b64_tr_b16 v[210:211], v220 offset:512
    v_mfma_f32_16x16x32_bf16 v[64:67], v[216:219], a[128:131], v[64:67]
    s_waitcnt lgkmcnt(8)
    v_mfma_f32_16x16x32_bf16 v[80:83], v[192:195], a[144:147], v[80:83]
    ds_read_b64_tr_b16 v[212:213], v221 offset:0
    s_mov_b32 s51, 9216
    v_mfma_f32_16x16x32_bf16 v[84:87], v[192:195], a[148:151], v[84:87]
    buffer_load_dwordx4 a[16:19], v1, s[20:23], s51 offen sc1
    v_mfma_f32_16x16x32_bf16 v[88:91], v[192:195], a[152:155], v[88:91]
    ds_read_b64_tr_b16 v[214:215], v221 offset:512
    v_mfma_f32_16x16x32_bf16 v[92:95], v[192:195], a[156:159], v[92:95]
    s_waitcnt lgkmcnt(8)
    v_mfma_f32_16x16x32_bf16 v[124:127], v[196:199], a[156:159], v[124:127]
    ds_read_b64_tr_b16 v[216:217], v222 offset:0
    v_mfma_f32_16x16x32_bf16 v[120:123], v[196:199], a[152:155], v[120:123]
    buffer_load_dwordx4 a[20:23], v242, s[20:23], s51 offen sc1
    v_mfma_f32_16x16x32_bf16 v[116:119], v[196:199], a[148:151], v[116:119]
    ds_read_b64_tr_b16 v[218:219], v222 offset:512
    v_mfma_f32_16x16x32_bf16 v[112:115], v[196:199], a[144:147], v[112:115]
    s_waitcnt lgkmcnt(8)
    v_mfma_f32_16x16x32_bf16 v[144:147], v[200:203], a[144:147], v[144:147]
    ds_read_b64_tr_b16 v[192:193], v223 offset:0
    s_mov_b32 s51, 14336
    v_mfma_f32_16x16x32_bf16 v[148:151], v[200:203], a[148:151], v[148:151]
    buffer_load_dwordx4 a[24:27], v1, s[20:23], s51 offen sc1
    v_mfma_f32_16x16x32_bf16 v[152:155], v[200:203], a[152:155], v[152:155]
    ds_read_b64_tr_b16 v[194:195], v223 offset:512
    v_mfma_f32_16x16x32_bf16 v[156:159], v[200:203], a[156:159], v[156:159]
    s_waitcnt lgkmcnt(8)
    v_mfma_f32_16x16x32_bf16 v[60:63], v[204:207], a[156:159], v[60:63]
    s_waitcnt vmcnt(36)
    s_barrier
    ds_read_b64_tr_b16 v[196:197], v220 offset:4096
    v_mfma_f32_16x16x32_bf16 v[56:59], v[204:207], a[152:155], v[56:59]
    v_mfma_f32_16x16x32_bf16 v[52:55], v[204:207], a[148:151], v[52:55]
    ds_read_b64_tr_b16 v[198:199], v220 offset:4608
    v_mfma_f32_16x16x32_bf16 v[48:51], v[204:207], a[144:147], v[48:51]
    s_waitcnt lgkmcnt(8)
    v_mfma_f32_16x16x32_bf16 v[96:99], v[208:211], a[144:147], v[96:99]
    ds_read_b64_tr_b16 v[200:201], v221 offset:4096
    v_mfma_f32_16x16x32_bf16 v[100:103], v[208:211], a[148:151], v[100:103]
    buffer_load_dwordx4 a[28:31], v242, s[20:23], s51 offen sc1
    v_mfma_f32_16x16x32_bf16 v[104:107], v[208:211], a[152:155], v[104:107]
    ds_read_b64_tr_b16 v[202:203], v221 offset:4608
    v_mfma_f32_16x16x32_bf16 v[108:111], v[208:211], a[156:159], v[108:111]
    s_waitcnt lgkmcnt(8)
    v_mfma_f32_16x16x32_bf16 v[140:143], v[212:215], a[156:159], v[140:143]
    ds_read_b64_tr_b16 v[204:205], v222 offset:4096
    s_mov_b32 s51, 18432
    v_mfma_f32_16x16x32_bf16 v[136:139], v[212:215], a[152:155], v[136:139]
    buffer_load_dwordx4 a[32:35], v1, s[20:23], s51 offen sc1
    v_mfma_f32_16x16x32_bf16 v[132:135], v[212:215], a[148:151], v[132:135]
    ds_read_b64_tr_b16 v[206:207], v222 offset:4608
    v_mfma_f32_16x16x32_bf16 v[128:131], v[212:215], a[144:147], v[128:131]
    s_waitcnt lgkmcnt(8)
    v_mfma_f32_16x16x32_bf16 v[160:163], v[216:219], a[144:147], v[160:163]
    ds_read_b64_tr_b16 v[208:209], v223 offset:4096
    v_mfma_f32_16x16x32_bf16 v[164:167], v[216:219], a[148:151], v[164:167]
    buffer_load_dwordx4 a[36:39], v242, s[20:23], s51 offen sc1
    v_mfma_f32_16x16x32_bf16 v[168:171], v[216:219], a[152:155], v[168:171]
    ds_read_b64_tr_b16 v[210:211], v223 offset:4608
    v_mfma_f32_16x16x32_bf16 v[172:175], v[216:219], a[156:159], v[172:175]
    s_waitcnt lgkmcnt(8)
    v_mfma_f32_16x16x32_bf16 v[76:79], v[192:195], a[156:159], v[76:79]
    ds_read_b64_tr_b16 v[212:213], v220 offset:8192
    s_mov_b32 s51, 23552
    v_mfma_f32_16x16x32_bf16 v[72:75], v[192:195], a[152:155], v[72:75]
    buffer_load_dwordx4 a[40:43], v1, s[20:23], s51 offen sc1
    v_mfma_f32_16x16x32_bf16 v[68:71], v[192:195], a[148:151], v[68:71]
    ds_read_b64_tr_b16 v[214:215], v220 offset:8704
    v_mfma_f32_16x16x32_bf16 v[64:67], v[192:195], a[144:147], v[64:67]
    s_waitcnt lgkmcnt(8)
    v_mfma_f32_16x16x32_bf16 v[80:83], v[196:199], a[160:163], v[80:83]
    ds_read_b64_tr_b16 v[216:217], v221 offset:8192
    v_mfma_f32_16x16x32_bf16 v[84:87], v[196:199], a[164:167], v[84:87]
    v_mfma_f32_16x16x32_bf16 v[88:91], v[196:199], a[168:171], v[88:91]
    ds_read_b64_tr_b16 v[218:219], v221 offset:8704
    v_mfma_f32_16x16x32_bf16 v[92:95], v[196:199], a[172:175], v[92:95]
    s_waitcnt lgkmcnt(8)
    v_mfma_f32_16x16x32_bf16 v[124:127], v[200:203], a[172:175], v[124:127]
    ds_read_b64_tr_b16 v[192:193], v222 offset:8192
    v_mfma_f32_16x16x32_bf16 v[120:123], v[200:203], a[168:171], v[120:123]
    buffer_load_dwordx4 a[44:47], v242, s[20:23], s51 offen sc1
    v_mfma_f32_16x16x32_bf16 v[116:119], v[200:203], a[164:167], v[116:119]
    ds_read_b64_tr_b16 v[194:195], v222 offset:8704
    v_mfma_f32_16x16x32_bf16 v[112:115], v[200:203], a[160:163], v[112:115]
    s_waitcnt lgkmcnt(8)
    v_mfma_f32_16x16x32_bf16 v[144:147], v[204:207], a[160:163], v[144:147]
    ds_read_b64_tr_b16 v[196:197], v223 offset:8192
    s_add_u32 m0, s48, 98304
    v_mfma_f32_16x16x32_bf16 v[148:151], v[204:207], a[164:167], v[148:151]
    s_add_u32 s50, s1, 9216
    buffer_load_dwordx4 v224, s[24:27], s50 offen offset:0 sc1 lds
    v_mfma_f32_16x16x32_bf16 v[152:155], v[204:207], a[168:171], v[152:155]
    ds_read_b64_tr_b16 v[198:199], v223 offset:8704
    v_mfma_f32_16x16x32_bf16 v[156:159], v[204:207], a[172:175], v[156:159]
    s_waitcnt lgkmcnt(8)
    v_mfma_f32_16x16x32_bf16 v[60:63], v[208:211], a[172:175], v[60:63]
    ds_read_b64_tr_b16 v[200:201], v220 offset:12288
    s_add_u32 m0, s48, 99328
    v_mfma_f32_16x16x32_bf16 v[56:59], v[208:211], a[168:171], v[56:59]
    buffer_load_dwordx4 v225, s[24:27], s50 offen offset:0 sc1 lds
    v_mfma_f32_16x16x32_bf16 v[52:55], v[208:211], a[164:167], v[52:55]
    ds_read_b64_tr_b16 v[202:203], v220 offset:12800
    v_mfma_f32_16x16x32_bf16 v[48:51], v[208:211], a[160:163], v[48:51]
    s_waitcnt lgkmcnt(8)
    v_mfma_f32_16x16x32_bf16 v[96:99], v[212:215], a[160:163], v[96:99]
    ds_read_b64_tr_b16 v[204:205], v221 offset:12288
    s_add_u32 m0, s48, 99328
    v_mfma_f32_16x16x32_bf16 v[100:103], v[212:215], a[164:167], v[100:103]
    buffer_load_dwordx4 v225, s[24:27], s50 offen offset:1024 sc1 lds
    v_mfma_f32_16x16x32_bf16 v[104:107], v[212:215], a[168:171], v[104:107]
    ds_read_b64_tr_b16 v[206:207], v221 offset:12800
    v_mfma_f32_16x16x32_bf16 v[108:111], v[212:215], a[172:175], v[108:111]
    s_waitcnt lgkmcnt(8)
    v_mfma_f32_16x16x32_bf16 v[140:143], v[216:219], a[172:175], v[140:143]
    ds_read_b64_tr_b16 v[208:209], v222 offset:12288
    v_mfma_f32_16x16x32_bf16 v[136:139], v[216:219], a[168:171], v[136:139]
    v_mfma_f32_16x16x32_bf16 v[132:135], v[216:219], a[164:167], v[132:135]
    ds_read_b64_tr_b16 v[210:211], v222 offset:12800
    v_mfma_f32_16x16x32_bf16 v[128:131], v[216:219], a[160:163], v[128:131]
    v_add_u32 v253, 0x4000, v253
    s_mov_b64 exec, 255
    global_load_dword v15, v253, s[78:79] sc1
    s_mov_b64 exec, -1
    s_waitcnt lgkmcnt(8)
    v_mfma_f32_16x16x32_bf16 v[160:163], v[192:195], a[160:163], v[160:163]
    ds_read_b64_tr_b16 v[212:213], v223 offset:12288
    s_add_u32 m0, s48, 101376
    v_mfma_f32_16x16x32_bf16 v[164:167], v[192:195], a[164:167], v[164:167]
    buffer_load_dwordx4 v226, s[24:27], s50 offen offset:0 sc1 lds
    v_mfma_f32_16x16x32_bf16 v[168:171], v[192:195], a[168:171], v[168:171]
    ds_read_b64_tr_b16 v[214:215], v223 offset:12800
    v_mfma_f32_16x16x32_bf16 v[172:175], v[192:195], a[172:175], v[172:175]
    s_waitcnt lgkmcnt(8)
    v_mfma_f32_16x16x32_bf16 v[76:79], v[196:199], a[172:175], v[76:79]
    ds_read_b64_tr_b16 v[216:217], v220 offset:16384
    s_add_u32 m0, s48, 101376
    v_mfma_f32_16x16x32_bf16 v[72:75], v[196:199], a[168:171], v[72:75]
    buffer_load_dwordx4 v226, s[24:27], s50 offen offset:1024 sc1 lds
    v_mfma_f32_16x16x32_bf16 v[68:71], v[196:199], a[164:167], v[68:71]
    ds_read_b64_tr_b16 v[218:219], v220 offset:16896
    v_mfma_f32_16x16x32_bf16 v[64:67], v[196:199], a[160:163], v[64:67]
    s_waitcnt lgkmcnt(8)
    v_mfma_f32_16x16x32_bf16 v[80:83], v[200:203], a[176:179], v[80:83]
    ds_read_b64_tr_b16 v[192:193], v221 offset:16384
    s_add_u32 m0, s48, 103424
    v_mfma_f32_16x16x32_bf16 v[84:87], v[200:203], a[180:183], v[84:87]
    buffer_load_dwordx4 v227, s[24:27], s50 offen offset:0 sc1 lds
    v_mfma_f32_16x16x32_bf16 v[88:91], v[200:203], a[184:187], v[88:91]
    ds_read_b64_tr_b16 v[194:195], v221 offset:16896
    v_mfma_f32_16x16x32_bf16 v[92:95], v[200:203], a[188:191], v[92:95]
    s_waitcnt lgkmcnt(8)
    v_mfma_f32_16x16x32_bf16 v[124:127], v[204:207], a[188:191], v[124:127]
    ds_read_b64_tr_b16 v[196:197], v222 offset:16384
    s_add_u32 m0, s48, 103424
    v_mfma_f32_16x16x32_bf16 v[120:123], v[204:207], a[184:187], v[120:123]
    buffer_load_dwordx4 v227, s[24:27], s50 offen offset:1024 sc1 lds
    v_mfma_f32_16x16x32_bf16 v[116:119], v[204:207], a[180:183], v[116:119]
    ds_read_b64_tr_b16 v[198:199], v222 offset:16896
    v_mfma_f32_16x16x32_bf16 v[112:115], v[204:207], a[176:179], v[112:115]
    s_waitcnt lgkmcnt(8)
    v_mfma_f32_16x16x32_bf16 v[144:147], v[208:211], a[176:179], v[144:147]
    ds_read_b64_tr_b16 v[200:201], v223 offset:16384
    v_mfma_f32_16x16x32_bf16 v[148:151], v[208:211], a[180:183], v[148:151]
    v_mfma_f32_16x16x32_bf16 v[152:155], v[208:211], a[184:187], v[152:155]
    ds_read_b64_tr_b16 v[202:203], v223 offset:16896
    v_mfma_f32_16x16x32_bf16 v[156:159], v[208:211], a[188:191], v[156:159]
    s_waitcnt lgkmcnt(8)
    v_mfma_f32_16x16x32_bf16 v[60:63], v[212:215], a[188:191], v[60:63]
    s_waitcnt vmcnt(45)
    s_barrier
    ds_read_b64_tr_b16 v[204:205], v220 offset:20480
    s_mov_b32 s51, 27648
    v_mfma_f32_16x16x32_bf16 v[56:59], v[212:215], a[184:187], v[56:59]
    buffer_load_dwordx4 a[48:51], v1, s[20:23], s51 offen sc1
    v_mfma_f32_16x16x32_bf16 v[52:55], v[212:215], a[180:183], v[52:55]
    ds_read_b64_tr_b16 v[206:207], v220 offset:20992
    v_mfma_f32_16x16x32_bf16 v[48:51], v[212:215], a[176:179], v[48:51]
    s_waitcnt lgkmcnt(8)
    v_mfma_f32_16x16x32_bf16 v[96:99], v[216:219], a[176:179], v[96:99]
    ds_read_b64_tr_b16 v[208:209], v220 offset:24576
    v_mfma_f32_16x16x32_bf16 v[100:103], v[216:219], a[180:183], v[100:103]
    buffer_load_dwordx4 a[52:55], v242, s[20:23], s51 offen sc1
    v_mfma_f32_16x16x32_bf16 v[104:107], v[216:219], a[184:187], v[104:107]
    ds_read_b64_tr_b16 v[210:211], v220 offset:25088
    v_mfma_f32_16x16x32_bf16 v[108:111], v[216:219], a[188:191], v[108:111]
    s_waitcnt lgkmcnt(8)
    v_mfma_f32_16x16x32_bf16 v[140:143], v[192:195], a[188:191], v[140:143]
    ds_read_b64_tr_b16 v[212:213], v220 offset:28672
    s_mov_b32 s51, 32768
    v_mfma_f32_16x16x32_bf16 v[136:139], v[192:195], a[184:187], v[136:139]
    buffer_load_dwordx4 a[56:59], v1, s[20:23], s51 offen sc1
    v_mfma_f32_16x16x32_bf16 v[132:135], v[192:195], a[180:183], v[132:135]
    ds_read_b64_tr_b16 v[214:215], v220 offset:29184
    v_mfma_f32_16x16x32_bf16 v[128:131], v[192:195], a[176:179], v[128:131]
    s_waitcnt lgkmcnt(8)
    v_mfma_f32_16x16x32_bf16 v[160:163], v[196:199], a[176:179], v[160:163]
    ds_read_b64_tr_b16 v[216:217], v220 offset:32768
    v_mfma_f32_16x16x32_bf16 v[164:167], v[196:199], a[180:183], v[164:167]
    buffer_load_dwordx4 a[60:63], v242, s[20:23], s51 offen sc1
    v_mfma_f32_16x16x32_bf16 v[168:171], v[196:199], a[184:187], v[168:171]
    ds_read_b64_tr_b16 v[218:219], v220 offset:33280
    v_mfma_f32_16x16x32_bf16 v[172:175], v[196:199], a[188:191], v[172:175]
    s_waitcnt lgkmcnt(8)
    v_mfma_f32_16x16x32_bf16 v[76:79], v[200:203], a[188:191], v[76:79]
    s_waitcnt vmcnt(34)
    s_barrier
    ds_read_b64_tr_b16 v[192:193], v220 offset:36864
    v_mfma_f32_16x16x32_bf16 v[72:75], v[200:203], a[184:187], v[72:75]
    v_mfma_f32_16x16x32_bf16 v[68:71], v[200:203], a[180:183], v[68:71]
    ds_read_b64_tr_b16 v[194:195], v220 offset:37376
    v_mfma_f32_16x16x32_bf16 v[64:67], v[200:203], a[176:179], v[64:67]
    s_waitcnt lgkmcnt(8)
    v_mfma_f32_16x16x32_bf16 v[80:83], v[204:207], a[192:195], v[80:83]
    ds_read_b64_tr_b16 v[196:197], v220 offset:40960
    s_mov_b32 s51, 1024
    v_mfma_f32_16x16x32_bf16 v[84:87], v[204:207], a[196:199], v[84:87]
    buffer_load_dwordx4 a[64:67], v1, s[20:23], s51 offen sc1
    v_mfma_f32_16x16x32_bf16 v[88:91], v[204:207], a[200:203], v[88:91]
    ds_read_b64_tr_b16 v[198:199], v220 offset:41472
    v_mfma_f32_16x16x32_bf16 v[92:95], v[204:207], a[204:207], v[92:95]
    s_waitcnt lgkmcnt(8)
    v_mfma_f32_16x16x32_bf16 v[108:111], v[208:211], a[204:207], v[108:111]
    ds_read_b64_tr_b16 v[200:201], v220 offset:45056
    v_mfma_f32_16x16x32_bf16 v[104:107], v[208:211], a[200:203], v[104:107]
    buffer_load_dwordx4 a[68:71], v242, s[20:23], s51 offen sc1
    v_mfma_f32_16x16x32_bf16 v[100:103], v[208:211], a[196:199], v[100:103]
    ds_read_b64_tr_b16 v[202:203], v220 offset:45568
    v_mfma_f32_16x16x32_bf16 v[96:99], v[208:211], a[192:195], v[96:99]
    s_waitcnt lgkmcnt(8)
    v_mfma_f32_16x16x32_bf16 v[80:83], v[212:215], a[208:211], v[80:83]
    ds_read_b64_tr_b16 v[204:205], v220 offset:49152
    s_mov_b32 s51, 6144
    v_mfma_f32_16x16x32_bf16 v[84:87], v[212:215], a[212:215], v[84:87]
    buffer_load_dwordx4 a[72:75], v1, s[20:23], s51 offen sc1
    v_mfma_f32_16x16x32_bf16 v[88:91], v[212:215], a[216:219], v[88:91]
    ds_read_b64_tr_b16 v[206:207], v220 offset:49664
    v_mfma_f32_16x16x32_bf16 v[92:95], v[212:215], a[220:223], v[92:95]
    s_waitcnt lgkmcnt(8)
    v_mfma_f32_16x16x32_bf16 v[108:111], v[216:219], a[220:223], v[108:111]
    ds_read_b64_tr_b16 v[208:209], v220 offset:53248
    v_mfma_f32_16x16x32_bf16 v[104:107], v[216:219], a[216:219], v[104:107]
    buffer_load_dwordx4 a[76:79], v242, s[20:23], s51 offen sc1
    v_mfma_f32_16x16x32_bf16 v[100:103], v[216:219], a[212:215], v[100:103]
    ds_read_b64_tr_b16 v[210:211], v220 offset:53760
    v_mfma_f32_16x16x32_bf16 v[96:99], v[216:219], a[208:211], v[96:99]
    s_waitcnt vmcnt(12)
    v_cmp_ne_u32 vcc, s64, v15
    s_nop 4
    s_cbranch_vccnz L_g_slow3
L_g_back3:
    s_waitcnt lgkmcnt(8)
    v_mfma_f32_16x16x32_bf16 v[80:83], v[192:195], a[224:227], v[80:83]
    ds_read_b64_tr_b16 v[212:213], v220 offset:57344
    v_mfma_f32_16x16x32_bf16 v[84:87], v[192:195], a[228:231], v[84:87]
    v_mfma_f32_16x16x32_bf16 v[88:91], v[192:195], a[232:235], v[88:91]
    ds_read_b64_tr_b16 v[214:215], v220 offset:57856
    v_mfma_f32_16x16x32_bf16 v[92:95], v[192:195], a[236:239], v[92:95]
    s_waitcnt lgkmcnt(8)
    v_mfma_f32_16x16x32_bf16 v[108:111], v[196:199], a[236:239], v[108:111]
    ds_read_b64_tr_b16 v[216:217], v220 offset:61440
    s_mov_b32 s51, 10240
    v_mfma_f32_16x16x32_bf16 v[104:107], v[196:199], a[232:235], v[104:107]
    buffer_load_dwordx4 a[80:83], v1, s[20:23], s51 offen sc1
    v_mfma_f32_16x16x32_bf16 v[100:103], v[196:199], a[228:231], v[100:103]
    ds_read_b64_tr_b16 v[218:219], v220 offset:61952
    v_mfma_f32_16x16x32_bf16 v[96:99], v[196:199], a[224:227], v[96:99]
    s_waitcnt lgkmcnt(8)
    v_mfma_f32_16x16x32_bf16 v[80:83], v[200:203], a[240:243], v[80:83]
    ds_read_b64_tr_b16 v[192:193], v231 offset:0
    v_mfma_f32_16x16x32_bf16 v[84:87], v[200:203], a[244:247], v[84:87]
    buffer_load_dwordx4 a[84:87], v242, s[20:23], s51 offen sc1
    v_mfma_f32_16x16x32_bf16 v[88:91], v[200:203], a[248:251], v[88:91]
    ds_read_b64_tr_b16 v[194:195], v231 offset:512
    v_mfma_f32_16x16x32_bf16 v[92:95], v[200:203], a[252:255], v[92:95]
    s_waitcnt lgkmcnt(8)
    v_mfma_f32_16x16x32_bf16 v[108:111], v[204:207], a[252:255], v[108:111]
    ds_read_b64_tr_b16 v[196:197], v221 offset:20480
    s_mov_b32 s51, 15360
    v_mfma_f32_16x16x32_bf16 v[104:107], v[204:207], a[248:251], v[104:107]
    buffer_load_dwordx4 a[88:91], v1, s[20:23], s51 offen sc1
    v_mfma_f32_16x16x32_bf16 v[100:103], v[204:207], a[244:247], v[100:103]
    ds_read_b64_tr_b16 v[198:199], v221 offset:20992
    v_mfma_f32_16x16x32_bf16 v[96:99], v[204:207], a[240:243], v[96:99]
    s_waitcnt lgkmcnt(8)
    v_mfma_f32_16x16x32_bf16 v[80:83], v[208:211], v[16:19], v[80:83]
    ds_read_b64_tr_b16 v[200:201], v221 offset:24576
    v_mfma_f32_16x16x32_bf16 v[84:87], v[208:211], v[20:23], v[84:87]
    buffer_load_dwordx4 a[92:95], v242, s[20:23], s51 offen sc1
    v_mfma_f32_16x16x32_bf16 v[88:91], v[208:211], v[24:27], v[88:91]
    ds_read_b64_tr_b16 v[202:203], v221 offset:25088
    v_mfma_f32_16x16x32_bf16 v[92:95], v[208:211], v[28:31], v[92:95]
    s_waitcnt lgkmcnt(8)
    v_mfma_f32_16x16x32_bf16 v[108:111], v[212:215], v[28:31], v[108:111]
    ds_read_b64_tr_b16 v[204:205], v221 offset:28672
    v_mfma_f32_16x16x32_bf16 v[104:107], v[212:215], v[24:27], v[104:107]
    v_mfma_f32_16x16x32_bf16 v[100:103], v[212:215], v[20:23], v[100:103]
    ds_read_b64_tr_b16 v[206:207], v221 offset:29184
    v_mfma_f32_16x16x32_bf16 v[96:99], v[212:215], v[16:19], v[96:99]
    s_waitcnt lgkmcnt(8)
    v_mfma_f32_16x16x32_bf16 v[80:83], v[216:219], v[32:35], v[80:83]
    ds_read_b64_tr_b16 v[208:209], v221 offset:32768
    s_mov_b32 s51, 19456
    v_mfma_f32_16x16x32_bf16 v[84:87], v[216:219], v[36:39], v[84:87]
    buffer_load_dwordx4 a[96:99], v1, s[20:23], s51 offen sc1
    v_mfma_f32_16x16x32_bf16 v[88:91], v[216:219], v[40:43], v[88:91]
    ds_read_b64_tr_b16 v[210:211], v221 offset:33280
    v_mfma_f32_16x16x32_bf16 v[92:95], v[216:219], v[44:47], v[92:95]
    s_waitcnt lgkmcnt(8)
    v_mfma_f32_16x16x32_bf16 v[108:111], v[192:195], v[44:47], v[108:111]
    ds_read_b64_tr_b16 v[212:213], v221 offset:36864
    v_mfma_f32_16x16x32_bf16 v[104:107], v[192:195], v[40:43], v[104:107]
    buffer_load_dwordx4 a[100:103], v242, s[20:23], s51 offen sc1
    v_mfma_f32_16x16x32_bf16 v[100:103], v[192:195], v[36:39], v[100:103]
    ds_read_b64_tr_b16 v[214:215], v221 offset:37376
    v_mfma_f32_16x16x32_bf16 v[96:99], v[192:195], v[32:35], v[96:99]
    s_waitcnt lgkmcnt(8)
    v_mfma_f32_16x16x32_bf16 v[112:115], v[196:199], a[192:195], v[112:115]
    ds_read_b64_tr_b16 v[216:217], v221 offset:40960
    s_mov_b32 s51, 24576
    v_mfma_f32_16x16x32_bf16 v[116:119], v[196:199], a[196:199], v[116:119]
    buffer_load_dwordx4 a[104:107], v1, s[20:23], s51 offen sc1
    v_mfma_f32_16x16x32_bf16 v[120:123], v[196:199], a[200:203], v[120:123]
    ds_read_b64_tr_b16 v[218:219], v221 offset:41472
    v_mfma_f32_16x16x32_bf16 v[124:127], v[196:199], a[204:207], v[124:127]
    s_waitcnt lgkmcnt(8)
    v_mfma_f32_16x16x32_bf16 v[140:143], v[200:203], a[204:207], v[140:143]
    ds_read_b64_tr_b16 v[192:193], v221 offset:45056
    v_max_f32 v232, 0, v80
    v_mfma_f32_16x16x32_bf16 v[136:139], v[200:203], a[200:203], v[136:139]
    buffer_load_dwordx4 a[108:111], v242, s[20:23], s51 offen sc1
    v_mfma_f32_16x16x32_bf16 v[132:135], v[200:203], a[196:199], v[132:135]
    ds_read_b64_tr_b16 v[194:195], v221 offset:45568
    v_max_f32 v233, 0, v81
    v_mfma_f32_16x16x32_bf16 v[128:131], v[200:203], a[192:195], v[128:131]
    v_max_f32 v234, 0, v82
    s_waitcnt lgkmcnt(8)
    v_mfma_f32_16x16x32_bf16 v[112:115], v[204:207], a[208:211], v[112:115]
    ds_read_b64_tr_b16 v[196:197], v221 offset:49152
    v_max_f32 v235, 0, v83
    v_mfma_f32_16x16x32_bf16 v[116:119], v[204:207], a[212:215], v[116:119]
    v_mul_f32 v232, v232, v96
    v_mul_f32 v233, v233, v97
    v_mfma_f32_16x16x32_bf16 v[120:123], v[204:207], a[216:219], v[120:123]
    ds_read_b64_tr_b16 v[198:199], v221 offset:49664
    v_mul_f32 v234, v234, v98
    v_mfma_f32_16x16x32_bf16 v[124:127], v[204:207], a[220:223], v[124:127]
    v_mul_f32 v235, v235, v99
    s_waitcnt lgkmcnt(8)
    v_mfma_f32_16x16x32_bf16 v[140:143], v[208:211], a[220:223], v[140:143]
    ds_read_b64_tr_b16 v[200:201], v221 offset:53248
    s_mov_b32 s51, 28672
    v_mfma_f32_16x16x32_bf16 v[136:139], v[208:211], a[216:219], v[136:139]
    buffer_load_dwordx4 a[112:115], v1, s[20:23], s51 offen sc1
    v_mfma_f32_16x16x32_bf16 v[132:135], v[208:211], a[212:215], v[132:135]
    ds_read_b64_tr_b16 v[202:203], v221 offset:53760
    v_cvt_pk_bf16_f32 v176, v232, v233
    v_mfma_f32_16x16x32_bf16 v[128:131], v[208:211], a[208:211], v[128:131]
    v_cvt_pk_bf16_f32 v177, v234, v235
    s_waitcnt lgkmcnt(8)
    v_mfma_f32_16x16x32_bf16 v[112:115], v[212:215], a[224:227], v[112:115]
    ds_read_b64_tr_b16 v[204:205], v221 offset:57344
    v_max_f32 v232, 0, v84
    v_mfma_f32_16x16x32_bf16 v[116:119], v[212:215], a[228:231], v[116:119]
    buffer_load_dwordx4 a[116:119], v242, s[20:23], s51 offen sc1
    v_mfma_f32_16x16x32_bf16 v[120:123], v[212:215], a[232:235], v[120:123]
    ds_read_b64_tr_b16 v[206:207], v221 offset:57856
    v_max_f32 v233, 0, v85
    v_mfma_f32_16x16x32_bf16 v[124:127], v[212:215], a[236:239], v[124:127]
    v_max_f32 v234, 0, v86
    s_waitcnt lgkmcnt(8)
    v_mfma_f32_16x16x32_bf16 v[140:143], v[216:219], a[236:239], v[140:143]
    ds_read_b64_tr_b16 v[208:209], v221 offset:61440
    s_mov_b32 s51, 33792
    v_mfma_f32_16x16x32_bf16 v[136:139], v[216:219], a[232:235], v[136:139]
    buffer_load_dwordx4 a[120:123], v1, s[20:23], s51 offen sc1
    v_mfma_f32_16x16x32_bf16 v[132:135], v[216:219], a[228:231], v[132:135]
    ds_read_b64_tr_b16 v[210:211], v221 offset:61952
    v_max_f32 v235, 0, v87
    v_mfma_f32_16x16x32_bf16 v[128:131], v[216:219], a[224:227], v[128:131]
    v_mul_f32 v232, v232, v100
    s_waitcnt lgkmcnt(8)
    v_mfma_f32_16x16x32_bf16 v[112:115], v[192:195], a[240:243], v[112:115]
    ds_read_b64_tr_b16 v[212:213], v245 offset:0
    v_mul_f32 v233, v233, v101
    v_mfma_f32_16x16x32_bf16 v[116:119], v[192:195], a[244:247], v[116:119]
    buffer_load_dwordx4 a[124:127], v242, s[20:23], s51 offen sc1
    v_mfma_f32_16x16x32_bf16 v[120:123], v[192:195], a[248:251], v[120:123]
    ds_read_b64_tr_b16 v[214:215], v245 offset:512
    v_mul_f32 v234, v234, v102
    v_mfma_f32_16x16x32_bf16 v[124:127], v[192:195], a[252:255], v[124:127]
    v_mul_f32 v235, v235, v103
    s_waitcnt lgkmcnt(8)
    v_mfma_f32_16x16x32_bf16 v[140:143], v[196:199], a[252:255], v[140:143]
    ds_read_b64_tr_b16 v[216:217], v222 offset:20480
    v_cvt_pk_bf16_f32 v180, v232, v233
    v_mfma_f32_16x16x32_bf16 v[136:139], v[196:199], a[248:251], v[136:139]
    v_cvt_pk_bf16_f32 v181, v234, v235
    v_max_f32 v232, 0, v88
    v_mfma_f32_16x16x32_bf16 v[132:135], v[196:199], a[244:247], v[132:135]
    ds_read_b64_tr_b16 v[218:219], v222 offset:20992
    v_max_f32 v233, 0, v89
    v_mfma_f32_16x16x32_bf16 v[128:131], v[196:199], a[240:243], v[128:131]
    v_max_f32 v234, 0, v90
    s_waitcnt lgkmcnt(8)
    v_mfma_f32_16x16x32_bf16 v[112:115], v[200:203], v[16:19], v[112:115]
    ds_read_b64_tr_b16 v[192:193], v222 offset:24576
    s_mov_b32 s51, 4096
    v_mfma_f32_16x16x32_bf16 v[116:119], v[200:203], v[20:23], v[116:119]
    buffer_load_dwordx2 a[128:129], v243, s[20:23], s51 offen sc1
    v_mfma_f32_16x16x32_bf16 v[120:123], v[200:203], v[24:27], v[120:123]
    ds_read_b64_tr_b16 v[194:195], v222 offset:25088
    v_max_f32 v235, 0, v91
    v_mfma_f32_16x16x32_bf16 v[124:127], v[200:203], v[28:31], v[124:127]
    v_mul_f32 v232, v232, v104
    s_waitcnt lgkmcnt(8)
    v_mfma_f32_16x16x32_bf16 v[140:143], v[204:207], v[28:31], v[140:143]
    ds_read_b64_tr_b16 v[196:197], v222 offset:28672
    v_mul_f32 v233, v233, v105
    v_mfma_f32_16x16x32_bf16 v[136:139], v[204:207], v[24:27], v[136:139]
    buffer_load_dwordx2 a[130:131], v243, s[20:23], s51 offen offset:512 sc1
    v_mfma_f32_16x16x32_bf16 v[132:135], v[204:207], v[20:23], v[132:135]
    ds_read_b64_tr_b16 v[198:199], v222 offset:29184
    v_mul_f32 v234, v234, v106
    v_mfma_f32_16x16x32_bf16 v[128:131], v[204:207], v[16:19], v[128:131]
    v_mul_f32 v235, v235, v107
    s_waitcnt lgkmcnt(8)
    v_mfma_f32_16x16x32_bf16 v[112:115], v[208:211], v[32:35], v[112:115]
    ds_read_b64_tr_b16 v[200:201], v222 offset:32768
    v_cvt_pk_bf16_f32 v184, v232, v233
    v_mfma_f32_16x16x32_bf16 v[116:119], v[208:211], v[36:39], v[116:119]
    buffer_load_dwordx2 a[132:133], v244, s[20:23], s51 offen sc1
    v_mfma_f32_16x16x32_bf16 v[120:123], v[208:211], v[40:43], v[120:123]
    ds_read_b64_tr_b16 v[202:203], v222 offset:33280
    v_cvt_pk_bf16_f32 v185, v234, v235
    v_mfma_f32_16x16x32_bf16 v[124:127], v[208:211], v[44:47], v[124:127]
    v_max_f32 v232, 0, v92
    s_waitcnt lgkmcnt(8)
    v_mfma_f32_16x16x32_bf16 v[140:143], v[212:215], v[44:47], v[140:143]
    ds_read_b64_tr_b16 v[204:205], v222 offset:36864
    v_max_f32 v233, 0, v93
    v_mfma_f32_16x16x32_bf16 v[136:139], v[212:215], v[40:43], v[136:139]
    buffer_load_dwordx2 a[134:135], v244, s[20:23], s51 offen offset:512 sc1
    v_mfma_f32_16x16x32_bf16 v[132:135], v[212:215], v[36:39], v[132:135]
    ds_read_b64_tr_b16 v[206:207], v222 offset:37376
    v_max_f32 v234, 0, v94
    v_mfma_f32_16x16x32_bf16 v[128:131], v[212:215], v[32:35], v[128:131]
    v_max_f32 v235, 0, v95
    s_waitcnt lgkmcnt(8)
    v_mfma_f32_16x16x32_bf16 v[144:147], v[216:219], a[192:195], v[144:147]
    ds_read_b64_tr_b16 v[208:209], v222 offset:40960
    v_mul_f32 v232, v232, v108
    v_mfma_f32_16x16x32_bf16 v[148:151], v[216:219], a[196:199], v[148:151]
    v_mul_f32 v233, v233, v109
    v_mul_f32 v234, v234, v110
    v_mfma_f32_16x16x32_bf16 v[152:155], v[216:219], a[200:203], v[152:155]
    ds_read_b64_tr_b16 v[210:211], v222 offset:41472
    v_mul_f32 v235, v235, v111
    v_mfma_f32_16x16x32_bf16 v[156:159], v[216:219], a[204:207], v[156:159]
    v_cvt_pk_bf16_f32 v188, v232, v233
    s_waitcnt lgkmcnt(8)
    v_mfma_f32_16x16x32_bf16 v[172:175], v[192:195], a[204:207], v[172:175]
    ds_read_b64_tr_b16 v[212:213], v222 offset:45056
    s_mov_b32 s51, 13312
    v_mfma_f32_16x16x32_bf16 v[168:171], v[192:195], a[200:203], v[168:171]
    buffer_load_dwordx2 a[136:137], v243, s[20:23], s51 offen sc1
    v_mfma_f32_16x16x32_bf16 v[164:167], v[192:195], a[196:199], v[164:167]
    ds_read_b64_tr_b16 v[214:215], v222 offset:45568
    v_cvt_pk_bf16_f32 v189, v234, v235
    v_mfma_f32_16x16x32_bf16 v[160:163], v[192:195], a[192:195], v[160:163]
    v_max_f32 v232, 0, v112
    s_waitcnt lgkmcnt(8)
    v_mfma_f32_16x16x32_bf16 v[144:147], v[196:199], a[208:211], v[144:147]
    ds_read_b64_tr_b16 v[216:217], v222 offset:49152
    v_max_f32 v233, 0, v113
    v_mfma_f32_16x16x32_bf16 v[148:151], v[196:199], a[212:215], v[148:151]
    buffer_load_dwordx2 a[138:139], v243, s[20:23], s51 offen offset:512 sc1
    v_mfma_f32_16x16x32_bf16 v[152:155], v[196:199], a[216:219], v[152:155]
    ds_read_b64_tr_b16 v[218:219], v222 offset:49664
    v_max_f32 v234, 0, v114
    v_mfma_f32_16x16x32_bf16 v[156:159], v[196:199], a[220:223], v[156:159]
    v_max_f32 v235, 0, v115
    s_waitcnt lgkmcnt(8)
    v_mfma_f32_16x16x32_bf16 v[172:175], v[200:203], a[220:223], v[172:175]
    ds_read_b64_tr_b16 v[192:193], v222 offset:53248
    v_mul_f32 v232, v232, v128
    v_mfma_f32_16x16x32_bf16 v[168:171], v[200:203], a[216:219], v[168:171]
    buffer_load_dwordx2 a[140:141], v244, s[20:23], s51 offen sc1
    v_mfma_f32_16x16x32_bf16 v[164:167], v[200:203], a[212:215], v[164:167]
    ds_read_b64_tr_b16 v[194:195], v222 offset:53760
    v_mul_f32 v233, v233, v129
    v_mfma_f32_16x16x32_bf16 v[160:163], v[200:203], a[208:211], v[160:163]
    v_mul_f32 v234, v234, v130
    s_waitcnt lgkmcnt(8)
    v_mfma_f32_16x16x32_bf16 v[144:147], v[204:207], a[224:227], v[144:147]
    ds_read_b64_tr_b16 v[196:197], v222 offset:57344
    v_mul_f32 v235, v235, v131
    v_mfma_f32_16x16x32_bf16 v[148:151], v[204:207], a[228:231], v[148:151]
    buffer_load_dwordx2 a[142:143], v244, s[20:23], s51 offen offset:512 sc1
    v_mfma_f32_16x16x32_bf16 v[152:155], v[204:207], a[232:235], v[152:155]
    ds_read_b64_tr_b16 v[198:199], v222 offset:57856
    v_cvt_pk_bf16_f32 v178, v232, v233
    v_mfma_f32_16x16x32_bf16 v[156:159], v[204:207], a[236:239], v[156:159]
    v_cvt_pk_bf16_f32 v179, v234, v235
    s_waitcnt lgkmcnt(8)
    v_mfma_f32_16x16x32_bf16 v[172:175], v[208:211], a[236:239], v[172:175]
    ds_read_b64_tr_b16 v[200:201], v222 offset:61440
    buffer_store_dwordx4 v[176:179], v9, s[16:19], 0 offen offset:2048 sc1
    v_mfma_f32_16x16x32_bf16 v[168:171], v[208:211], a[232:235], v[168:171]
    v_max_f32 v232, 0, v116
    v_max_f32 v233, 0, v117
    v_mfma_f32_16x16x32_bf16 v[164:167], v[208:211], a[228:231], v[164:167]
    ds_read_b64_tr_b16 v[202:203], v222 offset:61952
    v_max_f32 v234, 0, v118
    v_mfma_f32_16x16x32_bf16 v[160:163], v[208:211], a[224:227], v[160:163]
    v_max_f32 v235, 0, v119
    s_waitcnt lgkmcnt(8)
    v_mfma_f32_16x16x32_bf16 v[144:147], v[212:215], a[240:243], v[144:147]
    ds_read_b64_tr_b16 v[204:205], v252 offset:0
    s_mov_b32 s51, 22528
    v_mfma_f32_16x16x32_bf16 v[148:151], v[212:215], a[244:247], v[148:151]
    buffer_load_dwordx2 a[144:145], v243, s[20:23], s51 offen sc1
    v_mfma_f32_16x16x32_bf16 v[152:155], v[212:215], a[248:251], v[152:155]
    ds_read_b64_tr_b16 v[206:207], v252 offset:512
    v_mul_f32 v232, v232, v132
    v_mfma_f32_16x16x32_bf16 v[156:159], v[212:215], a[252:255], v[156:159]
    v_mul_f32 v233, v233, v133
    s_waitcnt lgkmcnt(8)
    v_mfma_f32_16x16x32_bf16 v[172:175], v[216:219], a[252:255], v[172:175]
    ds_read_b64_tr_b16 v[208:209], v223 offset:20480
    v_mul_f32 v234, v234, v134
    v_mfma_f32_16x16x32_bf16 v[168:171], v[216:219], a[248:251], v[168:171]
    buffer_load_dwordx2 a[146:147], v243, s[20:23], s51 offen offset:512 sc1
    v_mfma_f32_16x16x32_bf16 v[164:167], v[216:219], a[244:247], v[164:167]
    ds_read_b64_tr_b16 v[210:211], v223 offset:20992
    v_mul_f32 v235, v235, v135
    v_mfma_f32_16x16x32_bf16 v[160:163], v[216:219], a[240:243], v[160:163]
    v_cvt_pk_bf16_f32 v182, v232, v233
    s_waitcnt lgkmcnt(8)
    v_mfma_f32_16x16x32_bf16 v[144:147], v[192:195], v[16:19], v[144:147]
    ds_read_b64_tr_b16 v[212:213], v223 offset:24576
    v_cvt_pk_bf16_f32 v183, v234, v235
    v_mfma_f32_16x16x32_bf16 v[148:151], v[192:195], v[20:23], v[148:151]
    buffer_load_dwordx2 a[148:149], v244, s[20:23], s51 offen sc1
    v_mfma_f32_16x16x32_bf16 v[152:155], v[192:195], v[24:27], v[152:155]
    ds_read_b64_tr_b16 v[214:215], v223 offset:25088
    buffer_store_dwordx4 v[180:183], v10, s[16:19], 0 offen offset:2048 sc1
    v_mfma_f32_16x16x32_bf16 v[156:159], v[192:195], v[28:31], v[156:159]
    v_max_f32 v232, 0, v120
    s_waitcnt lgkmcnt(8)
    v_mfma_f32_16x16x32_bf16 v[172:175], v[196:199], v[28:31], v[172:175]
    ds_read_b64_tr_b16 v[216:217], v223 offset:28672
    v_max_f32 v233, 0, v121
    v_mfma_f32_16x16x32_bf16 v[168:171], v[196:199], v[24:27], v[168:171]
    buffer_load_dwordx2 a[150:151], v244, s[20:23], s51 offen offset:512 sc1
    v_mfma_f32_16x16x32_bf16 v[164:167], v[196:199], v[20:23], v[164:167]
    ds_read_b64_tr_b16 v[218:219], v223 offset:29184
    v_max_f32 v234, 0, v122
    v_mfma_f32_16x16x32_bf16 v[160:163], v[196:199], v[16:19], v[160:163]
    v_max_f32 v235, 0, v123
    s_waitcnt lgkmcnt(8)
    v_mfma_f32_16x16x32_bf16 v[144:147], v[200:203], v[32:35], v[144:147]
    ds_read_b64_tr_b16 v[192:193], v223 offset:32768
    v_mul_f32 v232, v232, v136
    v_mfma_f32_16x16x32_bf16 v[148:151], v[200:203], v[36:39], v[148:151]
    v_mul_f32 v233, v233, v137
    v_mul_f32 v234, v234, v138
    v_mfma_f32_16x16x32_bf16 v[152:155], v[200:203], v[40:43], v[152:155]
    ds_read_b64_tr_b16 v[194:195], v223 offset:33280
    v_mul_f32 v235, v235, v139
    v_mfma_f32_16x16x32_bf16 v[156:159], v[200:203], v[44:47], v[156:159]
    v_cvt_pk_bf16_f32 v186, v232, v233
    s_waitcnt lgkmcnt(8)
    v_mfma_f32_16x16x32_bf16 v[172:175], v[204:207], v[44:47], v[172:175]
    ds_read_b64_tr_b16 v[196:197], v223 offset:36864
    s_mov_b32 s51, 31744
    v_mfma_f32_16x16x32_bf16 v[168:171], v[204:207], v[40:43], v[168:171]
    buffer_load_dwordx2 a[152:153], v243, s[20:23], s51 offen sc1
    v_mfma_f32_16x16x32_bf16 v[164:167], v[204:207], v[36:39], v[164:167]
    ds_read_b64_tr_b16 v[198:199], v223 offset:37376
    v_cvt_pk_bf16_f32 v187, v234, v235
    v_mfma_f32_16x16x32_bf16 v[160:163], v[204:207], v[32:35], v[160:163]
    buffer_store_dwordx4 v[184:187], v11, s[16:19], 0 offen offset:2048 sc1
    s_waitcnt lgkmcnt(8)
    v_mfma_f32_16x16x32_bf16 v[48:51], v[208:211], a[192:195], v[48:51]
    ds_read_b64_tr_b16 v[200:201], v223 offset:40960
    v_max_f32 v232, 0, v124
    v_mfma_f32_16x16x32_bf16 v[52:55], v[208:211], a[196:199], v[52:55]
    buffer_load_dwordx2 a[154:155], v243, s[20:23], s51 offen offset:512 sc1
    v_mfma_f32_16x16x32_bf16 v[56:59], v[208:211], a[200:203], v[56:59]
    ds_read_b64_tr_b16 v[202:203], v223 offset:41472
    v_max_f32 v233, 0, v125
    v_mfma_f32_16x16x32_bf16 v[60:63], v[208:211], a[204:207], v[60:63]
    v_max_f32 v234, 0, v126
    s_waitcnt lgkmcnt(8)
    v_mfma_f32_16x16x32_bf16 v[76:79], v[212:215], a[204:207], v[76:79]
    ds_read_b64_tr_b16 v[204:205], v223 offset:45056
    v_max_f32 v235, 0, v127
    v_mfma_f32_16x16x32_bf16 v[72:75], v[212:215], a[200:203], v[72:75]
    buffer_load_dwordx2 a[156:157], v244, s[20:23], s51 offen sc1
    v_mfma_f32_16x16x32_bf16 v[68:71], v[212:215], a[196:199], v[68:71]
    ds_read_b64_tr_b16 v[206:207], v223 offset:45568
    v_mul_f32 v232, v232, v140
    v_mfma_f32_16x16x32_bf16 v[64:67], v[212:215], a[192:195], v[64:67]
    v_mul_f32 v233, v233, v141
    s_waitcnt lgkmcnt(8)
    v_mfma_f32_16x16x32_bf16 v[48:51], v[216:219], a[208:211], v[48:51]
    ds_read_b64_tr_b16 v[208:209], v223 offset:49152
    v_mul_f32 v234, v234, v142
    v_mfma_f32_16x16x32_bf16 v[52:55], v[216:219], a[212:215], v[52:55]
    buffer_load_dwordx2 a[158:159], v244, s[20:23], s51 offen offset:512 sc1
    v_mfma_f32_16x16x32_bf16 v[56:59], v[216:219], a[216:219], v[56:59]
    ds_read_b64_tr_b16 v[210:211], v223 offset:49664
    v_mul_f32 v235, v235, v143
    v_mfma_f32_16x16x32_bf16 v[60:63], v[216:219], a[220:223], v[60:63]
    v_cvt_pk_bf16_f32 v190, v232, v233
    s_waitcnt lgkmcnt(8)
    v_mfma_f32_16x16x32_bf16 v[76:79], v[192:195], a[220:223], v[76:79]
    ds_read_b64_tr_b16 v[212:213], v223 offset:53248
    v_cvt_pk_bf16_f32 v191, v234, v235
    v_mfma_f32_16x16x32_bf16 v[72:75], v[192:195], a[216:219], v[72:75]
    buffer_store_dwordx4 v[188:191], v12, s[16:19], 0 offen offset:2048 sc1
    v_max_f32 v232, 0, v144
    v_mfma_f32_16x16x32_bf16 v[68:71], v[192:195], a[212:215], v[68:71]
    ds_read_b64_tr_b16 v[214:215], v223 offset:53760
    v_max_f32 v233, 0, v145
    v_mfma_f32_16x16x32_bf16 v[64:67], v[192:195], a[208:211], v[64:67]
    v_max_f32 v234, 0, v146
    s_waitcnt lgkmcnt(8)
    v_mfma_f32_16x16x32_bf16 v[48:51], v[196:199], a[224:227], v[48:51]
    ds_read_b64_tr_b16 v[216:217], v223 offset:57344
    v_max_f32 v235, 0, v147
    v_mfma_f32_16x16x32_bf16 v[52:55], v[196:199], a[228:231], v[52:55]
    v_mul_f32 v232, v232, v160
    v_mul_f32 v233, v233, v161
    v_mfma_f32_16x16x32_bf16 v[56:59], v[196:199], a[232:235], v[56:59]
    ds_read_b64_tr_b16 v[218:219], v223 offset:57856
    v_mul_f32 v234, v234, v162
    v_mfma_f32_16x16x32_bf16 v[60:63], v[196:199], a[236:239], v[60:63]
    v_mul_f32 v235, v235, v163
    s_waitcnt lgkmcnt(8)
    v_mfma_f32_16x16x32_bf16 v[76:79], v[200:203], a[236:239], v[76:79]
    ds_read_b64_tr_b16 v[192:193], v223 offset:61440
    v_cvt_pk_bf16_f32 v176, v232, v233
    v_mfma_f32_16x16x32_bf16 v[72:75], v[200:203], a[232:235], v[72:75]
    v_cvt_pk_bf16_f32 v177, v234, v235
    v_max_f32 v232, 0, v148
    v_mfma_f32_16x16x32_bf16 v[68:71], v[200:203], a[228:231], v[68:71]
    ds_read_b64_tr_b16 v[194:195], v223 offset:61952
    v_max_f32 v233, 0, v149
    v_mfma_f32_16x16x32_bf16 v[64:67], v[200:203], a[224:227], v[64:67]
    v_max_f32 v234, 0, v150
    s_waitcnt lgkmcnt(8)
    v_mfma_f32_16x16x32_bf16 v[48:51], v[204:207], a[240:243], v[48:51]
    ds_read_b64_tr_b16 v[196:197], v0 offset:0
    v_max_f32 v235, 0, v151
    v_mfma_f32_16x16x32_bf16 v[52:55], v[204:207], a[244:247], v[52:55]
    v_mul_f32 v232, v232, v164
    v_mul_f32 v233, v233, v165
    v_mfma_f32_16x16x32_bf16 v[56:59], v[204:207], a[248:251], v[56:59]
    ds_read_b64_tr_b16 v[198:199], v0 offset:512
    v_mul_f32 v234, v234, v166
    v_mfma_f32_16x16x32_bf16 v[60:63], v[204:207], a[252:255], v[60:63]
    v_mul_f32 v235, v235, v167
    s_waitcnt lgkmcnt(8)
    v_mfma_f32_16x16x32_bf16 v[76:79], v[208:211], a[252:255], v[76:79]
    s_waitcnt vmcnt(63)
    s_barrier
    ds_read_b128 v[200:203], v8 offset:36864
    s_add_u32 m0, s48, 0
    v_mfma_f32_16x16x32_bf16 v[72:75], v[208:211], a[248:251], v[72:75]
    s_add_u32 s50, s1, 175104
    buffer_load_dwordx4 v224, s[24:27], s50 offen offset:0 sc1 lds
    v_mfma_f32_16x16x32_bf16 v[68:71], v[208:211], a[244:247], v[68:71]
    ds_read_b128 v[88:91], v8 offset:44032
    v_cvt_pk_bf16_f32 v180, v232, v233
    v_mfma_f32_16x16x32_bf16 v[64:67], v[208:211], a[240:243], v[64:67]
    v_cvt_pk_bf16_f32 v181, v234, v235
    s_waitcnt lgkmcnt(8)
    v_mfma_f32_16x16x32_bf16 v[48:51], v[212:215], v[16:19], v[48:51]
    ds_read_b128 v[204:207], v8 offset:37888
    s_add_u32 m0, s48, 1024
    v_mfma_f32_16x16x32_bf16 v[52:55], v[212:215], v[20:23], v[52:55]
    buffer_load_dwordx4 v225, s[24:27], s50 offen offset:0 sc1 lds
    v_mfma_f32_16x16x32_bf16 v[56:59], v[212:215], v[24:27], v[56:59]
    ds_read_b128 v[92:95], v8 offset:45056
    v_max_f32 v232, 0, v152
    v_mfma_f32_16x16x32_bf16 v[60:63], v[212:215], v[28:31], v[60:63]
    v_max_f32 v233, 0, v153
    s_waitcnt lgkmcnt(8)
    v_mfma_f32_16x16x32_bf16 v[76:79], v[216:219], v[28:31], v[76:79]
    ds_read_b128 v[208:211], v8 offset:38912
    s_add_u32 m0, s48, 1024
    v_mfma_f32_16x16x32_bf16 v[72:75], v[216:219], v[24:27], v[72:75]
    buffer_load_dwordx4 v225, s[24:27], s50 offen offset:1024 sc1 lds
    v_mfma_f32_16x16x32_bf16 v[68:71], v[216:219], v[20:23], v[68:71]
    ds_read_b128 v[96:99], v8 offset:46080
    v_max_f32 v234, 0, v154
    v_mfma_f32_16x16x32_bf16 v[64:67], v[216:219], v[16:19], v[64:67]
    v_max_f32 v235, 0, v155
    s_waitcnt lgkmcnt(8)
    v_mfma_f32_16x16x32_bf16 v[48:51], v[192:195], v[32:35], v[48:51]
    ds_read_b128 v[212:215], v8 offset:39936
    s_add_u32 m0, s48, 3072
    v_mfma_f32_16x16x32_bf16 v[52:55], v[192:195], v[36:39], v[52:55]
    buffer_load_dwordx4 v226, s[24:27], s50 offen offset:0 sc1 lds
    v_mfma_f32_16x16x32_bf16 v[56:59], v[192:195], v[40:43], v[56:59]
    ds_read_b128 v[100:103], v8 offset:47104
    v_mul_f32 v232, v232, v168
    v_mfma_f32_16x16x32_bf16 v[60:63], v[192:195], v[44:47], v[60:63]
    v_mul_f32 v233, v233, v169
    s_waitcnt lgkmcnt(8)
    v_mfma_f32_16x16x32_bf16 v[76:79], v[196:199], v[44:47], v[76:79]
    ds_read_b128 v[216:219], v8 offset:40960
    s_add_u32 m0, s48, 3072
    v_mfma_f32_16x16x32_bf16 v[72:75], v[196:199], v[40:43], v[72:75]
    buffer_load_dwordx4 v226, s[24:27], s50 offen offset:1024 sc1 lds
    v_mfma_f32_16x16x32_bf16 v[68:71], v[196:199], v[36:39], v[68:71]
    ds_read_b128 v[104:107], v8 offset:48128
    v_mul_f32 v234, v234, v170
    v_mfma_f32_16x16x32_bf16 v[64:67], v[196:199], v[32:35], v[64:67]
    v_mul_f32 v235, v235, v171
L_g_p2:
    s_waitcnt vmcnt(63)
    s_waitcnt lgkmcnt(8)
    v_mfma_f32_16x16x32_bf16 v[112:115], v[200:203], a[0:3], 0
    ds_read_b128 v[192:195], v8 offset:41984
    s_add_u32 m0, s48, 5120
    v_mfma_f32_16x16x32_bf16 v[112:115], v[88:91], a[8:11], v[112:115]
    buffer_load_dwordx4 v227, s[24:27], s50 offen offset:0 sc1 lds
    v_mfma_f32_16x16x32_bf16 v[116:119], v[88:91], a[12:15], 0
    ds_read_b128 v[80:83], v8 offset:49152
    v_cvt_pk_bf16_f32 v184, v232, v233
    v_mfma_f32_16x16x32_bf16 v[116:119], v[200:203], a[4:7], v[116:119]
    v_cvt_pk_bf16_f32 v185, v234, v235
    s_waitcnt lgkmcnt(8)
    v_mfma_f32_16x16x32_bf16 v[120:123], v[204:207], a[0:3], 0
    ds_read_b128 v[196:199], v8 offset:43008
    v_max_f32 v232, 0, v156
    v_mfma_f32_16x16x32_bf16 v[120:123], v[92:95], a[8:11], v[120:123]
    v_max_f32 v233, 0, v157
    v_max_f32 v234, 0, v158
    v_mfma_f32_16x16x32_bf16 v[124:127], v[92:95], a[12:15], 0
    ds_read_b128 v[84:87], v8 offset:50176
    v_max_f32 v235, 0, v159
    v_mfma_f32_16x16x32_bf16 v[124:127], v[204:207], a[4:7], v[124:127]
    v_mul_f32 v232, v232, v172
    s_waitcnt lgkmcnt(8)
    v_mfma_f32_16x16x32_bf16 v[128:131], v[208:211], a[0:3], 0
    s_waitcnt vmcnt(62)
    s_barrier
    ds_read_b128 v[200:203], v8 offset:51200
    s_add_u32 m0, s48, 5120
    v_mfma_f32_16x16x32_bf16 v[128:131], v[96:99], a[8:11], v[128:131]
    buffer_load_dwordx4 v227, s[24:27], s50 offen offset:1024 sc1 lds
    v_mfma_f32_16x16x32_bf16 v[132:135], v[96:99], a[12:15], 0
    ds_read_b128 v[88:91], v8 offset:58368
    v_mul_f32 v233, v233, v173
    v_mfma_f32_16x16x32_bf16 v[132:135], v[208:211], a[4:7], v[132:135]
    v_mul_f32 v234, v234, v174
    s_waitcnt lgkmcnt(8)
    v_mfma_f32_16x16x32_bf16 v[136:139], v[212:215], a[0:3], 0
    ds_read_b128 v[204:207], v8 offset:52224
    s_add_u32 m0, s48, 28672
    v_mfma_f32_16x16x32_bf16 v[136:139], v[100:103], a[8:11], v[136:139]
    s_add_u32 s50, s0, 36864
    buffer_load_dwordx4 v224, s[24:27], s50 offen offset:0 sc1 lds
    v_mfma_f32_16x16x32_bf16 v[140:143], v[100:103], a[12:15], 0
    ds_read_b128 v[92:95], v8 offset:59392
    v_mul_f32 v235, v235, v175
    v_mfma_f32_16x16x32_bf16 v[140:143], v[212:215], a[4:7], v[140:143]
    v_cvt_pk_bf16_f32 v188, v232, v233
    v_cvt_pk_bf16_f32 v189, v234, v235
    s_waitcnt lgkmcnt(8)
    v_mfma_f32_16x16x32_bf16 v[144:147], v[216:219], a[0:3], 0
    ds_read_b128 v[208:211], v8 offset:53248
    s_add_u32 m0, s48, 29696
    v_mfma_f32_16x16x32_bf16 v[144:147], v[104:107], a[8:11], v[144:147]
    buffer_load_dwordx4 v225, s[24:27], s50 offen offset:0 sc1 lds
    v_mfma_f32_16x16x32_bf16 v[148:151], v[104:107], a[12:15], 0
    ds_read_b128 v[96:99], v8 offset:60416
    v_max_f32 v232, 0, v48
    v_mfma_f32_16x16x32_bf16 v[148:151], v[216:219], a[4:7], v[148:151]
    v_max_f32 v233, 0, v49
    s_waitcnt lgkmcnt(8)
    v_mfma_f32_16x16x32_bf16 v[152:155], v[192:195], a[0:3], 0
    ds_read_b128 v[212:215], v8 offset:54272
    s_add_u32 m0, s48, 29696
    v_mfma_f32_16x16x32_bf16 v[152:155], v[80:83], a[8:11], v[152:155]
    buffer_load_dwordx4 v225, s[24:27], s50 offen offset:1024 sc1 lds
    v_mfma_f32_16x16x32_bf16 v[156:159], v[80:83], a[12:15], 0
    ds_read_b128 v[100:103], v8 offset:61440
    v_max_f32 v234, 0, v50
    v_mfma_f32_16x16x32_bf16 v[156:159], v[192:195], a[4:7], v[156:159]
    v_max_f32 v235, 0, v51
    s_waitcnt lgkmcnt(8)
    v_mfma_f32_16x16x32_bf16 v[160:163], v[196:199], a[0:3], 0
    ds_read_b128 v[216:219], v8 offset:55296
    v_mul_f32 v232, v232, v64
    v_mfma_f32_16x16x32_bf16 v[160:163], v[84:87], a[8:11], v[160:163]
    v_mul_f32 v233, v233, v65
    v_mul_f32 v234, v234, v66
    v_mfma_f32_16x16x32_bf16 v[164:167], v[84:87], a[12:15], 0
    ds_read_b128 v[104:107], v8 offset:62464
    v_mul_f32 v235, v235, v67
    v_mfma_f32_16x16x32_bf16 v[164:167], v[196:199], a[4:7], v[164:167]
    v_cvt_pk_bf16_f32 v178, v232, v233
    s_waitcnt vmcnt(62)
    s_waitcnt lgkmcnt(8)
    v_mfma_f32_16x16x32_bf16 v[112:115], v[200:203], a[16:19], v[112:115]
    ds_read_b128 v[192:195], v8 offset:56320
    s_add_u32 m0, s48, 31744
    v_mfma_f32_16x16x32_bf16 v[112:115], v[88:91], a[24:27], v[112:115]
    buffer_load_dwordx4 v226, s[24:27], s50 offen offset:0 sc1 lds
    v_mfma_f32_16x16x32_bf16 v[116:119], v[88:91], a[28:31], v[116:119]
    ds_read_b128 v[80:83], v8 offset:63488
    v_cvt_pk_bf16_f32 v179, v234, v235
    v_mfma_f32_16x16x32_bf16 v[116:119], v[200:203], a[20:23], v[116:119]
    buffer_store_dwordx4 v[176:179], v9, s[16:19], 0 offen offset:3072 sc1
    s_waitcnt lgkmcnt(8)
    v_mfma_f32_16x16x32_bf16 v[120:123], v[204:207], a[16:19], v[120:123]
    ds_read_b128 v[196:199], v8 offset:57344
    s_add_u32 m0, s48, 31744
    v_mfma_f32_16x16x32_bf16 v[120:123], v[92:95], a[24:27], v[120:123]
    buffer_load_dwordx4 v226, s[24:27], s50 offen offset:1024 sc1 lds
    v_mfma_f32_16x16x32_bf16 v[124:127], v[92:95], a[28:31], v[124:127]
    ds_read_b128 v[84:87], v8 offset:64512
    v_max_f32 v232, 0, v52
    v_mfma_f32_16x16x32_bf16 v[124:127], v[204:207], a[20:23], v[124:127]
    v_max_f32 v233, 0, v53
    s_waitcnt lgkmcnt(8)
    v_mfma_f32_16x16x32_bf16 v[128:131], v[208:211], a[16:19], v[128:131]
    ds_read_b128 v[200:203], v7 offset:20480
    s_add_u32 m0, s48, 33792
    v_mfma_f32_16x16x32_bf16 v[128:131], v[96:99], a[24:27], v[128:131]
    buffer_load_dwordx4 v227, s[24:27], s50 offen offset:0 sc1 lds
    v_mfma_f32_16x16x32_bf16 v[132:135], v[96:99], a[28:31], v[132:135]
    ds_read_b128 v[88:91], v7 offset:27648
    v_max_f32 v234, 0, v54
    v_mfma_f32_16x16x32_bf16 v[132:135], v[208:211], a[20:23], v[132:135]
    v_max_f32 v235, 0, v55
    s_waitcnt lgkmcnt(8)
    v_mfma_f32_16x16x32_bf16 v[136:139], v[212:215], a[16:19], v[136:139]
    ds_read_b128 v[204:207], v7 offset:21504
    s_add_u32 m0, s48, 33792
    v_mfma_f32_16x16x32_bf16 v[136:139], v[100:103], a[24:27], v[136:139]
    buffer_load_dwordx4 v227, s[24:27], s50 offen offset:1024 sc1 lds
    v_mfma_f32_16x16x32_bf16 v[140:143], v[100:103], a[28:31], v[140:143]
    ds_read_b128 v[92:95], v7 offset:28672
    v_mul_f32 v232, v232, v68
    v_mfma_f32_16x16x32_bf16 v[140:143], v[212:215], a[20:23], v[140:143]
    v_mul_f32 v233, v233, v69
    s_waitcnt lgkmcnt(8)
    v_mfma_f32_16x16x32_bf16 v[144:147], v[216:219], a[16:19], v[144:147]
    ds_read_b128 v[208:211], v7 offset:22528
    v_mul_f32 v234, v234, v70
    v_mfma_f32_16x16x32_bf16 v[144:147], v[104:107], a[24:27], v[144:147]
    v_mul_f32 v235, v235, v71
    v_cvt_pk_bf16_f32 v182, v232, v233
    v_mfma_f32_16x16x32_bf16 v[148:151], v[104:107], a[28:31], v[148:151]
    ds_read_b128 v[96:99], v7 offset:29696
    v_cvt_pk_bf16_f32 v183, v234, v235
    v_mfma_f32_16x16x32_bf16 v[148:151], v[216:219], a[20:23], v[148:151]
    buffer_store_dwordx4 v[180:183], v10, s[16:19], 0 offen offset:3072 sc1
    s_waitcnt lgkmcnt(8)
    v_mfma_f32_16x16x32_bf16 v[152:155], v[192:195], a[16:19], v[152:155]
    ds_read_b128 v[212:215], v7 offset:23552
    v_max_f32 v232, 0, v56
    v_mfma_f32_16x16x32_bf16 v[152:155], v[80:83], a[24:27], v[152:155]
    v_max_f32 v233, 0, v57
    v_max_f32 v234, 0, v58
    v_mfma_f32_16x16x32_bf16 v[156:159], v[80:83], a[28:31], v[156:159]
    ds_read_b128 v[100:103], v7 offset:30720
    v_max_f32 v235, 0, v59
    v_mfma_f32_16x16x32_bf16 v[156:159], v[192:195], a[20:23], v[156:159]
    v_mul_f32 v232, v232, v72
    s_waitcnt lgkmcnt(8)
    v_mfma_f32_16x16x32_bf16 v[160:163], v[196:199], a[16:19], v[160:163]
    ds_read_b128 v[216:219], v7 offset:24576
    v_mul_f32 v233, v233, v73
    v_mfma_f32_16x16x32_bf16 v[160:163], v[84:87], a[24:27], v[160:163]
    v_mul_f32 v234, v234, v74
    v_mul_f32 v235, v235, v75
    v_mfma_f32_16x16x32_bf16 v[164:167], v[84:87], a[28:31], v[164:167]
    ds_read_b128 v[104:107], v7 offset:31744
    v_cvt_pk_bf16_f32 v186, v232, v233
    v_mfma_f32_16x16x32_bf16 v[164:167], v[196:199], a[20:23], v[164:167]
    v_cvt_pk_bf16_f32 v187, v234, v235
    s_waitcnt vmcnt(63)
    s_waitcnt lgkmcnt(8)
    v_mfma_f32_16x16x32_bf16 v[112:115], v[200:203], a[32:35], v[112:115]
    ds_read_b128 v[192:195], v7 offset:25600
    buffer_store_dwordx4 v[184:187], v11, s[16:19], 0 offen offset:3072 sc1
    v_mfma_f32_16x16x32_bf16 v[112:115], v[88:91], a[40:43], v[112:115]
    v_max_f32 v232, 0, v60
    v_max_f32 v233, 0, v61
    v_mfma_f32_16x16x32_bf16 v[116:119], v[88:91], a[44:47], v[116:119]
    ds_read_b128 v[80:83], v7 offset:32768
    v_max_f32 v234, 0, v62
    v_mfma_f32_16x16x32_bf16 v[116:119], v[200:203], a[36:39], v[116:119]
    v_max_f32 v235, 0, v63
    s_waitcnt lgkmcnt(8)
    v_mfma_f32_16x16x32_bf16 v[120:123], v[204:207], a[32:35], v[120:123]
    ds_read_b128 v[196:199], v7 offset:26624
    v_mul_f32 v232, v232, v76
    v_mfma_f32_16x16x32_bf16 v[120:123], v[92:95], a[40:43], v[120:123]
    v_mul_f32 v233, v233, v77
    v_mul_f32 v234, v234, v78
    v_mfma_f32_16x16x32_bf16 v[124:127], v[92:95], a[44:47], v[124:127]
    ds_read_b128 v[84:87], v7 offset:33792
    v_mul_f32 v235, v235, v79
    v_mfma_f32_16x16x32_bf16 v[124:127], v[204:207], a[36:39], v[124:127]
    v_cvt_pk_bf16_f32 v190, v232, v233
    s_waitcnt lgkmcnt(8)
    v_mfma_f32_16x16x32_bf16 v[128:131], v[208:211], a[32:35], v[128:131]
    s_waitcnt vmcnt(17)
    s_barrier
    v_add_u32 v240, s53, v240
    v_mov_b32 v254, s64
    s_mov_b64 exec, 1
    global_store_dword v240, v254, s[78:79] sc1
    s_mov_b64 exec, -1
    ds_read_b128 v[200:203], v7 offset:34816
    s_add_u32 m0, s48, 135168
    v_mfma_f32_16x16x32_bf16 v[128:131], v[96:99], a[40:43], v[128:131]
    s_add_u32 s50, s1, 18432
    buffer_load_dwordx4 v224, s[24:27], s50 offen offset:0 sc1 lds
    v_mfma_f32_16x16x32_bf16 v[132:135], v[96:99], a[44:47], v[132:135]
    ds_read_b128 v[88:91], v7 offset:41984
    v_cvt_pk_bf16_f32 v191, v234, v235
    v_mfma_f32_16x16x32_bf16 v[132:135], v[208:211], a[36:39], v[132:135]
    buffer_store_dwordx4 v[188:191], v12, s[16:19], 0 offen offset:3072 sc1
    s_waitcnt lgkmcnt(8)
    v_mfma_f32_16x16x32_bf16 v[136:139], v[212:215], a[32:35], v[136:139]
    ds_read_b128 v[204:207], v7 offset:35840
    s_add_u32 m0, s48, 136192
    v_mfma_f32_16x16x32_bf16 v[136:139], v[100:103], a[40:43], v[136:139]
    buffer_load_dwordx4 v225, s[24:27], s50 offen offset:0 sc1 lds
    v_mfma_f32_16x16x32_bf16 v[140:143], v[100:103], a[44:47], v[140:143]
    ds_read_b128 v[92:95], v7 offset:43008
    v_mfma_f32_16x16x32_bf16 v[140:143], v[212:215], a[36:39], v[140:143]
    s_waitcnt lgkmcnt(8)
    v_mfma_f32_16x16x32_bf16 v[144:147], v[216:219], a[32:35], v[144:147]
    ds_read_b128 v[208:211], v7 offset:36864
    s_add_u32 m0, s48, 136192
    v_mfma_f32_16x16x32_bf16 v[144:147], v[104:107], a[40:43], v[144:147]
    buffer_load_dwordx4 v225, s[24:27], s50 offen offset:1024 sc1 lds
    v_mfma_f32_16x16x32_bf16 v[148:151], v[104:107], a[44:47], v[148:151]
    ds_read_b128 v[96:99], v7 offset:44032
    v_mfma_f32_16x16x32_bf16 v[148:151], v[216:219], a[36:39], v[148:151]
    s_waitcnt lgkmcnt(8)
    v_mfma_f32_16x16x32_bf16 v[152:155], v[192:195], a[32:35], v[152:155]
    ds_read_b128 v[212:215], v7 offset:37888
    s_add_u32 m0, s48, 138240
    v_mfma_f32_16x16x32_bf16 v[152:155], v[80:83], a[40:43], v[152:155]
    buffer_load_dwordx4 v226, s[24:27], s50 offen offset:0 sc1 lds
    v_mfma_f32_16x16x32_bf16 v[156:159], v[80:83], a[44:47], v[156:159]
    ds_read_b128 v[100:103], v7 offset:45056
    v_mfma_f32_16x16x32_bf16 v[156:159], v[192:195], a[36:39], v[156:159]
    s_waitcnt lgkmcnt(8)
    v_mfma_f32_16x16x32_bf16 v[160:163], v[196:199], a[32:35], v[160:163]
    ds_read_b128 v[216:219], v7 offset:38912
    s_add_u32 m0, s48, 138240
    v_mfma_f32_16x16x32_bf16 v[160:163], v[84:87], a[40:43], v[160:163]
    buffer_load_dwordx4 v226, s[24:27], s50 offen offset:1024 sc1 lds
    v_mfma_f32_16x16x32_bf16 v[164:167], v[84:87], a[44:47], v[164:167]
    ds_read_b128 v[104:107], v7 offset:46080
    s_lshl_b32 s57, s56, 11
    v_mfma_f32_16x16x32_bf16 v[164:167], v[196:199], a[36:39], v[164:167]
    s_lshl_b32 s6, s37, 13
    s_waitcnt vmcnt(60)
    s_waitcnt lgkmcnt(8)
    v_mfma_f32_16x16x32_bf16 v[112:115], v[200:203], a[48:51], v[112:115]
    ds_read_b128 v[192:195], v7 offset:39936
    s_add_u32 m0, s48, 140288
    v_mfma_f32_16x16x32_bf16 v[112:115], v[88:91], a[56:59], v[112:115]
    buffer_load_dwordx4 v227, s[24:27], s50 offen offset:0 sc1 lds
    v_mfma_f32_16x16x32_bf16 v[116:119], v[88:91], a[60:63], v[116:119]
    ds_read_b128 v[80:83], v7 offset:47104
    s_add_u32 s58, s57, s6
    v_mfma_f32_16x16x32_bf16 v[116:119], v[200:203], a[52:55], v[116:119]
    s_add_u32 s72, s59, s6
    s_waitcnt lgkmcnt(8)
    v_mfma_f32_16x16x32_bf16 v[120:123], v[204:207], a[48:51], v[120:123]
    ds_read_b128 v[196:199], v7 offset:40960
    s_cmp_eq_u32 s56, s37
    s_cselect_b32 s72, s72, 1073741824
    v_mfma_f32_16x16x32_bf16 v[120:123], v[92:95], a[56:59], v[120:123]
    s_add_u32 s57, s57, s59
    s_mul_i32 s8, s56, 40960
    v_mfma_f32_16x16x32_bf16 v[124:127], v[92:95], a[60:63], v[124:127]
    ds_read_b128 v[84:87], v7 offset:48128
    s_lshl_b32 s6, s37, 10
    v_mfma_f32_16x16x32_bf16 v[124:127], v[204:207], a[52:55], v[124:127]
    s_add_u32 s8, s8, s6
    s_waitcnt lgkmcnt(8)
    v_mfma_f32_16x16x32_bf16 v[128:131], v[208:211], a[48:51], v[128:131]
    ds_read_b128 v[200:203], v8 offset:0
    s_add_u32 m0, s48, 140288
    v_mfma_f32_16x16x32_bf16 v[128:131], v[96:99], a[56:59], v[128:131]
    buffer_load_dwordx4 v227, s[24:27], s50 offen offset:1024 sc1 lds
    v_mfma_f32_16x16x32_bf16 v[132:135], v[96:99], a[60:63], v[132:135]
    ds_read_b128 v[88:91], v8 offset:7168
    s_add_u32 s6, s37, 1
    v_mfma_f32_16x16x32_bf16 v[132:135], v[208:211], a[52:55], v[132:135]
    s_and_b32 s6, s6, 3
    s_waitcnt lgkmcnt(8)
    v_mfma_f32_16x16x32_bf16 v[136:139], v[212:215], a[48:51], v[136:139]
    ds_read_b128 v[204:207], v8 offset:1024
    s_lshl_b32 s67, s6, 15
    v_mfma_f32_16x16x32_bf16 v[136:139], v[100:103], a[56:59], v[136:139]
    s_add_u32 s9, s67, s58
    s_lshl_b32 s67, s6, 13
    v_mfma_f32_16x16x32_bf16 v[140:143], v[100:103], a[60:63], v[140:143]
    ds_read_b128 v[92:95], v8 offset:8192
    s_add_u32 s12, s67, s57
    v_mfma_f32_16x16x32_bf16 v[140:143], v[212:215], a[52:55], v[140:143]
    s_add_u32 s6, s37, 2
    s_waitcnt lgkmcnt(8)
    v_mfma_f32_16x16x32_bf16 v[144:147], v[216:219], a[48:51], v[144:147]
    ds_read_b128 v[208:211], v8 offset:2048
    s_and_b32 s6, s6, 3
    v_mfma_f32_16x16x32_bf16 v[144:147], v[104:107], a[56:59], v[144:147]
    s_lshl_b32 s67, s6, 15
    s_add_u32 s10, s67, s58
    v_mfma_f32_16x16x32_bf16 v[148:151], v[104:107], a[60:63], v[148:151]
    ds_read_b128 v[96:99], v8 offset:9216
    s_lshl_b32 s67, s6, 13
    v_mfma_f32_16x16x32_bf16 v[148:151], v[216:219], a[52:55], v[148:151]
    s_add_u32 s13, s67, s57
    s_waitcnt lgkmcnt(8)
    v_mfma_f32_16x16x32_bf16 v[152:155], v[192:195], a[48:51], v[152:155]
    ds_read_b128 v[212:215], v8 offset:3072
    s_add_u32 s6, s37, 3
    v_mfma_f32_16x16x32_bf16 v[152:155], v[80:83], a[56:59], v[152:155]
    s_and_b32 s6, s6, 3
    s_lshl_b32 s67, s6, 15
    v_mfma_f32_16x16x32_bf16 v[156:159], v[80:83], a[60:63], v[156:159]
    ds_read_b128 v[100:103], v8 offset:10240
    s_add_u32 s11, s67, s58
    v_mfma_f32_16x16x32_bf16 v[156:159], v[192:195], a[52:55], v[156:159]
    s_lshl_b32 s67, s6, 13
    s_waitcnt lgkmcnt(8)
    v_mfma_f32_16x16x32_bf16 v[160:163], v[196:199], a[48:51], v[160:163]
    ds_read_b128 v[216:219], v8 offset:4096
    s_add_u32 s14, s67, s57
    v_mfma_f32_16x16x32_bf16 v[160:163], v[84:87], a[56:59], v[160:163]
    s_lshl_b32 s6, s40, 7
    s_lshl_b32 s67, s56, 5
    v_mfma_f32_16x16x32_bf16 v[164:167], v[84:87], a[60:63], v[164:167]
    ds_read_b128 v[104:107], v8 offset:11264
    s_add_u32 s6, s6, s67
    v_mfma_f32_16x16x32_bf16 v[164:167], v[196:199], a[52:55], v[164:167]
    v_and_b32 v9, 15, v13
    s_waitcnt vmcnt(58)
    s_waitcnt lgkmcnt(8)
    v_mfma_f32_16x16x32_bf16 v[112:115], v[200:203], a[64:67], v[112:115]
    ds_read_b128 v[192:195], v8 offset:5120
    v_add_u32 v9, s6, v9
    v_mfma_f32_16x16x32_bf16 v[112:115], v[88:91], a[72:75], v[112:115]
    v_mul_u32_u24 v9, 1152, v9
    v_lshrrev_b32 v10, 4, v13
    v_mfma_f32_16x16x32_bf16 v[116:119], v[88:91], a[76:79], v[116:119]
    ds_read_b128 v[80:83], v8 offset:12288
    s_mul_i32 s6, s41, 144
    v_mfma_f32_16x16x32_bf16 v[116:119], v[200:203], a[68:71], v[116:119]
    v_lshl_add_u32 v10, v10, 2, s6
    s_waitcnt lgkmcnt(8)
    v_mfma_f32_16x16x32_bf16 v[120:123], v[204:207], a[64:67], v[120:123]
    ds_read_b128 v[196:199], v8 offset:6144
    v_lshl_add_u32 v14, v10, 1, v9
    v_mfma_f32_16x16x32_bf16 v[120:123], v[92:95], a[72:75], v[120:123]
    v_lshlrev_b32 v10, 2, v10
    v_add_u32 v10, 105216, v10
    v_mfma_f32_16x16x32_bf16 v[124:127], v[92:95], a[76:79], v[124:127]
    ds_read_b128 v[84:87], v8 offset:13312
    s_lshl_b32 s67, s37, 7
    v_mfma_f32_16x16x32_bf16 v[124:127], v[204:207], a[68:71], v[124:127]
    v_add_u32 v6, s67, v10
    s_waitcnt lgkmcnt(8)
    v_mfma_f32_16x16x32_bf16 v[128:131], v[208:211], a[64:67], v[128:131]
    s_waitcnt vmcnt(19)
    s_barrier
    ds_read_b128 v[200:203], v8 offset:14336
    s_add_u32 m0, s48, 69632
    v_mfma_f32_16x16x32_bf16 v[128:131], v[96:99], a[72:75], v[128:131]
    s_add_u32 s50, s1, 184320
    buffer_load_dwordx4 v224, s[24:27], s50 offen offset:0 sc1 lds
    v_mfma_f32_16x16x32_bf16 v[132:135], v[96:99], a[76:79], v[132:135]
    ds_read_b128 v[88:91], v8 offset:21504
    v_bfe_u32 v241, v13, 4, 1
    v_mfma_f32_16x16x32_bf16 v[132:135], v[208:211], a[68:71], v[132:135]
    v_lshlrev_b32 v246, 5, v241
    s_waitcnt lgkmcnt(8)
    v_mfma_f32_16x16x32_bf16 v[136:139], v[212:215], a[64:67], v[136:139]
    ds_read_b128 v[204:207], v8 offset:15360
    s_add_u32 m0, s48, 70656
    v_mfma_f32_16x16x32_bf16 v[136:139], v[100:103], a[72:75], v[136:139]
    buffer_load_dwordx4 v225, s[24:27], s50 offen offset:0 sc1 lds
    v_mfma_f32_16x16x32_bf16 v[140:143], v[100:103], a[76:79], v[140:143]
    ds_read_b128 v[92:95], v8 offset:22528
    v_bfe_u32 v247, v13, 5, 1
    v_mfma_f32_16x16x32_bf16 v[140:143], v[212:215], a[68:71], v[140:143]
    v_lshl_add_u32 v246, v247, 4, v246
    s_waitcnt lgkmcnt(8)
    v_mfma_f32_16x16x32_bf16 v[144:147], v[216:219], a[64:67], v[144:147]
    ds_read_b128 v[208:211], v8 offset:16384
    s_add_u32 m0, s48, 70656
    v_mfma_f32_16x16x32_bf16 v[144:147], v[104:107], a[72:75], v[144:147]
    buffer_load_dwordx4 v225, s[24:27], s50 offen offset:1024 sc1 lds
    v_mfma_f32_16x16x32_bf16 v[148:151], v[104:107], a[76:79], v[148:151]
    ds_read_b128 v[96:99], v8 offset:23552
    s_lshl_b32 s6, s40, 3
    v_mfma_f32_16x16x32_bf16 v[148:151], v[216:219], a[68:71], v[148:151]
    s_lshl_b32 s67, s56, 1
    s_waitcnt lgkmcnt(8)
    v_mfma_f32_16x16x32_bf16 v[152:155], v[192:195], a[64:67], v[152:155]
    ds_read_b128 v[212:215], v8 offset:17408
    s_add_u32 m0, s48, 72704
    v_mfma_f32_16x16x32_bf16 v[152:155], v[80:83], a[72:75], v[152:155]
    buffer_load_dwordx4 v226, s[24:27], s50 offen offset:0 sc1 lds
    v_mfma_f32_16x16x32_bf16 v[156:159], v[80:83], a[76:79], v[156:159]
    ds_read_b128 v[100:103], v8 offset:24576
    s_add_u32 s6, s6, s67
    v_mfma_f32_16x16x32_bf16 v[156:159], v[192:195], a[68:71], v[156:159]
    s_mul_i32 s6, s6, 18432
    s_waitcnt lgkmcnt(8)
    v_mfma_f32_16x16x32_bf16 v[160:163], v[196:199], a[64:67], v[160:163]
    ds_read_b128 v[216:219], v8 offset:18432
    s_add_u32 m0, s48, 72704
    v_mfma_f32_16x16x32_bf16 v[160:163], v[84:87], a[72:75], v[160:163]
    buffer_load_dwordx4 v226, s[24:27], s50 offen offset:1024 sc1 lds
    v_mfma_f32_16x16x32_bf16 v[164:167], v[84:87], a[76:79], v[164:167]
    ds_read_b128 v[104:107], v8 offset:25600
    s_mul_i32 s67, s41, 4608
    v_mfma_f32_16x16x32_bf16 v[164:167], v[196:199], a[68:71], v[164:167]
    s_add_u32 s6, s6, s67
    s_waitcnt vmcnt(59)
    s_waitcnt lgkmcnt(8)
    v_mfma_f32_16x16x32_bf16 v[112:115], v[200:203], a[80:83], v[112:115]
    ds_read_b128 v[192:195], v8 offset:19456
    s_add_u32 m0, s48, 74752
    v_mfma_f32_16x16x32_bf16 v[112:115], v[88:91], a[88:91], v[112:115]
    buffer_load_dwordx4 v227, s[24:27], s50 offen offset:0 sc1 lds
    v_mfma_f32_16x16x32_bf16 v[116:119], v[88:91], a[92:95], v[116:119]
    ds_read_b128 v[80:83], v8 offset:26624
    s_add_u32 s6, s6, 7602176
    v_mfma_f32_16x16x32_bf16 v[116:119], v[200:203], a[84:87], v[116:119]
    v_and_b32 v11, 15, v13
    s_waitcnt lgkmcnt(8)
    v_mfma_f32_16x16x32_bf16 v[120:123], v[204:207], a[80:83], v[120:123]
    ds_read_b128 v[196:199], v8 offset:20480
    v_lshl_add_u32 v11, v11, 4, s6
    v_mfma_f32_16x16x32_bf16 v[120:123], v[92:95], a[88:91], v[120:123]
    v_lshl_add_u32 v249, v247, 8, v11
    v_lshl_add_u32 v249, v241, 3, v249
    v_mfma_f32_16x16x32_bf16 v[124:127], v[92:95], a[92:95], v[124:127]
    ds_read_b128 v[84:87], v8 offset:27648
    v_add_u32 v249, 4096, v249
    v_mfma_f32_16x16x32_bf16 v[124:127], v[204:207], a[84:87], v[124:127]
    v_add_u32 v241, 18432, v249
    s_waitcnt lgkmcnt(8)
    v_mfma_f32_16x16x32_bf16 v[128:131], v[208:211], a[80:83], v[128:131]
    ds_read_b128 v[200:203], v1 offset:0
    s_add_u32 m0, s48, 74752
    v_mfma_f32_16x16x32_bf16 v[128:131], v[96:99], a[88:91], v[128:131]
    buffer_load_dwordx4 v227, s[24:27], s50 offen offset:1024 sc1 lds
    v_mfma_f32_16x16x32_bf16 v[132:135], v[96:99], a[92:95], v[132:135]
    ds_read_b128 v[88:91], v1 offset:7168
    v_lshl_add_u32 v11, v246, 4, v11
    v_mfma_f32_16x16x32_bf16 v[132:135], v[208:211], a[84:87], v[132:135]
    s_lshl_b32 s67, s37, 10
    s_waitcnt lgkmcnt(8)
    v_mfma_f32_16x16x32_bf16 v[136:139], v[212:215], a[80:83], v[136:139]
    ds_read_b128 v[204:207], v1 offset:1024
    v_add_u32 v11, s67, v11
    v_mfma_f32_16x16x32_bf16 v[136:139], v[100:103], a[88:91], v[136:139]
    v_add_u32 v12, 18432, v11
    s_mul_i32 s6, s41, 288
    v_mfma_f32_16x16x32_bf16 v[140:143], v[100:103], a[92:95], v[140:143]
    ds_read_b128 v[92:95], v1 offset:8192
    s_lshl_b32 s67, s37, 6
    v_mfma_f32_16x16x32_bf16 v[140:143], v[212:215], a[84:87], v[140:143]
    s_add_u32 s6, s6, s67
    s_waitcnt lgkmcnt(8)
    v_mfma_f32_16x16x32_bf16 v[144:147], v[216:219], a[80:83], v[144:147]
    ds_read_b128 v[208:211], v1 offset:2048
    v_add3_u32 v246, v246, v9, s6
    v_mfma_f32_16x16x32_bf16 v[144:147], v[104:107], a[88:91], v[144:147]
    v_add_u32 v247, 18432, v246
    s_mov_b32 s39, 0xffff0000
    v_mfma_f32_16x16x32_bf16 v[148:151], v[104:107], a[92:95], v[148:151]
    ds_read_b128 v[96:99], v1 offset:9216
    s_mov_b32 s65, 0xfffefffe
    v_mfma_f32_16x16x32_bf16 v[148:151], v[216:219], a[84:87], v[148:151]
    v_and_b32 v2, 3, v13
    s_waitcnt lgkmcnt(8)
    v_mfma_f32_16x16x32_bf16 v[152:155], v[192:195], a[80:83], v[152:155]
    ds_read_b128 v[212:215], v1 offset:3072
    v_lshlrev_b32 v2, 3, v2
    v_mfma_f32_16x16x32_bf16 v[152:155], v[80:83], a[88:91], v[152:155]
    v_lshrrev_b32 v2, v2, s64
    v_bfe_u32 v3, v2, 0, 1
    v_mfma_f32_16x16x32_bf16 v[156:159], v[80:83], a[92:95], v[156:159]
    ds_read_b128 v[100:103], v1 offset:10240
    v_bfe_u32 v254, v2, 1, 1
    v_lshl_or_b32 v3, v254, 16, v3
    v_mfma_f32_16x16x32_bf16 v[156:159], v[192:195], a[84:87], v[156:159]
    v_bfe_u32 v4, v2, 2, 1
    s_waitcnt lgkmcnt(8)
    v_mfma_f32_16x16x32_bf16 v[160:163], v[196:199], a[80:83], v[160:163]
    ds_read_b128 v[216:219], v1 offset:4096
    v_bfe_u32 v254, v2, 3, 1
    v_lshl_or_b32 v4, v254, 16, v4
    v_mfma_f32_16x16x32_bf16 v[160:163], v[84:87], a[88:91], v[160:163]
    v_bfe_u32 v248, v2, 4, 1
    v_bfe_u32 v254, v2, 5, 1
    v_lshl_or_b32 v248, v254, 16, v248
    v_mfma_f32_16x16x32_bf16 v[164:167], v[84:87], a[92:95], v[164:167]
    ds_read_b128 v[104:107], v1 offset:11264
    v_bfe_u32 v230, v2, 6, 1
    v_mfma_f32_16x16x32_bf16 v[164:167], v[196:199], a[84:87], v[164:167]
    v_bfe_u32 v254, v2, 7, 1
    v_lshl_or_b32 v230, v254, 16, v230
    v_add_u32 v253, 0x4000, v253
    s_mov_b64 exec, 255
    global_load_dword v15, v253, s[78:79] sc1
    s_mov_b64 exec, -1
    s_waitcnt vmcnt(58)
    s_waitcnt lgkmcnt(8)
    v_mfma_f32_16x16x32_bf16 v[112:115], v[200:203], a[96:99], v[112:115]
    ds_read_b128 v[192:195], v1 offset:5120
    v_mov_b32 v2, 0x8000
    v_mfma_f32_16x16x32_bf16 v[112:115], v[88:91], a[104:107], v[112:115]
    v_mfma_f32_16x16x32_bf16 v[116:119], v[88:91], a[108:111], v[116:119]
    ds_read_b128 v[80:83], v1 offset:12288
    v_mfma_f32_16x16x32_bf16 v[116:119], v[200:203], a[100:103], v[116:119]
    s_waitcnt lgkmcnt(8)
    v_mfma_f32_16x16x32_bf16 v[120:123], v[204:207], a[96:99], v[120:123]
    ds_read_b128 v[196:199], v1 offset:6144
    v_mfma_f32_16x16x32_bf16 v[120:123], v[92:95], a[104:107], v[120:123]
    global_load_dwordx4 v[232:235], v11, s[78:79] sc1
    v_mfma_f32_16x16x32_bf16 v[124:127], v[92:95], a[108:111], v[124:127]
    ds_read_b128 v[84:87], v1 offset:13312
    v_mfma_f32_16x16x32_bf16 v[124:127], v[204:207], a[100:103], v[124:127]
    s_waitcnt lgkmcnt(8)
    v_mfma_f32_16x16x32_bf16 v[128:131], v[208:211], a[96:99], v[128:131]
    s_waitcnt vmcnt(15)
    s_barrier
    v_add_u32 v240, s53, v240
    v_mov_b32 v254, s64
    s_mov_b64 exec, 1
    global_store_dword v240, v254, s[78:79] sc1
    s_mov_b64 exec, -1
    ds_read_b128 v[200:203], v1 offset:14336
    v_mfma_f32_16x16x32_bf16 v[128:131], v[96:99], a[104:107], v[128:131]
    global_load_dwordx4 v[236:239], v12, s[78:79] sc1
    v_mfma_f32_16x16x32_bf16 v[132:135], v[96:99], a[108:111], v[132:135]
    ds_read_b128 v[88:91], v1 offset:21504
    v_mfma_f32_16x16x32_bf16 v[132:135], v[208:211], a[100:103], v[132:135]
    s_waitcnt lgkmcnt(8)
    v_mfma_f32_16x16x32_bf16 v[136:139], v[212:215], a[96:99], v[136:139]
    ds_read_b128 v[204:207], v1 offset:15360
    v_mfma_f32_16x16x32_bf16 v[136:139], v[100:103], a[104:107], v[136:139]
    global_load_dwordx4 v[68:71], v6, s[78:79] offset:0
    v_mfma_f32_16x16x32_bf16 v[140:143], v[100:103], a[108:111], v[140:143]
    ds_read_b128 v[92:95], v1 offset:22528
    v_mfma_f32_16x16x32_bf16 v[140:143], v[212:215], a[100:103], v[140:143]
    s_waitcnt lgkmcnt(8)
    v_mfma_f32_16x16x32_bf16 v[144:147], v[216:219], a[96:99], v[144:147]
    ds_read_b128 v[208:211], v1 offset:16384
    v_mfma_f32_16x16x32_bf16 v[144:147], v[104:107], a[104:107], v[144:147]
    global_load_dwordx4 v[72:75], v6, s[78:79] offset:64
    v_mfma_f32_16x16x32_bf16 v[148:151], v[104:107], a[108:111], v[148:151]
    ds_read_b128 v[96:99], v1 offset:23552
    v_mfma_f32_16x16x32_bf16 v[148:151], v[216:219], a[100:103], v[148:151]
    s_waitcnt lgkmcnt(8)
    v_mfma_f32_16x16x32_bf16 v[152:155], v[192:195], a[96:99], v[152:155]
    ds_read_b128 v[212:215], v1 offset:17408
    v_mfma_f32_16x16x32_bf16 v[152:155], v[80:83], a[104:107], v[152:155]
    global_load_dwordx4 v[76:79], v10, s[78:79] offset:512
    v_mfma_f32_16x16x32_bf16 v[156:159], v[80:83], a[108:111], v[156:159]
    ds_read_b128 v[100:103], v1 offset:24576
    v_mfma_f32_16x16x32_bf16 v[156:159], v[192:195], a[100:103], v[156:159]
    s_waitcnt lgkmcnt(8)
    v_mfma_f32_16x16x32_bf16 v[160:163], v[196:199], a[96:99], v[160:163]
    ds_read_b128 v[216:219], v1 offset:18432
    v_mfma_f32_16x16x32_bf16 v[160:163], v[84:87], a[104:107], v[160:163]
    global_load_dwordx2 v[64:65], v249, s[78:79] sc1
    v_mfma_f32_16x16x32_bf16 v[164:167], v[84:87], a[108:111], v[164:167]
    ds_read_b128 v[104:107], v1 offset:25600
    v_mfma_f32_16x16x32_bf16 v[164:167], v[196:199], a[100:103], v[164:167]
    s_waitcnt vmcnt(61)
    s_waitcnt lgkmcnt(8)
    v_mfma_f32_16x16x32_bf16 v[112:115], v[200:203], a[112:115], v[112:115]
    ds_read_b128 v[192:195], v1 offset:19456
    v_mfma_f32_16x16x32_bf16 v[112:115], v[88:91], a[120:123], v[112:115]
    v_mfma_f32_16x16x32_bf16 v[116:119], v[88:91], a[124:127], v[116:119]
    ds_read_b128 v[80:83], v1 offset:26624
    v_mfma_f32_16x16x32_bf16 v[116:119], v[200:203], a[116:119], v[116:119]
    s_waitcnt lgkmcnt(8)
    v_mfma_f32_16x16x32_bf16 v[120:123], v[204:207], a[112:115], v[120:123]
    ds_read_b128 v[196:199], v1 offset:20480
    v_mfma_f32_16x16x32_bf16 v[120:123], v[92:95], a[120:123], v[120:123]
    global_load_dwordx2 v[66:67], v241, s[78:79] sc1
    v_mfma_f32_16x16x32_bf16 v[124:127], v[92:95], a[124:127], v[124:127]
    ds_read_b128 v[84:87], v1 offset:27648
    v_mfma_f32_16x16x32_bf16 v[124:127], v[204:207], a[116:119], v[124:127]
    s_waitcnt lgkmcnt(8)
    v_mfma_f32_16x16x32_bf16 v[128:131], v[208:211], a[112:115], v[128:131]
    ds_read_b128 v[200:203], v1 offset:28672
    s_add_u32 m0, s48, 98304
    v_mfma_f32_16x16x32_bf16 v[128:131], v[96:99], a[120:123], v[128:131]
    s_add_u32 s50, s1, 27648
    buffer_load_dwordx4 v224, s[24:27], s50 offen offset:0 sc1 lds
    v_mfma_f32_16x16x32_bf16 v[132:135], v[96:99], a[124:127], v[132:135]
    ds_read_b128 v[88:91], v1 offset:35840
    v_mfma_f32_16x16x32_bf16 v[132:135], v[208:211], a[116:119], v[132:135]
    s_waitcnt lgkmcnt(8)
    v_mfma_f32_16x16x32_bf16 v[136:139], v[212:215], a[112:115], v[136:139]
    ds_read_b128 v[204:207], v1 offset:29696
    s_add_u32 m0, s48, 99328
    v_mfma_f32_16x16x32_bf16 v[136:139], v[100:103], a[120:123], v[136:139]
    buffer_load_dwordx4 v225, s[24:27], s50 offen offset:0 sc1 lds
    v_mfma_f32_16x16x32_bf16 v[140:143], v[100:103], a[124:127], v[140:143]
    ds_read_b128 v[92:95], v1 offset:36864
    v_mfma_f32_16x16x32_bf16 v[140:143], v[212:215], a[116:119], v[140:143]
    s_waitcnt lgkmcnt(8)
    v_mfma_f32_16x16x32_bf16 v[144:147], v[216:219], a[112:115], v[144:147]
    ds_read_b128 v[208:211], v1 offset:30720
    s_add_u32 m0, s48, 99328
    v_mfma_f32_16x16x32_bf16 v[144:147], v[104:107], a[120:123], v[144:147]
    buffer_load_dwordx4 v225, s[24:27], s50 offen offset:1024 sc1 lds
    v_mfma_f32_16x16x32_bf16 v[148:151], v[104:107], a[124:127], v[148:151]
    ds_read_b128 v[96:99], v1 offset:37888
    v_mfma_f32_16x16x32_bf16 v[148:151], v[216:219], a[116:119], v[148:151]
    s_waitcnt lgkmcnt(8)
    v_mfma_f32_16x16x32_bf16 v[152:155], v[192:195], a[112:115], v[152:155]
    ds_read_b128 v[212:215], v1 offset:31744
    v_mfma_f32_16x16x32_bf16 v[152:155], v[80:83], a[120:123], v[152:155]
    v_mfma_f32_16x16x32_bf16 v[156:159], v[80:83], a[124:127], v[156:159]
    ds_read_b128 v[100:103], v1 offset:38912
    v_mfma_f32_16x16x32_bf16 v[156:159], v[192:195], a[116:119], v[156:159]
    s_waitcnt lgkmcnt(8)
    v_mfma_f32_16x16x32_bf16 v[160:163], v[196:199], a[112:115], v[160:163]
    ds_read_b128 v[216:219], v1 offset:32768
    s_add_u32 m0, s48, 101376
    v_mfma_f32_16x16x32_bf16 v[160:163], v[84:87], a[120:123], v[160:163]
    buffer_load_dwordx4 v226, s[24:27], s50 offen offset:0 sc1 lds
    v_mfma_f32_16x16x32_bf16 v[164:167], v[84:87], a[124:127], v[164:167]
    ds_read_b128 v[104:107], v1 offset:39936
    v_mfma_f32_16x16x32_bf16 v[164:167], v[196:199], a[116:119], v[164:167]
    s_waitcnt vmcnt(12)
    v_cmp_ne_u32 vcc, s64, v15
    s_nop 4
    s_cbranch_vccnz L_g_slow4
L_g_back4:
    s_waitcnt vmcnt(58)
    s_waitcnt lgkmcnt(8)
    v_mfma_f32_16x16x32_bf16 v[112:115], v[200:203], a[128:131], v[112:115]
    ds_read_b128 v[192:195], v1 offset:33792
    s_mov_b32 s51, 2048
    v_mfma_f32_16x16x32_bf16 v[112:115], v[88:91], a[136:139], v[112:115]
    buffer_load_dwordx4 a[160:163], v1, s[20:23], s51 offen sc1
    v_mfma_f32_16x16x32_bf16 v[116:119], v[88:91], a[140:143], v[116:119]
    ds_read_b128 v[80:83], v1 offset:40960
    v_mfma_f32_16x16x32_bf16 v[116:119], v[200:203], a[132:135], v[116:119]
    s_waitcnt lgkmcnt(8)
    v_mfma_f32_16x16x32_bf16 v[120:123], v[204:207], a[128:131], v[120:123]
    ds_read_b128 v[196:199], v1 offset:34816
    v_mfma_f32_16x16x32_bf16 v[120:123], v[92:95], a[136:139], v[120:123]
    buffer_load_dwordx4 a[164:167], v242, s[20:23], s51 offen sc1
    v_mfma_f32_16x16x32_bf16 v[124:127], v[92:95], a[140:143], v[124:127]
    ds_read_b128 v[84:87], v1 offset:41984
    v_mfma_f32_16x16x32_bf16 v[124:127], v[204:207], a[132:135], v[124:127]
    s_waitcnt lgkmcnt(8)
    v_mfma_f32_16x16x32_bf16 v[128:131], v[208:211], a[128:131], v[128:131]
    s_waitcnt vmcnt(22)
    s_barrier
    ds_read_b128 v[200:203], v1 offset:43008
    s_mov_b32 s51, 7168
    v_mfma_f32_16x16x32_bf16 v[128:131], v[96:99], a[136:139], v[128:131]
    buffer_load_dwordx4 a[168:171], v1, s[20:23], s51 offen sc1
    v_mfma_f32_16x16x32_bf16 v[132:135], v[96:99], a[140:143], v[132:135]
    ds_read_b128 v[88:91], v7 offset:1024
    v_mfma_f32_16x16x32_bf16 v[132:135], v[208:211], a[132:135], v[132:135]
    s_waitcnt lgkmcnt(8)
    v_mfma_f32_16x16x32_bf16 v[136:139], v[212:215], a[128:131], v[136:139]
    ds_read_b128 v[204:207], v1 offset:44032
    v_mfma_f32_16x16x32_bf16 v[136:139], v[100:103], a[136:139], v[136:139]
    buffer_load_dwordx4 a[172:175], v242, s[20:23], s51 offen sc1
    v_mfma_f32_16x16x32_bf16 v[140:143], v[100:103], a[140:143], v[140:143]
    ds_read_b128 v[92:95], v7 offset:2048
    v_mfma_f32_16x16x32_bf16 v[140:143], v[212:215], a[132:135], v[140:143]
    s_waitcnt lgkmcnt(8)
    v_mfma_f32_16x16x32_bf16 v[144:147], v[216:219], a[128:131], v[144:147]
    ds_read_b128 v[208:211], v1 offset:45056
    s_mov_b32 s51, 11264
    v_mfma_f32_16x16x32_bf16 v[144:147], v[104:107], a[136:139], v[144:147]
    buffer_load_dwordx4 a[176:179], v1, s[20:23], s51 offen sc1
    v_mfma_f32_16x16x32_bf16 v[148:151], v[104:107], a[140:143], v[148:151]
    ds_read_b128 v[96:99], v7 offset:3072
    v_mfma_f32_16x16x32_bf16 v[148:151], v[216:219], a[132:135], v[148:151]
    s_waitcnt lgkmcnt(8)
    v_mfma_f32_16x16x32_bf16 v[152:155], v[192:195], a[128:131], v[152:155]
    ds_read_b128 v[212:215], v1 offset:46080
    v_mfma_f32_16x16x32_bf16 v[152:155], v[80:83], a[136:139], v[152:155]
    buffer_load_dwordx4 a[180:183], v242, s[20:23], s51 offen sc1
    v_mfma_f32_16x16x32_bf16 v[156:159], v[80:83], a[140:143], v[156:159]
    ds_read_b128 v[100:103], v7 offset:4096
    v_mfma_f32_16x16x32_bf16 v[156:159], v[192:195], a[132:135], v[156:159]
    s_waitcnt lgkmcnt(8)
    v_mfma_f32_16x16x32_bf16 v[160:163], v[196:199], a[128:131], v[160:163]
    ds_read_b128 v[216:219], v1 offset:47104
    s_mov_b32 s51, 16384
    v_mfma_f32_16x16x32_bf16 v[160:163], v[84:87], a[136:139], v[160:163]
    buffer_load_dwordx4 a[184:187], v1, s[20:23], s51 offen sc1
    v_mfma_f32_16x16x32_bf16 v[164:167], v[84:87], a[140:143], v[164:167]
    ds_read_b128 v[104:107], v7 offset:5120
    v_mfma_f32_16x16x32_bf16 v[164:167], v[196:199], a[132:135], v[164:167]
    s_waitcnt vmcnt(54)
    s_waitcnt lgkmcnt(8)
    v_mfma_f32_16x16x32_bf16 v[112:115], v[200:203], a[144:147], v[112:115]
    ds_read_b128 v[192:195], v1 offset:48128
    v_mfma_f32_16x16x32_bf16 v[112:115], v[88:91], a[152:155], v[112:115]
    buffer_load_dwordx4 a[188:191], v242, s[20:23], s51 offen sc1
    v_mfma_f32_16x16x32_bf16 v[116:119], v[88:91], a[156:159], v[116:119]
    ds_read_b128 v[80:83], v7 offset:6144
    v_mfma_f32_16x16x32_bf16 v[116:119], v[200:203], a[148:151], v[116:119]
    s_waitcnt lgkmcnt(8)
    v_mfma_f32_16x16x32_bf16 v[120:123], v[204:207], a[144:147], v[120:123]
    ds_read_b128 v[196:199], v7 offset:0
    s_mov_b32 s51, 20480
    v_mfma_f32_16x16x32_bf16 v[120:123], v[92:95], a[152:155], v[120:123]
    buffer_load_dwordx4 a[192:195], v1, s[20:23], s51 offen sc1
    v_mfma_f32_16x16x32_bf16 v[124:127], v[92:95], a[156:159], v[124:127]
    ds_read_b128 v[84:87], v7 offset:7168
    v_mfma_f32_16x16x32_bf16 v[124:127], v[204:207], a[148:151], v[124:127]
    s_waitcnt lgkmcnt(8)
    v_mfma_f32_16x16x32_bf16 v[128:131], v[208:211], a[144:147], v[128:131]
    ds_read_b128 v[200:203], v8 offset:36864
    v_mfma_f32_16x16x32_bf16 v[128:131], v[96:99], a[152:155], v[128:131]
    buffer_load_dwordx4 a[196:199], v242, s[20:23], s51 offen sc1
    v_mfma_f32_16x16x32_bf16 v[132:135], v[96:99], a[156:159], v[132:135]
    ds_read_b128 v[88:91], v8 offset:44032
    v_mfma_f32_16x16x32_bf16 v[132:135], v[208:211], a[148:151], v[132:135]
    s_waitcnt lgkmcnt(8)
    v_mfma_f32_16x16x32_bf16 v[136:139], v[212:215], a[144:147], v[136:139]
    ds_read_b128 v[204:207], v8 offset:37888
    s_mov_b32 s51, 25600
    v_mfma_f32_16x16x32_bf16 v[136:139], v[100:103], a[152:155], v[136:139]
    buffer_load_dwordx4 a[200:203], v1, s[20:23], s51 offen sc1
    v_mfma_f32_16x16x32_bf16 v[140:143], v[100:103], a[156:159], v[140:143]
    ds_read_b128 v[92:95], v8 offset:45056
    v_mfma_f32_16x16x32_bf16 v[140:143], v[212:215], a[148:151], v[140:143]
    s_waitcnt lgkmcnt(8)
    v_mfma_f32_16x16x32_bf16 v[144:147], v[216:219], a[144:147], v[144:147]
    ds_read_b128 v[208:211], v8 offset:38912
    v_mfma_f32_16x16x32_bf16 v[144:147], v[104:107], a[152:155], v[144:147]
    buffer_load_dwordx4 a[204:207], v242, s[20:23], s51 offen sc1
    v_mfma_f32_16x16x32_bf16 v[148:151], v[104:107], a[156:159], v[148:151]
    ds_read_b128 v[96:99], v8 offset:46080
    v_mfma_f32_16x16x32_bf16 v[148:151], v[216:219], a[148:151], v[148:151]
    v_add_u32 v253, 0x4000, v253
    s_mov_b64 exec, 255
    global_load_dword v15, v253, s[78:79] sc1
    s_mov_b64 exec, -1
    s_waitcnt lgkmcnt(8)
    v_mfma_f32_16x16x32_bf16 v[152:155], v[192:195], a[144:147], v[152:155]
    ds_read_b128 v[212:215], v8 offset:39936
    s_add_u32 m0, s48, 101376
    v_mfma_f32_16x16x32_bf16 v[152:155], v[80:83], a[152:155], v[152:155]
    buffer_load_dwordx4 v226, s[24:27], s50 offen offset:1024 sc1 lds
    v_mfma_f32_16x16x32_bf16 v[156:159], v[80:83], a[156:159], v[156:159]
    ds_read_b128 v[100:103], v8 offset:47104
    v_mfma_f32_16x16x32_bf16 v[156:159], v[192:195], a[148:151], v[156:159]
    s_waitcnt lgkmcnt(8)
    v_mfma_f32_16x16x32_bf16 v[160:163], v[196:199], a[144:147], v[160:163]
    ds_read_b128 v[216:219], v8 offset:40960
    s_add_u32 m0, s48, 103424
    v_mfma_f32_16x16x32_bf16 v[160:163], v[84:87], a[152:155], v[160:163]
    buffer_load_dwordx4 v227, s[24:27], s50 offen offset:0 sc1 lds
    v_mfma_f32_16x16x32_bf16 v[164:167], v[84:87], a[156:159], v[164:167]
    ds_read_b128 v[104:107], v8 offset:48128
    v_mfma_f32_16x16x32_bf16 v[164:167], v[196:199], a[148:151], v[164:167]
    s_waitcnt vmcnt(11)
    s_waitcnt lgkmcnt(8)
    v_mfma_f32_16x16x32_bf16 v[112:115], v[200:203], a[160:163], v[112:115]
    ds_read_b128 v[192:195], v8 offset:41984
    s_add_u32 m0, s48, 103424
    v_mfma_f32_16x16x32_bf16 v[112:115], v[88:91], a[168:171], v[112:115]
    buffer_load_dwordx4 v227, s[24:27], s50 offen offset:1024 sc1 lds
    v_mfma_f32_16x16x32_bf16 v[116:119], v[88:91], a[172:175], v[116:119]
    ds_read_b128 v[80:83], v8 offset:49152
    v_mfma_f32_16x16x32_bf16 v[116:119], v[200:203], a[164:167], v[116:119]
    s_waitcnt lgkmcnt(8)
    v_mfma_f32_16x16x32_bf16 v[120:123], v[204:207], a[160:163], v[120:123]
    ds_read_b128 v[196:199], v8 offset:43008
    s_mov_b32 s51, 29696
    v_mfma_f32_16x16x32_bf16 v[120:123], v[92:95], a[168:171], v[120:123]
    buffer_load_dwordx4 a[208:211], v1, s[20:23], s51 offen sc1
    v_mfma_f32_16x16x32_bf16 v[124:127], v[92:95], a[172:175], v[124:127]
    ds_read_b128 v[84:87], v8 offset:50176
    v_mfma_f32_16x16x32_bf16 v[124:127], v[204:207], a[164:167], v[124:127]
    s_waitcnt lgkmcnt(8)
    v_mfma_f32_16x16x32_bf16 v[128:131], v[208:211], a[160:163], v[128:131]
    s_waitcnt vmcnt(30)
    s_barrier
    ds_read_b128 v[200:203], v8 offset:51200
    v_mfma_f32_16x16x32_bf16 v[128:131], v[96:99], a[168:171], v[128:131]
    buffer_load_dwordx4 a[212:215], v242, s[20:23], s51 offen sc1
    v_mfma_f32_16x16x32_bf16 v[132:135], v[96:99], a[172:175], v[132:135]
    ds_read_b128 v[88:91], v8 offset:58368
    v_mfma_f32_16x16x32_bf16 v[132:135], v[208:211], a[164:167], v[132:135]
    s_waitcnt lgkmcnt(8)
    v_mfma_f32_16x16x32_bf16 v[136:139], v[212:215], a[160:163], v[136:139]
    ds_read_b128 v[204:207], v8 offset:52224
    s_mov_b32 s51, 34816
    v_mfma_f32_16x16x32_bf16 v[136:139], v[100:103], a[168:171], v[136:139]
    buffer_load_dwordx4 a[216:219], v1, s[20:23], s51 offen sc1
    v_mfma_f32_16x16x32_bf16 v[140:143], v[100:103], a[172:175], v[140:143]
    ds_read_b128 v[92:95], v8 offset:59392
    v_mfma_f32_16x16x32_bf16 v[140:143], v[212:215], a[164:167], v[140:143]
    s_waitcnt lgkmcnt(8)
    v_mfma_f32_16x16x32_bf16 v[144:147], v[216:219], a[160:163], v[144:147]
    ds_read_b128 v[208:211], v8 offset:53248
    v_mfma_f32_16x16x32_bf16 v[144:147], v[104:107], a[168:171], v[144:147]
    buffer_load_dwordx4 a[220:223], v242, s[20:23], s51 offen sc1
    v_mfma_f32_16x16x32_bf16 v[148:151], v[104:107], a[172:175], v[148:151]
    ds_read_b128 v[96:99], v8 offset:60416
    v_mfma_f32_16x16x32_bf16 v[148:151], v[216:219], a[164:167], v[148:151]
    s_waitcnt lgkmcnt(8)
    v_mfma_f32_16x16x32_bf16 v[152:155], v[192:195], a[160:163], v[152:155]
    ds_read_b128 v[212:215], v8 offset:54272
    v_mfma_f32_16x16x32_bf16 v[152:155], v[80:83], a[168:171], v[152:155]
    v_mfma_f32_16x16x32_bf16 v[156:159], v[80:83], a[172:175], v[156:159]
    ds_read_b128 v[100:103], v8 offset:61440
    v_mfma_f32_16x16x32_bf16 v[156:159], v[192:195], a[164:167], v[156:159]
    s_waitcnt lgkmcnt(8)
    v_mfma_f32_16x16x32_bf16 v[160:163], v[196:199], a[160:163], v[160:163]
    ds_read_b128 v[216:219], v8 offset:55296
    s_add_u32 m0, s48, 0
    v_mfma_f32_16x16x32_bf16 v[160:163], v[84:87], a[168:171], v[160:163]
    s_add_u32 s50, s1, 193536
    buffer_load_dwordx4 v224, s[24:27], s50 offen offset:0 sc1 lds
    v_mfma_f32_16x16x32_bf16 v[164:167], v[84:87], a[172:175], v[164:167]
    ds_read_b128 v[104:107], v8 offset:62464
    v_mfma_f32_16x16x32_bf16 v[164:167], v[196:199], a[164:167], v[164:167]
    s_waitcnt vmcnt(13)
    s_waitcnt lgkmcnt(8)
    v_mfma_f32_16x16x32_bf16 v[112:115], v[200:203], a[176:179], v[112:115]
    ds_read_b128 v[192:195], v8 offset:56320
    s_add_u32 m0, s48, 1024
    v_mfma_f32_16x16x32_bf16 v[112:115], v[88:91], a[184:187], v[112:115]
    buffer_load_dwordx4 v225, s[24:27], s50 offen offset:0 sc1 lds
    v_mfma_f32_16x16x32_bf16 v[116:119], v[88:91], a[188:191], v[116:119]
    ds_read_b128 v[80:83], v8 offset:63488
    v_mfma_f32_16x16x32_bf16 v[116:119], v[200:203], a[180:183], v[116:119]
    s_waitcnt lgkmcnt(8)
    v_mfma_f32_16x16x32_bf16 v[120:123], v[204:207], a[176:179], v[120:123]
    ds_read_b128 v[196:199], v8 offset:57344
    s_add_u32 m0, s48, 1024
    v_mfma_f32_16x16x32_bf16 v[120:123], v[92:95], a[184:187], v[120:123]
    buffer_load_dwordx4 v225, s[24:27], s50 offen offset:1024 sc1 lds
    v_mfma_f32_16x16x32_bf16 v[124:127], v[92:95], a[188:191], v[124:127]
    ds_read_b128 v[84:87], v8 offset:64512
    v_mfma_f32_16x16x32_bf16 v[124:127], v[204:207], a[180:183], v[124:127]
    s_waitcnt lgkmcnt(8)
    v_mfma_f32_16x16x32_bf16 v[128:131], v[208:211], a[176:179], v[128:131]
    ds_read_b128 v[200:203], v7 offset:20480
    s_add_u32 m0, s48, 3072
    v_mfma_f32_16x16x32_bf16 v[128:131], v[96:99], a[184:187], v[128:131]
    buffer_load_dwordx4 v226, s[24:27], s50 offen offset:0 sc1 lds
    v_mfma_f32_16x16x32_bf16 v[132:135], v[96:99], a[188:191], v[132:135]
    ds_read_b128 v[88:91], v7 offset:27648
    v_mfma_f32_16x16x32_bf16 v[132:135], v[208:211], a[180:183], v[132:135]
    s_waitcnt lgkmcnt(8)
    v_mfma_f32_16x16x32_bf16 v[136:139], v[212:215], a[176:179], v[136:139]
    ds_read_b128 v[204:207], v7 offset:21504
    s_add_u32 m0, s48, 3072
    v_mfma_f32_16x16x32_bf16 v[136:139], v[100:103], a[184:187], v[136:139]
    buffer_load_dwordx4 v226, s[24:27], s50 offen offset:1024 sc1 lds
    v_mfma_f32_16x16x32_bf16 v[140:143], v[100:103], a[188:191], v[140:143]
    ds_read_b128 v[92:95], v7 offset:28672
    v_mfma_f32_16x16x32_bf16 v[140:143], v[212:215], a[180:183], v[140:143]
    s_waitcnt lgkmcnt(8)
    v_mfma_f32_16x16x32_bf16 v[144:147], v[216:219], a[176:179], v[144:147]
    ds_read_b128 v[208:211], v7 offset:22528
    s_add_u32 m0, s48, 5120
    v_mfma_f32_16x16x32_bf16 v[144:147], v[104:107], a[184:187], v[144:147]
    buffer_load_dwordx4 v227, s[24:27], s50 offen offset:0 sc1 lds
    v_mfma_f32_16x16x32_bf16 v[148:151], v[104:107], a[188:191], v[148:151]
    ds_read_b128 v[96:99], v7 offset:29696
    v_mfma_f32_16x16x32_bf16 v[148:151], v[216:219], a[180:183], v[148:151]
    s_waitcnt vmcnt(13)
    v_cmp_ne_u32 vcc, s64, v15
    s_nop 4
    s_cbranch_vccnz L_g_slow5
L_g_back5:
    s_waitcnt lgkmcnt(8)
    v_mfma_f32_16x16x32_bf16 v[152:155], v[192:195], a[176:179], v[152:155]
    ds_read_b128 v[212:215], v7 offset:23552
    s_mov_b32 s51, 3072
    v_mfma_f32_16x16x32_bf16 v[152:155], v[80:83], a[184:187], v[152:155]
    buffer_load_dwordx4 a[224:227], v1, s[20:23], s51 offen sc1
    v_mfma_f32_16x16x32_bf16 v[156:159], v[80:83], a[188:191], v[156:159]
    ds_read_b128 v[100:103], v7 offset:30720
    v_mfma_f32_16x16x32_bf16 v[156:159], v[192:195], a[180:183], v[156:159]
    s_waitcnt lgkmcnt(8)
    v_mfma_f32_16x16x32_bf16 v[160:163], v[196:199], a[176:179], v[160:163]
    ds_read_b128 v[216:219], v7 offset:24576
    v_mfma_f32_16x16x32_bf16 v[160:163], v[84:87], a[184:187], v[160:163]
    buffer_load_dwordx4 a[228:231], v242, s[20:23], s51 offen sc1
    v_mfma_f32_16x16x32_bf16 v[164:167], v[84:87], a[188:191], v[164:167]
    ds_read_b128 v[104:107], v7 offset:31744
    v_mfma_f32_16x16x32_bf16 v[164:167], v[196:199], a[180:183], v[164:167]
    s_waitcnt vmcnt(16)
    s_waitcnt lgkmcnt(8)
    v_mfma_f32_16x16x32_bf16 v[112:115], v[200:203], a[192:195], v[112:115]
    ds_read_b128 v[192:195], v7 offset:25600
    s_mov_b32 s51, 8192
    v_mfma_f32_16x16x32_bf16 v[112:115], v[88:91], a[200:203], v[112:115]
    buffer_load_dwordx4 a[232:235], v1, s[20:23], s51 offen sc1
    v_mfma_f32_16x16x32_bf16 v[116:119], v[88:91], a[204:207], v[116:119]
    ds_read_b128 v[80:83], v7 offset:32768
    v_mfma_f32_16x16x32_bf16 v[116:119], v[200:203], a[196:199], v[116:119]
    s_waitcnt lgkmcnt(8)
    v_mfma_f32_16x16x32_bf16 v[120:123], v[204:207], a[192:195], v[120:123]
    ds_read_b128 v[196:199], v7 offset:26624
    v_mfma_f32_16x16x32_bf16 v[120:123], v[92:95], a[200:203], v[120:123]
    buffer_load_dwordx4 a[236:239], v242, s[20:23], s51 offen sc1
    v_mfma_f32_16x16x32_bf16 v[124:127], v[92:95], a[204:207], v[124:127]
    ds_read_b128 v[84:87], v7 offset:33792
    v_mfma_f32_16x16x32_bf16 v[124:127], v[204:207], a[196:199], v[124:127]
    s_waitcnt lgkmcnt(8)
    v_mfma_f32_16x16x32_bf16 v[128:131], v[208:211], a[192:195], v[128:131]
    s_waitcnt vmcnt(14)
    s_barrier
    ds_read_b128 v[200:203], v7 offset:34816
    s_add_u32 m0, s48, 5120
    v_mfma_f32_16x16x32_bf16 v[128:131], v[96:99], a[200:203], v[128:131]
    buffer_load_dwordx4 v227, s[24:27], s50 offen offset:1024 sc1 lds
    v_mfma_f32_16x16x32_bf16 v[132:135], v[96:99], a[204:207], v[132:135]
    ds_read_b128 v[88:91], v7 offset:41984
    v_mfma_f32_16x16x32_bf16 v[132:135], v[208:211], a[196:199], v[132:135]
    s_waitcnt lgkmcnt(8)
    v_mfma_f32_16x16x32_bf16 v[136:139], v[212:215], a[192:195], v[136:139]
    ds_read_b128 v[204:207], v7 offset:35840
    s_mov_b32 s51, 12288
    v_mfma_f32_16x16x32_bf16 v[136:139], v[100:103], a[200:203], v[136:139]
    buffer_load_dwordx4 a[240:243], v1, s[20:23], s51 offen sc1
    v_mfma_f32_16x16x32_bf16 v[140:143], v[100:103], a[204:207], v[140:143]
    ds_read_b128 v[92:95], v7 offset:43008
    v_mfma_f32_16x16x32_bf16 v[140:143], v[212:215], a[196:199], v[140:143]
    s_waitcnt lgkmcnt(8)
    v_mfma_f32_16x16x32_bf16 v[144:147], v[216:219], a[192:195], v[144:147]
    ds_read_b128 v[208:211], v7 offset:36864
    v_mfma_f32_16x16x32_bf16 v[144:147], v[104:107], a[200:203], v[144:147]
    buffer_load_dwordx4 a[244:247], v242, s[20:23], s51 offen sc1
    v_mfma_f32_16x16x32_bf16 v[148:151], v[104:107], a[204:207], v[148:151]
    ds_read_b128 v[96:99], v7 offset:44032
    v_mfma_f32_16x16x32_bf16 v[148:151], v[216:219], a[196:199], v[148:151]
    s_waitcnt lgkmcnt(8)
    v_mfma_f32_16x16x32_bf16 v[152:155], v[192:195], a[192:195], v[152:155]
    ds_read_b128 v[212:215], v7 offset:37888
    s_mov_b32 s51, 17408
    v_mfma_f32_16x16x32_bf16 v[152:155], v[80:83], a[200:203], v[152:155]
    buffer_load_dwordx4 a[248:251], v1, s[20:23], s51 offen sc1
    v_mfma_f32_16x16x32_bf16 v[156:159], v[80:83], a[204:207], v[156:159]
    ds_read_b128 v[100:103], v7 offset:45056
    v_mfma_f32_16x16x32_bf16 v[156:159], v[192:195], a[196:199], v[156:159]
    s_waitcnt lgkmcnt(8)
    v_mfma_f32_16x16x32_bf16 v[160:163], v[196:199], a[192:195], v[160:163]
    ds_read_b128 v[216:219], v7 offset:38912
    v_mfma_f32_16x16x32_bf16 v[160:163], v[84:87], a[200:203], v[160:163]
    buffer_load_dwordx4 a[252:255], v242, s[20:23], s51 offen sc1
    v_mfma_f32_16x16x32_bf16 v[164:167], v[84:87], a[204:207], v[164:167]
    ds_read_b128 v[104:107], v7 offset:46080
    v_mfma_f32_16x16x32_bf16 v[164:167], v[196:199], a[196:199], v[164:167]
    s_waitcnt vmcnt(15)
    s_waitcnt lgkmcnt(8)
    v_mfma_f32_16x16x32_bf16 v[112:115], v[200:203], a[208:211], v[112:115]
    ds_read_b128 v[192:195], v7 offset:39936
    s_mov_b32 s51, 21504
    v_mfma_f32_16x16x32_bf16 v[112:115], v[88:91], a[216:219], v[112:115]
    buffer_load_dwordx4 v[16:19], v1, s[20:23], s51 offen sc1
    v_mfma_f32_16x16x32_bf16 v[116:119], v[88:91], a[220:223], v[116:119]
    ds_read_b128 v[80:83], v7 offset:47104
    v_mfma_f32_16x16x32_bf16 v[116:119], v[200:203], a[212:215], v[116:119]
    s_waitcnt lgkmcnt(8)
    v_mfma_f32_16x16x32_bf16 v[120:123], v[204:207], a[208:211], v[120:123]
    ds_read_b128 v[196:199], v7 offset:40960
    v_mfma_f32_16x16x32_bf16 v[120:123], v[92:95], a[216:219], v[120:123]
    buffer_load_dwordx4 v[20:23], v242, s[20:23], s51 offen sc1
    v_mfma_f32_16x16x32_bf16 v[124:127], v[92:95], a[220:223], v[124:127]
    ds_read_b128 v[84:87], v7 offset:48128
    v_mfma_f32_16x16x32_bf16 v[124:127], v[204:207], a[212:215], v[124:127]
    s_waitcnt lgkmcnt(8)
    v_mfma_f32_16x16x32_bf16 v[128:131], v[208:211], a[208:211], v[128:131]
    ds_read_b128 v[200:203], v8 offset:0
    s_mov_b32 s51, 26624
    v_mfma_f32_16x16x32_bf16 v[128:131], v[96:99], a[216:219], v[128:131]
    buffer_load_dwordx4 v[24:27], v1, s[20:23], s51 offen sc1
    v_mfma_f32_16x16x32_bf16 v[132:135], v[96:99], a[220:223], v[132:135]
    ds_read_b128 v[88:91], v8 offset:7168
    v_mfma_f32_16x16x32_bf16 v[132:135], v[208:211], a[212:215], v[132:135]
    s_waitcnt lgkmcnt(8)
    v_mfma_f32_16x16x32_bf16 v[136:139], v[212:215], a[208:211], v[136:139]
    ds_read_b128 v[204:207], v8 offset:1024
    v_mfma_f32_16x16x32_bf16 v[136:139], v[100:103], a[216:219], v[136:139]
    buffer_load_dwordx4 v[28:31], v242, s[20:23], s51 offen sc1
    v_mfma_f32_16x16x32_bf16 v[140:143], v[100:103], a[220:223], v[140:143]
    ds_read_b128 v[92:95], v8 offset:8192
    v_mfma_f32_16x16x32_bf16 v[140:143], v[212:215], a[212:215], v[140:143]
    s_waitcnt lgkmcnt(8)
    v_mfma_f32_16x16x32_bf16 v[144:147], v[216:219], a[208:211], v[144:147]
    ds_read_b128 v[208:211], v8 offset:2048
    s_mov_b32 s51, 30720
    v_mfma_f32_16x16x32_bf16 v[144:147], v[104:107], a[216:219], v[144:147]
    buffer_load_dwordx4 v[32:35], v1, s[20:23], s51 offen sc1
    v_mfma_f32_16x16x32_bf16 v[148:151], v[104:107], a[220:223], v[148:151]
    ds_read_b128 v[96:99], v8 offset:9216
    v_mfma_f32_16x16x32_bf16 v[148:151], v[216:219], a[212:215], v[148:151]
    s_waitcnt lgkmcnt(8)
    v_mfma_f32_16x16x32_bf16 v[152:155], v[192:195], a[208:211], v[152:155]
    ds_read_b128 v[212:215], v8 offset:3072
    v_mfma_f32_16x16x32_bf16 v[152:155], v[80:83], a[216:219], v[152:155]
    buffer_load_dwordx4 v[36:39], v242, s[20:23], s51 offen sc1
    v_mfma_f32_16x16x32_bf16 v[156:159], v[80:83], a[220:223], v[156:159]
    ds_read_b128 v[100:103], v8 offset:10240
    v_mfma_f32_16x16x32_bf16 v[156:159], v[192:195], a[212:215], v[156:159]
    s_waitcnt lgkmcnt(8)
    v_mfma_f32_16x16x32_bf16 v[160:163], v[196:199], a[208:211], v[160:163]
    ds_read_b128 v[216:219], v8 offset:4096
    s_mov_b32 s51, 35840
    v_mfma_f32_16x16x32_bf16 v[160:163], v[84:87], a[216:219], v[160:163]
    buffer_load_dwordx4 v[40:43], v1, s[20:23], s51 offen sc1
    v_mfma_f32_16x16x32_bf16 v[164:167], v[84:87], a[220:223], v[164:167]
    ds_read_b128 v[104:107], v8 offset:11264
    v_mfma_f32_16x16x32_bf16 v[164:167], v[196:199], a[212:215], v[164:167]
    s_waitcnt vmcnt(12)
    s_waitcnt lgkmcnt(8)
    v_mfma_f32_16x16x32_bf16 v[112:115], v[200:203], a[224:227], v[112:115]
    ds_read_b128 v[192:195], v8 offset:5120
    v_mfma_f32_16x16x32_bf16 v[112:115], v[88:91], a[232:235], v[112:115]
    buffer_load_dwordx4 v[44:47], v242, s[20:23], s51 offen sc1
    v_mfma_f32_16x16x32_bf16 v[116:119], v[88:91], a[236:239], v[116:119]
    ds_read_b128 v[80:83], v8 offset:12288
    v_mfma_f32_16x16x32_bf16 v[116:119], v[200:203], a[228:231], v[116:119]
    s_waitcnt lgkmcnt(8)
    v_mfma_f32_16x16x32_bf16 v[120:123], v[204:207], a[224:227], v[120:123]
    ds_read_b128 v[196:199], v8 offset:6144
    s_add_u32 m0, s54, 28672
    v_mfma_f32_16x16x32_bf16 v[120:123], v[92:95], a[232:235], v[120:123]
    s_add_u32 s50, s1, 0
    buffer_load_dwordx4 v228, s[24:27], s50 offen offset:0 sc1 lds
    v_mfma_f32_16x16x32_bf16 v[124:127], v[92:95], a[236:239], v[124:127]
    ds_read_b128 v[84:87], v8 offset:13312
    v_mfma_f32_16x16x32_bf16 v[124:127], v[204:207], a[228:231], v[124:127]
    s_waitcnt lgkmcnt(8)
    v_mfma_f32_16x16x32_bf16 v[128:131], v[208:211], a[224:227], v[128:131]
    s_waitcnt vmcnt(13)
    s_barrier
    ds_read_b128 v[200:203], v8 offset:14336
    s_add_u32 m0, s54, 28672
    v_mfma_f32_16x16x32_bf16 v[128:131], v[96:99], a[232:235], v[128:131]
    buffer_load_dwordx4 v228, s[24:27], s50 offen offset:1024 sc1 lds
    v_mfma_f32_16x16x32_bf16 v[132:135], v[96:99], a[236:239], v[132:135]
    ds_read_b128 v[88:91], v8 offset:21504
    v_mfma_f32_16x16x32_bf16 v[132:135], v[208:211], a[228:231], v[132:135]
    s_waitcnt lgkmcnt(8)
    v_mfma_f32_16x16x32_bf16 v[136:139], v[212:215], a[224:227], v[136:139]
    ds_read_b128 v[204:207], v8 offset:15360
    s_add_u32 m0, s54, 36864
    v_mfma_f32_16x16x32_bf16 v[136:139], v[100:103], a[232:235], v[136:139]
    s_add_u32 s50, s1, 165888
    buffer_load_dwordx4 v228, s[24:27], s50 offen offset:0 sc1 lds
    v_mfma_f32_16x16x32_bf16 v[140:143], v[100:103], a[236:239], v[140:143]
    ds_read_b128 v[92:95], v8 offset:22528
    v_mfma_f32_16x16x32_bf16 v[140:143], v[212:215], a[228:231], v[140:143]
    s_waitcnt lgkmcnt(8)
    v_mfma_f32_16x16x32_bf16 v[144:147], v[216:219], a[224:227], v[144:147]
    ds_read_b128 v[208:211], v8 offset:16384
    s_add_u32 m0, s54, 36864
    v_mfma_f32_16x16x32_bf16 v[144:147], v[104:107], a[232:235], v[144:147]
    buffer_load_dwordx4 v228, s[24:27], s50 offen offset:1024 sc1 lds
    v_mfma_f32_16x16x32_bf16 v[148:151], v[104:107], a[236:239], v[148:151]
    ds_read_b128 v[96:99], v8 offset:23552
    v_mfma_f32_16x16x32_bf16 v[148:151], v[216:219], a[228:231], v[148:151]
    s_waitcnt lgkmcnt(8)
    v_mfma_f32_16x16x32_bf16 v[152:155], v[192:195], a[224:227], v[152:155]
    ds_read_b128 v[212:215], v8 offset:17408
    s_add_u32 m0, s54, 45056
    v_mfma_f32_16x16x32_bf16 v[152:155], v[80:83], a[232:235], v[152:155]
    s_add_u32 s50, s1, 9216
    buffer_load_dwordx4 v228, s[24:27], s50 offen offset:0 sc1 lds
    v_mfma_f32_16x16x32_bf16 v[156:159], v[80:83], a[236:239], v[156:159]
    ds_read_b128 v[100:103], v8 offset:24576
    v_mfma_f32_16x16x32_bf16 v[156:159], v[192:195], a[228:231], v[156:159]
    s_waitcnt lgkmcnt(8)
    v_mfma_f32_16x16x32_bf16 v[160:163], v[196:199], a[224:227], v[160:163]
    ds_read_b128 v[216:219], v8 offset:18432
    s_add_u32 m0, s54, 45056
    v_mfma_f32_16x16x32_bf16 v[160:163], v[84:87], a[232:235], v[160:163]
    buffer_load_dwordx4 v228, s[24:27], s50 offen offset:1024 sc1 lds
    v_mfma_f32_16x16x32_bf16 v[164:167], v[84:87], a[236:239], v[164:167]
    ds_read_b128 v[104:107], v8 offset:25600
    v_mfma_f32_16x16x32_bf16 v[164:167], v[196:199], a[228:231], v[164:167]
    s_waitcnt vmcnt(14)
    s_waitcnt lgkmcnt(8)
    v_mfma_f32_16x16x32_bf16 v[112:115], v[200:203], a[240:243], v[112:115]
    ds_read_b128 v[192:195], v8 offset:19456
    s_add_u32 m0, s54, 53248
    v_mfma_f32_16x16x32_bf16 v[112:115], v[88:91], a[248:251], v[112:115]
    s_add_u32 s50, s1, 175104
    buffer_load_dwordx4 v228, s[24:27], s50 offen offset:0 sc1 lds
    v_mfma_f32_16x16x32_bf16 v[116:119], v[88:91], a[252:255], v[116:119]
    ds_read_b128 v[80:83], v8 offset:26624
    v_mfma_f32_16x16x32_bf16 v[116:119], v[200:203], a[244:247], v[116:119]
    s_waitcnt lgkmcnt(8)
    v_mfma_f32_16x16x32_bf16 v[120:123], v[204:207], a[240:243], v[120:123]
    ds_read_b128 v[196:199], v8 offset:20480
    s_add_u32 m0, s54, 53248
    v_mfma_f32_16x16x32_bf16 v[120:123], v[92:95], a[248:251], v[120:123]
    buffer_load_dwordx4 v228, s[24:27], s50 offen offset:1024 sc1 lds
    v_mfma_f32_16x16x32_bf16 v[124:127], v[92:95], a[252:255], v[124:127]
    ds_read_b128 v[84:87], v8 offset:27648
    v_mfma_f32_16x16x32_bf16 v[124:127], v[204:207], a[244:247], v[124:127]
    s_waitcnt lgkmcnt(8)
    v_mfma_f32_16x16x32_bf16 v[128:131], v[208:211], a[240:243], v[128:131]
    ds_read_b128 v[200:203], v1 offset:0
    s_add_u32 m0, s54, 61440
    v_mfma_f32_16x16x32_bf16 v[128:131], v[96:99], a[248:251], v[128:131]
    s_add_u32 s50, s0, 36864
    buffer_load_dwordx4 v228, s[24:27], s50 offen offset:0 sc1 lds
    v_mfma_f32_16x16x32_bf16 v[132:135], v[96:99], a[252:255], v[132:135]
    ds_read_b128 v[88:91], v1 offset:7168
    v_mfma_f32_16x16x32_bf16 v[132:135], v[208:211], a[244:247], v[132:135]
    s_waitcnt lgkmcnt(8)
    v_mfma_f32_16x16x32_bf16 v[136:139], v[212:215], a[240:243], v[136:139]
    ds_read_b128 v[204:207], v1 offset:14336
    s_add_u32 m0, s54, 61440
    v_mfma_f32_16x16x32_bf16 v[136:139], v[100:103], a[248:251], v[136:139]
    buffer_load_dwordx4 v228, s[24:27], s50 offen offset:1024 sc1 lds
    v_mfma_f32_16x16x32_bf16 v[140:143], v[100:103], a[252:255], v[140:143]
    ds_read_b128 v[92:95], v1 offset:21504
    v_mfma_f32_16x16x32_bf16 v[140:143], v[212:215], a[244:247], v[140:143]
    s_waitcnt lgkmcnt(8)
    v_mfma_f32_16x16x32_bf16 v[144:147], v[216:219], a[240:243], v[144:147]
    ds_read_b128 v[208:211], v1 offset:1024
    v_mfma_f32_16x16x32_bf16 v[144:147], v[104:107], a[248:251], v[144:147]
    v_mfma_f32_16x16x32_bf16 v[148:151], v[104:107], a[252:255], v[148:151]
    ds_read_b128 v[96:99], v1 offset:8192
    v_mfma_f32_16x16x32_bf16 v[148:151], v[216:219], a[244:247], v[148:151]
    s_waitcnt lgkmcnt(8)
    v_mfma_f32_16x16x32_bf16 v[152:155], v[192:195], a[240:243], v[152:155]
    ds_read_b128 v[212:215], v1 offset:15360
    v_mfma_f32_16x16x32_bf16 v[152:155], v[80:83], a[248:251], v[152:155]
    v_mfma_f32_16x16x32_bf16 v[156:159], v[80:83], a[252:255], v[156:159]
    ds_read_b128 v[100:103], v1 offset:22528
    v_mfma_f32_16x16x32_bf16 v[156:159], v[192:195], a[244:247], v[156:159]
    s_waitcnt lgkmcnt(8)
    v_mfma_f32_16x16x32_bf16 v[160:163], v[196:199], a[240:243], v[160:163]
    ds_read_b128 v[216:219], v1 offset:2048
    s_add_u32 m0, s54, 131072
    v_mfma_f32_16x16x32_bf16 v[160:163], v[84:87], a[248:251], v[160:163]
    s_add_u32 s50, s1, 18432
    buffer_load_dwordx4 v228, s[24:27], s50 offen offset:0 sc1 lds
    v_mfma_f32_16x16x32_bf16 v[164:167], v[84:87], a[252:255], v[164:167]
    ds_read_b128 v[104:107], v1 offset:9216
    v_mfma_f32_16x16x32_bf16 v[164:167], v[196:199], a[244:247], v[164:167]
    s_waitcnt vmcnt(15)
    s_waitcnt lgkmcnt(8)
    v_mfma_f32_16x16x32_bf16 v[112:115], v[200:203], v[16:19], v[112:115]
    ds_read_b128 v[192:195], v1 offset:16384
    s_add_u32 m0, s54, 131072
    v_mfma_f32_16x16x32_bf16 v[112:115], v[88:91], v[24:27], v[112:115]
    buffer_load_dwordx4 v228, s[24:27], s50 offen offset:1024 sc1 lds
    v_mfma_f32_16x16x32_bf16 v[116:119], v[88:91], v[28:31], v[116:119]
    ds_read_b128 v[80:83], v1 offset:23552
    v_mfma_f32_16x16x32_bf16 v[116:119], v[200:203], v[20:23], v[116:119]
    s_waitcnt vmcnt(12)
    s_waitcnt lgkmcnt(8)
    v_mfma_f32_16x16x32_bf16 v[112:115], v[204:207], v[32:35], v[112:115]
    ds_read_b128 v[196:199], v1 offset:3072
    s_add_u32 m0, s54, 139264
    v_mfma_f32_16x16x32_bf16 v[112:115], v[92:95], v[40:43], v[112:115]
    s_add_u32 s50, s1, 184320
    buffer_load_dwordx4 v228, s[24:27], s50 offen offset:0 sc1 lds
    v_mfma_f32_16x16x32_bf16 v[116:119], v[92:95], v[44:47], v[116:119]
    ds_read_b128 v[84:87], v1 offset:10240
    v_mfma_f32_16x16x32_bf16 v[116:119], v[204:207], v[36:39], v[116:119]
    s_waitcnt lgkmcnt(8)
    v_mfma_f32_16x16x32_bf16 v[120:123], v[208:211], v[16:19], v[120:123]
    ds_read_b128 v[200:203], v1 offset:17408
    s_add_u32 m0, s54, 139264
    v_mfma_f32_16x16x32_bf16 v[120:123], v[96:99], v[24:27], v[120:123]
    buffer_load_dwordx4 v228, s[24:27], s50 offen offset:1024 sc1 lds
    v_mfma_f32_16x16x32_bf16 v[124:127], v[96:99], v[28:31], v[124:127]
    ds_read_b128 v[88:91], v1 offset:24576
    v_mfma_f32_16x16x32_bf16 v[124:127], v[208:211], v[20:23], v[124:127]
    s_waitcnt lgkmcnt(8)
    v_mfma_f32_16x16x32_bf16 v[120:123], v[212:215], v[32:35], v[120:123]
    ds_read_b128 v[204:207], v1 offset:4096
    s_add_u32 m0, s54, 147456
    v_mfma_f32_16x16x32_bf16 v[120:123], v[100:103], v[40:43], v[120:123]
    s_add_u32 s50, s1, 27648
    buffer_load_dwordx4 v228, s[24:27], s50 offen offset:0 sc1 lds
    v_mfma_f32_16x16x32_bf16 v[124:127], v[100:103], v[44:47], v[124:127]
    ds_read_b128 v[92:95], v1 offset:11264
    v_mfma_f32_16x16x32_bf16 v[124:127], v[212:215], v[36:39], v[124:127]
    s_waitcnt lgkmcnt(8)
    v_mfma_f32_16x16x32_bf16 v[128:131], v[216:219], v[16:19], v[128:131]
    ds_read_b128 v[208:211], v1 offset:18432
    s_add_u32 m0, s54, 147456
    v_mfma_f32_16x16x32_bf16 v[128:131], v[104:107], v[24:27], v[128:131]
    buffer_load_dwordx4 v228, s[24:27], s50 offen offset:1024 sc1 lds
    v_mfma_f32_16x16x32_bf16 v[132:135], v[104:107], v[28:31], v[132:135]
    ds_read_b128 v[96:99], v1 offset:25600
    v_cvt_pk_bf16_f32 v112, v112, v113
    v_mfma_f32_16x16x32_bf16 v[132:135], v[216:219], v[20:23], v[132:135]
    v_cvt_pk_bf16_f32 v113, v114, v115
    s_waitcnt lgkmcnt(8)
    v_mfma_f32_16x16x32_bf16 v[128:131], v[192:195], v[32:35], v[128:131]
    ds_read_b128 v[212:215], v1 offset:5120
    s_add_u32 m0, s54, 155648
    v_mfma_f32_16x16x32_bf16 v[128:131], v[80:83], v[40:43], v[128:131]
    s_add_u32 s50, s1, 193536
    buffer_load_dwordx4 v228, s[24:27], s50 offen offset:0 sc1 lds
    v_mfma_f32_16x16x32_bf16 v[132:135], v[80:83], v[44:47], v[132:135]
    ds_read_b128 v[100:103], v1 offset:12288
    v_cvt_pk_bf16_f32 v114, v116, v117
    v_mfma_f32_16x16x32_bf16 v[132:135], v[192:195], v[36:39], v[132:135]
    v_cvt_pk_bf16_f32 v115, v118, v119
    s_waitcnt lgkmcnt(8)
    v_mfma_f32_16x16x32_bf16 v[136:139], v[196:199], v[16:19], v[136:139]
    ds_read_b128 v[216:219], v1 offset:19456
    s_add_u32 m0, s54, 155648
    v_mfma_f32_16x16x32_bf16 v[136:139], v[84:87], v[24:27], v[136:139]
    buffer_load_dwordx4 v228, s[24:27], s50 offen offset:1024 sc1 lds
    v_mfma_f32_16x16x32_bf16 v[140:143], v[84:87], v[28:31], v[140:143]
    ds_read_b128 v[104:107], v1 offset:26624
    v_and_or_b32 v112, v112, s65, v3
    v_mfma_f32_16x16x32_bf16 v[140:143], v[196:199], v[20:23], v[140:143]
    v_and_or_b32 v113, v113, s65, v4
    s_waitcnt lgkmcnt(8)
    v_mfma_f32_16x16x32_bf16 v[136:139], v[200:203], v[32:35], v[136:139]
    ds_read_b128 v[192:195], v1 offset:6144
    v_and_or_b32 v114, v114, s65, v248
    v_mfma_f32_16x16x32_bf16 v[136:139], v[88:91], v[40:43], v[136:139]
    v_and_or_b32 v115, v115, s65, v230
    buffer_store_dwordx4 v[112:115], v1, s[60:63], s8 offen offset:0 sc1
    v_mfma_f32_16x16x32_bf16 v[140:143], v[88:91], v[44:47], v[140:143]
    ds_read_b128 v[80:83], v1 offset:13312
    v_cvt_pk_bf16_f32 v120, v120, v121
    v_mfma_f32_16x16x32_bf16 v[140:143], v[200:203], v[36:39], v[140:143]
    v_cvt_pk_bf16_f32 v121, v122, v123
    s_waitcnt lgkmcnt(8)
    v_mfma_f32_16x16x32_bf16 v[144:147], v[204:207], v[16:19], v[144:147]
    ds_read_b128 v[196:199], v1 offset:20480
    v_cvt_pk_bf16_f32 v122, v124, v125
    v_mfma_f32_16x16x32_bf16 v[144:147], v[92:95], v[24:27], v[144:147]
    v_cvt_pk_bf16_f32 v123, v126, v127
    v_and_or_b32 v120, v120, s65, v3
    v_mfma_f32_16x16x32_bf16 v[148:151], v[92:95], v[28:31], v[148:151]
    ds_read_b128 v[84:87], v1 offset:27648
    v_and_or_b32 v121, v121, s65, v4
    v_mfma_f32_16x16x32_bf16 v[148:151], v[204:207], v[20:23], v[148:151]
    v_and_or_b32 v122, v122, s65, v248
    s_waitcnt lgkmcnt(8)
    v_mfma_f32_16x16x32_bf16 v[144:147], v[208:211], v[32:35], v[144:147]
    s_waitcnt vmcnt(9)
    s_barrier
    ds_read_b128 v[200:203], v1 offset:28672
    v_and_or_b32 v123, v123, s65, v230
    v_mfma_f32_16x16x32_bf16 v[144:147], v[96:99], v[40:43], v[144:147]
    buffer_store_dwordx4 v[120:123], v1, s[60:63], s9 offen offset:0 sc1
    v_cvt_pk_bf16_f32 v128, v128, v129
    v_mfma_f32_16x16x32_bf16 v[148:151], v[96:99], v[44:47], v[148:151]
    ds_read_b128 v[88:91], v1 offset:30720
    v_cvt_pk_bf16_f32 v129, v130, v131
    v_mfma_f32_16x16x32_bf16 v[148:151], v[208:211], v[36:39], v[148:151]
    v_cvt_pk_bf16_f32 v130, v132, v133
    s_waitcnt lgkmcnt(8)
    v_mfma_f32_16x16x32_bf16 v[152:155], v[212:215], v[16:19], v[152:155]
    ds_read_b128 v[204:207], v1 offset:29696
    v_cvt_pk_bf16_f32 v131, v134, v135
    v_mfma_f32_16x16x32_bf16 v[152:155], v[100:103], v[24:27], v[152:155]
    v_and_or_b32 v128, v128, s65, v3
    v_and_or_b32 v129, v129, s65, v4
    v_mfma_f32_16x16x32_bf16 v[156:159], v[100:103], v[28:31], v[156:159]
    ds_read_b128 v[92:95], v1 offset:31744
    v_and_or_b32 v130, v130, s65, v248
    v_mfma_f32_16x16x32_bf16 v[156:159], v[212:215], v[20:23], v[156:159]
    v_and_or_b32 v131, v131, s65, v230
    s_waitcnt lgkmcnt(8)
    v_mfma_f32_16x16x32_bf16 v[152:155], v[216:219], v[32:35], v[152:155]
    ds_read_b128 v[208:211], v1 offset:32768
    buffer_store_dwordx4 v[128:131], v1, s[60:63], s9 offen offset:1024 sc1
    v_mfma_f32_16x16x32_bf16 v[152:155], v[104:107], v[40:43], v[152:155]
    v_cvt_pk_bf16_f32 v136, v136, v137
    v_cvt_pk_bf16_f32 v137, v138, v139
    v_mfma_f32_16x16x32_bf16 v[156:159], v[104:107], v[44:47], v[156:159]
    ds_read_b128 v[96:99], v1 offset:34816
    v_cvt_pk_bf16_f32 v138, v140, v141
    v_mfma_f32_16x16x32_bf16 v[156:159], v[216:219], v[36:39], v[156:159]
    v_cvt_pk_bf16_f32 v139, v142, v143
    s_waitcnt lgkmcnt(8)
    v_mfma_f32_16x16x32_bf16 v[160:163], v[192:195], v[16:19], v[160:163]
    ds_read_b128 v[212:215], v1 offset:33792
    v_and_or_b32 v136, v136, s65, v3
    v_mfma_f32_16x16x32_bf16 v[160:163], v[80:83], v[24:27], v[160:163]
    v_and_or_b32 v137, v137, s65, v4
    v_and_or_b32 v138, v138, s65, v248
    v_mfma_f32_16x16x32_bf16 v[164:167], v[80:83], v[28:31], v[164:167]
    ds_read_b128 v[100:103], v1 offset:35840
    v_and_or_b32 v139, v139, s65, v230
    v_mfma_f32_16x16x32_bf16 v[164:167], v[192:195], v[20:23], v[164:167]
    s_waitcnt lgkmcnt(8)
    v_mfma_f32_16x16x32_bf16 v[160:163], v[196:199], v[32:35], v[160:163]
    ds_read_b128 v[216:219], v1 offset:36864
    buffer_store_dwordx4 v[136:139], v1, s[60:63], s10 offen offset:0 sc1
    v_mfma_f32_16x16x32_bf16 v[160:163], v[84:87], v[40:43], v[160:163]
    v_cvt_pk_bf16_f32 v144, v144, v145
    v_cvt_pk_bf16_f32 v145, v146, v147
    v_mfma_f32_16x16x32_bf16 v[164:167], v[84:87], v[44:47], v[164:167]
    ds_read_b128 v[104:107], v1 offset:38912
    v_cvt_pk_bf16_f32 v146, v148, v149
    v_mfma_f32_16x16x32_bf16 v[164:167], v[196:199], v[36:39], v[164:167]
    v_cvt_pk_bf16_f32 v147, v150, v151
    s_waitcnt lgkmcnt(8)
    v_mfma_f32_16x16x32_bf16 v[48:51], v[200:203], a[0:3], 0
    ds_read_b128 v[192:195], v1 offset:37888
    v_and_or_b32 v144, v144, s65, v3
    v_mfma_f32_16x16x32_bf16 v[48:51], v[88:91], a[8:11], v[48:51]
    v_and_or_b32 v145, v145, s65, v4
    v_and_or_b32 v146, v146, s65, v248
    v_mfma_f32_16x16x32_bf16 v[52:55], v[88:91], a[12:15], 0
    ds_read_b128 v[80:83], v1 offset:39936
    v_and_or_b32 v147, v147, s65, v230
    v_mfma_f32_16x16x32_bf16 v[52:55], v[200:203], a[4:7], v[52:55]
    s_waitcnt lgkmcnt(8)
    v_mfma_f32_16x16x32_bf16 v[56:59], v[204:207], a[0:3], 0
    ds_read_b128 v[196:199], v1 offset:40960
    buffer_store_dwordx4 v[144:147], v1, s[60:63], s10 offen offset:1024 sc1
    v_mfma_f32_16x16x32_bf16 v[56:59], v[92:95], a[8:11], v[56:59]
    v_cvt_pk_bf16_f32 v152, v152, v153
    v_cvt_pk_bf16_f32 v153, v154, v155
    v_mfma_f32_16x16x32_bf16 v[60:63], v[92:95], a[12:15], 0
    ds_read_b128 v[84:87], v1 offset:43008
    v_cvt_pk_bf16_f32 v154, v156, v157
    v_mfma_f32_16x16x32_bf16 v[60:63], v[204:207], a[4:7], v[60:63]
    v_cvt_pk_bf16_f32 v155, v158, v159
    s_waitcnt lgkmcnt(8)
    v_mfma_f32_16x16x32_bf16 v[48:51], v[208:211], a[16:19], v[48:51]
    ds_read_b128 v[200:203], v1 offset:41984
    v_and_or_b32 v152, v152, s65, v3
    v_mfma_f32_16x16x32_bf16 v[48:51], v[96:99], a[24:27], v[48:51]
    v_and_or_b32 v153, v153, s65, v4
    v_and_or_b32 v154, v154, s65, v248
    v_mfma_f32_16x16x32_bf16 v[52:55], v[96:99], a[28:31], v[52:55]
    ds_read_b128 v[88:91], v1 offset:44032
    v_and_or_b32 v155, v155, s65, v230
    v_mfma_f32_16x16x32_bf16 v[52:55], v[208:211], a[20:23], v[52:55]
    s_waitcnt lgkmcnt(8)
    v_mfma_f32_16x16x32_bf16 v[56:59], v[212:215], a[16:19], v[56:59]
    ds_read_b128 v[204:207], v1 offset:45056
    buffer_store_dwordx4 v[152:155], v1, s[60:63], s11 offen offset:0 sc1
    v_mfma_f32_16x16x32_bf16 v[56:59], v[100:103], a[24:27], v[56:59]
    v_cvt_pk_bf16_f32 v160, v160, v161
    v_cvt_pk_bf16_f32 v161, v162, v163
    v_mfma_f32_16x16x32_bf16 v[60:63], v[100:103], a[28:31], v[60:63]
    ds_read_b128 v[92:95], v1 offset:47104
    v_cvt_pk_bf16_f32 v162, v164, v165
    v_mfma_f32_16x16x32_bf16 v[60:63], v[212:215], a[20:23], v[60:63]
    v_cvt_pk_bf16_f32 v163, v166, v167
    s_waitcnt lgkmcnt(8)
    v_mfma_f32_16x16x32_bf16 v[48:51], v[216:219], a[32:35], v[48:51]
    ds_read_b128 v[208:211], v1 offset:46080
    v_and_or_b32 v160, v160, s65, v3
    v_mfma_f32_16x16x32_bf16 v[48:51], v[104:107], a[40:43], v[48:51]
    v_and_or_b32 v161, v161, s65, v4
    v_and_or_b32 v162, v162, s65, v248
    v_mfma_f32_16x16x32_bf16 v[52:55], v[104:107], a[44:47], v[52:55]
    ds_read_b128 v[96:99], v1 offset:48128
    v_and_or_b32 v163, v163, s65, v230
    v_mfma_f32_16x16x32_bf16 v[52:55], v[216:219], a[36:39], v[52:55]
    s_waitcnt lgkmcnt(8)
    v_mfma_f32_16x16x32_bf16 v[56:59], v[192:195], a[32:35], v[56:59]
    ds_read_b128 v[212:215], v7 offset:0
    buffer_store_dwordx4 v[160:163], v1, s[60:63], s11 offen offset:1024 sc1
    v_mfma_f32_16x16x32_bf16 v[56:59], v[80:83], a[40:43], v[56:59]
    v_mfma_f32_16x16x32_bf16 v[60:63], v[80:83], a[44:47], v[60:63]
    ds_read_b128 v[100:103], v7 offset:2048
    v_mfma_f32_16x16x32_bf16 v[60:63], v[192:195], a[36:39], v[60:63]
    s_waitcnt lgkmcnt(8)
    v_mfma_f32_16x16x32_bf16 v[48:51], v[196:199], a[48:51], v[48:51]
    ds_read_b128 v[216:219], v7 offset:1024
    v_mfma_f32_16x16x32_bf16 v[48:51], v[84:87], a[56:59], v[48:51]
    v_mfma_f32_16x16x32_bf16 v[52:55], v[84:87], a[60:63], v[52:55]
    ds_read_b128 v[104:107], v7 offset:3072
    v_mfma_f32_16x16x32_bf16 v[52:55], v[196:199], a[52:55], v[52:55]
    s_waitcnt lgkmcnt(8)
    v_mfma_f32_16x16x32_bf16 v[56:59], v[200:203], a[48:51], v[56:59]
    ds_read_b128 v[192:195], v7 offset:4096
    v_mfma_f32_16x16x32_bf16 v[56:59], v[88:91], a[56:59], v[56:59]
    v_mfma_f32_16x16x32_bf16 v[60:63], v[88:91], a[60:63], v[60:63]
    ds_read_b128 v[80:83], v7 offset:6144
    v_mfma_f32_16x16x32_bf16 v[60:63], v[200:203], a[52:55], v[60:63]
    s_waitcnt lgkmcnt(8)
    v_mfma_f32_16x16x32_bf16 v[48:51], v[204:207], a[64:67], v[48:51]
    ds_read_b128 v[196:199], v7 offset:5120
    v_mfma_f32_16x16x32_bf16 v[48:51], v[92:95], a[72:75], v[48:51]
    v_mfma_f32_16x16x32_bf16 v[52:55], v[92:95], a[76:79], v[52:55]
    ds_read_b128 v[84:87], v7 offset:7168
    v_mfma_f32_16x16x32_bf16 v[52:55], v[204:207], a[68:71], v[52:55]
    s_waitcnt lgkmcnt(8)
    v_mfma_f32_16x16x32_bf16 v[56:59], v[208:211], a[64:67], v[56:59]
    ds_read_b128 v[200:203], v7 offset:8192
    v_mfma_f32_16x16x32_bf16 v[56:59], v[96:99], a[72:75], v[56:59]
    v_mfma_f32_16x16x32_bf16 v[60:63], v[96:99], a[76:79], v[60:63]
    ds_read_b128 v[88:91], v7 offset:10240
    v_mfma_f32_16x16x32_bf16 v[60:63], v[208:211], a[68:71], v[60:63]
    s_waitcnt lgkmcnt(8)
    v_mfma_f32_16x16x32_bf16 v[48:51], v[212:215], a[80:83], v[48:51]
    ds_read_b128 v[204:207], v7 offset:9216
    v_mfma_f32_16x16x32_bf16 v[48:51], v[100:103], a[88:91], v[48:51]
    v_mfma_f32_16x16x32_bf16 v[52:55], v[100:103], a[92:95], v[52:55]
    ds_read_b128 v[92:95], v7 offset:11264
    v_mfma_f32_16x16x32_bf16 v[52:55], v[212:215], a[84:87], v[52:55]
    s_waitcnt lgkmcnt(8)
    v_mfma_f32_16x16x32_bf16 v[56:59], v[216:219], a[80:83], v[56:59]
    ds_read_b128 v[208:211], v7 offset:12288
    v_mfma_f32_16x16x32_bf16 v[56:59], v[104:107], a[88:91], v[56:59]
    v_mfma_f32_16x16x32_bf16 v[60:63], v[104:107], a[92:95], v[60:63]
    ds_read_b128 v[96:99], v7 offset:14336
    v_mfma_f32_16x16x32_bf16 v[60:63], v[216:219], a[84:87], v[60:63]
    s_waitcnt lgkmcnt(8)
    v_mfma_f32_16x16x32_bf16 v[48:51], v[192:195], a[96:99], v[48:51]
    ds_read_b128 v[212:215], v7 offset:13312
    v_mfma_f32_16x16x32_bf16 v[48:51], v[80:83], a[104:107], v[48:51]
    v_mfma_f32_16x16x32_bf16 v[52:55], v[80:83], a[108:111], v[52:55]
    ds_read_b128 v[100:103], v7 offset:15360
    v_mfma_f32_16x16x32_bf16 v[52:55], v[192:195], a[100:103], v[52:55]
    s_waitcnt lgkmcnt(8)
    v_mfma_f32_16x16x32_bf16 v[56:59], v[196:199], a[96:99], v[56:59]
    ds_read_b128 v[216:219], v7 offset:16384
    v_mfma_f32_16x16x32_bf16 v[56:59], v[84:87], a[104:107], v[56:59]
    v_mfma_f32_16x16x32_bf16 v[60:63], v[84:87], a[108:111], v[60:63]
    ds_read_b128 v[104:107], v7 offset:18432
    v_mfma_f32_16x16x32_bf16 v[60:63], v[196:199], a[100:103], v[60:63]
    s_waitcnt lgkmcnt(8)
    v_mfma_f32_16x16x32_bf16 v[48:51], v[200:203], a[112:115], v[48:51]
    ds_read_b128 v[192:195], v7 offset:17408
    v_mfma_f32_16x16x32_bf16 v[48:51], v[88:91], a[120:123], v[48:51]
    v_mfma_f32_16x16x32_bf16 v[52:55], v[88:91], a[124:127], v[52:55]
    ds_read_b128 v[80:83], v7 offset:19456
    v_mfma_f32_16x16x32_bf16 v[52:55], v[200:203], a[116:119], v[52:55]
    s_waitcnt lgkmcnt(8)
    v_mfma_f32_16x16x32_bf16 v[56:59], v[204:207], a[112:115], v[56:59]
    s_waitcnt vmcnt(7)
    s_barrier
    ds_read_b128 v[196:199], v8 offset:32768
    v_mfma_f32_16x16x32_bf16 v[56:59], v[92:95], a[120:123], v[56:59]
    v_mfma_f32_16x16x32_bf16 v[60:63], v[92:95], a[124:127], v[60:63]
    ds_read_b128 v[84:87], v8 offset:34816
    v_mfma_f32_16x16x32_bf16 v[60:63], v[204:207], a[116:119], v[60:63]
    s_waitcnt lgkmcnt(8)
    v_mfma_f32_16x16x32_bf16 v[48:51], v[208:211], a[128:131], v[48:51]
    ds_read_b128 v[200:203], v8 offset:33792
    v_mfma_f32_16x16x32_bf16 v[48:51], v[96:99], a[136:139], v[48:51]
    v_mfma_f32_16x16x32_bf16 v[52:55], v[96:99], a[140:143], v[52:55]
    ds_read_b128 v[88:91], v8 offset:35840
    v_mfma_f32_16x16x32_bf16 v[52:55], v[208:211], a[132:135], v[52:55]
    s_waitcnt lgkmcnt(8)
    v_mfma_f32_16x16x32_bf16 v[56:59], v[212:215], a[128:131], v[56:59]
    ds_read_b128 v[204:207], v8 offset:36864
    v_mfma_f32_16x16x32_bf16 v[56:59], v[100:103], a[136:139], v[56:59]
    v_mfma_f32_16x16x32_bf16 v[60:63], v[100:103], a[140:143], v[60:63]
    ds_read_b128 v[92:95], v8 offset:38912
    v_mfma_f32_16x16x32_bf16 v[60:63], v[212:215], a[132:135], v[60:63]
    s_waitcnt lgkmcnt(8)
    v_mfma_f32_16x16x32_bf16 v[48:51], v[216:219], a[144:147], v[48:51]
    ds_read_b128 v[208:211], v8 offset:37888
    v_mfma_f32_16x16x32_bf16 v[48:51], v[104:107], a[152:155], v[48:51]
    v_mfma_f32_16x16x32_bf16 v[52:55], v[104:107], a[156:159], v[52:55]
    ds_read_b128 v[96:99], v8 offset:39936
    v_mfma_f32_16x16x32_bf16 v[52:55], v[216:219], a[148:151], v[52:55]
    s_waitcnt lgkmcnt(8)
    v_mfma_f32_16x16x32_bf16 v[56:59], v[192:195], a[144:147], v[56:59]
    ds_read_b128 v[212:215], v8 offset:40960
    v_mfma_f32_16x16x32_bf16 v[56:59], v[80:83], a[152:155], v[56:59]
    v_mfma_f32_16x16x32_bf16 v[60:63], v[80:83], a[156:159], v[60:63]
    ds_read_b128 v[100:103], v8 offset:43008
    v_mfma_f32_16x16x32_bf16 v[60:63], v[192:195], a[148:151], v[60:63]
    s_waitcnt lgkmcnt(8)
    v_mfma_f32_16x16x32_bf16 v[48:51], v[196:199], a[160:163], v[48:51]
    ds_read_b128 v[216:219], v8 offset:41984
    v_mfma_f32_16x16x32_bf16 v[48:51], v[84:87], a[168:171], v[48:51]
    v_mfma_f32_16x16x32_bf16 v[52:55], v[84:87], a[172:175], v[52:55]
    ds_read_b128 v[104:107], v8 offset:44032
    v_mfma_f32_16x16x32_bf16 v[52:55], v[196:199], a[164:167], v[52:55]
    s_waitcnt lgkmcnt(8)
    v_mfma_f32_16x16x32_bf16 v[56:59], v[200:203], a[160:163], v[56:59]
    ds_read_b128 v[192:195], v8 offset:45056
    v_mfma_f32_16x16x32_bf16 v[56:59], v[88:91], a[168:171], v[56:59]
    v_mfma_f32_16x16x32_bf16 v[60:63], v[88:91], a[172:175], v[60:63]
    ds_read_b128 v[80:83], v8 offset:47104
    v_mfma_f32_16x16x32_bf16 v[60:63], v[200:203], a[164:167], v[60:63]
    s_waitcnt lgkmcnt(8)
    v_mfma_f32_16x16x32_bf16 v[48:51], v[204:207], a[176:179], v[48:51]
    ds_read_b128 v[196:199], v8 offset:46080
    v_mfma_f32_16x16x32_bf16 v[48:51], v[92:95], a[184:187], v[48:51]
    v_mfma_f32_16x16x32_bf16 v[52:55], v[92:95], a[188:191], v[52:55]
    ds_read_b128 v[84:87], v8 offset:48128
    v_mfma_f32_16x16x32_bf16 v[52:55], v[204:207], a[180:183], v[52:55]
    s_waitcnt lgkmcnt(8)
    v_mfma_f32_16x16x32_bf16 v[56:59], v[208:211], a[176:179], v[56:59]
    ds_read_b128 v[200:203], v8 offset:49152
    v_mfma_f32_16x16x32_bf16 v[56:59], v[96:99], a[184:187], v[56:59]
    v_mfma_f32_16x16x32_bf16 v[60:63], v[96:99], a[188:191], v[60:63]
    ds_read_b128 v[88:91], v8 offset:51200
    v_mfma_f32_16x16x32_bf16 v[60:63], v[208:211], a[180:183], v[60:63]
    s_waitcnt lgkmcnt(8)
    v_mfma_f32_16x16x32_bf16 v[48:51], v[212:215], a[192:195], v[48:51]
    ds_read_b128 v[204:207], v8 offset:50176
    v_mfma_f32_16x16x32_bf16 v[48:51], v[100:103], a[200:203], v[48:51]
    v_mfma_f32_16x16x32_bf16 v[52:55], v[100:103], a[204:207], v[52:55]
    ds_read_b128 v[92:95], v8 offset:52224
    v_mfma_f32_16x16x32_bf16 v[52:55], v[212:215], a[196:199], v[52:55]
    s_waitcnt lgkmcnt(8)
    v_mfma_f32_16x16x32_bf16 v[56:59], v[216:219], a[192:195], v[56:59]
    ds_read_b128 v[208:211], v8 offset:53248
    v_mfma_f32_16x16x32_bf16 v[56:59], v[104:107], a[200:203], v[56:59]
    v_mfma_f32_16x16x32_bf16 v[60:63], v[104:107], a[204:207], v[60:63]
    ds_read_b128 v[96:99], v8 offset:55296
    v_mfma_f32_16x16x32_bf16 v[60:63], v[216:219], a[196:199], v[60:63]
    s_waitcnt lgkmcnt(8)
    v_mfma_f32_16x16x32_bf16 v[48:51], v[192:195], a[208:211], v[48:51]
    ds_read_b128 v[212:215], v8 offset:54272
    v_mfma_f32_16x16x32_bf16 v[48:51], v[80:83], a[216:219], v[48:51]
    buffer_load_dwordx4 v[176:179], v1, s[60:63], s72 offen offset:0 sc1
    v_mfma_f32_16x16x32_bf16 v[52:55], v[80:83], a[220:223], v[52:55]
    ds_read_b128 v[100:103], v8 offset:56320
    v_mfma_f32_16x16x32_bf16 v[52:55], v[192:195], a[212:215], v[52:55]
    s_waitcnt lgkmcnt(8)
    v_mfma_f32_16x16x32_bf16 v[56:59], v[196:199], a[208:211], v[56:59]
    ds_read_b128 v[216:219], v8 offset:57344
    v_mfma_f32_16x16x32_bf16 v[56:59], v[84:87], a[216:219], v[56:59]
    buffer_load_dwordx4 v[180:183], v1, s[60:63], s72 offen offset:1024 sc1
    v_mfma_f32_16x16x32_bf16 v[60:63], v[84:87], a[220:223], v[60:63]
    ds_read_b128 v[104:107], v8 offset:59392
    v_mfma_f32_16x16x32_bf16 v[60:63], v[196:199], a[212:215], v[60:63]
    s_waitcnt lgkmcnt(8)
    v_mfma_f32_16x16x32_bf16 v[48:51], v[200:203], a[224:227], v[48:51]
    ds_read_b128 v[192:195], v8 offset:58368
    v_mfma_f32_16x16x32_bf16 v[48:51], v[88:91], a[232:235], v[48:51]
    buffer_load_dwordx4 v[184:187], v1, s[60:63], s72 offen offset:2048 sc1
    v_mfma_f32_16x16x32_bf16 v[52:55], v[88:91], a[236:239], v[52:55]
    ds_read_b128 v[80:83], v8 offset:60416
    v_mfma_f32_16x16x32_bf16 v[52:55], v[200:203], a[228:231], v[52:55]
    s_waitcnt lgkmcnt(8)
    v_mfma_f32_16x16x32_bf16 v[56:59], v[204:207], a[224:227], v[56:59]
    ds_read_b128 v[196:199], v8 offset:61440
    v_mfma_f32_16x16x32_bf16 v[56:59], v[92:95], a[232:235], v[56:59]
    buffer_load_dwordx4 v[188:191], v1, s[60:63], s72 offen offset:3072 sc1
    v_mfma_f32_16x16x32_bf16 v[60:63], v[92:95], a[236:239], v[60:63]
    ds_read_b128 v[84:87], v8 offset:63488
    v_mfma_f32_16x16x32_bf16 v[60:63], v[204:207], a[228:231], v[60:63]
    s_waitcnt lgkmcnt(8)
    v_mfma_f32_16x16x32_bf16 v[48:51], v[208:211], a[240:243], v[48:51]
    ds_read_b128 v[200:203], v8 offset:62464
    v_mfma_f32_16x16x32_bf16 v[48:51], v[96:99], a[248:251], v[48:51]
    buffer_load_dwordx4 v[128:131], v1, s[60:63], s14 offen offset:0 sc1
    v_mfma_f32_16x16x32_bf16 v[52:55], v[96:99], a[252:255], v[52:55]
    ds_read_b128 v[88:91], v8 offset:64512
    v_mfma_f32_16x16x32_bf16 v[52:55], v[208:211], a[244:247], v[52:55]
    s_waitcnt lgkmcnt(8)
    v_mfma_f32_16x16x32_bf16 v[56:59], v[212:215], a[240:243], v[56:59]
    v_mfma_f32_16x16x32_bf16 v[56:59], v[100:103], a[248:251], v[56:59]
    buffer_load_dwordx4 v[132:135], v1, s[60:63], s14 offen offset:1024 sc1
    v_mfma_f32_16x16x32_bf16 v[60:63], v[100:103], a[252:255], v[60:63]
    v_mfma_f32_16x16x32_bf16 v[60:63], v[212:215], a[244:247], v[60:63]
    s_waitcnt lgkmcnt(6)
    v_mfma_f32_16x16x32_bf16 v[48:51], v[216:219], v[16:19], v[48:51]
    v_mfma_f32_16x16x32_bf16 v[48:51], v[104:107], v[24:27], v[48:51]
    v_mfma_f32_16x16x32_bf16 v[52:55], v[104:107], v[28:31], v[52:55]
    v_mfma_f32_16x16x32_bf16 v[52:55], v[216:219], v[20:23], v[52:55]
    s_waitcnt lgkmcnt(4)
    v_mfma_f32_16x16x32_bf16 v[56:59], v[192:195], v[16:19], v[56:59]
    v_mfma_f32_16x16x32_bf16 v[56:59], v[80:83], v[24:27], v[56:59]
    v_mfma_f32_16x16x32_bf16 v[60:63], v[80:83], v[28:31], v[60:63]
    v_mfma_f32_16x16x32_bf16 v[60:63], v[192:195], v[20:23], v[60:63]
    s_waitcnt lgkmcnt(2)
    v_mfma_f32_16x16x32_bf16 v[48:51], v[196:199], v[32:35], v[48:51]
    v_mfma_f32_16x16x32_bf16 v[48:51], v[84:87], v[40:43], v[48:51]
    v_mfma_f32_16x16x32_bf16 v[52:55], v[84:87], v[44:47], v[52:55]
    v_mfma_f32_16x16x32_bf16 v[52:55], v[196:199], v[36:39], v[52:55]
    s_waitcnt lgkmcnt(0)
    v_mfma_f32_16x16x32_bf16 v[56:59], v[200:203], v[32:35], v[56:59]
    v_mfma_f32_16x16x32_bf16 v[56:59], v[88:91], v[40:43], v[56:59]
    v_mfma_f32_16x16x32_bf16 v[60:63], v[88:91], v[44:47], v[60:63]
    v_mfma_f32_16x16x32_bf16 v[60:63], v[200:203], v[36:39], v[60:63]
L_g_tail:
    buffer_load_dwordx4 v[120:123], v1, s[60:63], s13 offen offset:0 sc1
    buffer_load_dwordx4 v[124:127], v1, s[60:63], s13 offen offset:1024 sc1
    buffer_load_dwordx4 v[112:115], v1, s[60:63], s12 offen offset:0 sc1
    buffer_load_dwordx4 v[116:119], v1, s[60:63], s12 offen offset:1024 sc1
    s_mov_b32 s49, 400000
    s_nop 2
L_g_xpa:
    s_waitcnt vmcnt(0)
    v_xor_b32 v112, v112, v3
    v_xor_b32 v113, v113, v4
    v_xor_b32 v114, v114, v248
    v_xor_b32 v115, v115, v230
    v_xor_b32 v116, v116, v3
    v_xor_b32 v117, v117, v4
    v_xor_b32 v118, v118, v248
    v_xor_b32 v119, v119, v230
    v_xor_b32 v120, v120, v3
    v_xor_b32 v121, v121, v4
    v_xor_b32 v122, v122, v248
    v_xor_b32 v123, v123, v230
    v_xor_b32 v124, v124, v3
    v_xor_b32 v125, v125, v4
    v_xor_b32 v126, v126, v248
    v_xor_b32 v127, v127, v230
    v_xor_b32 v128, v128, v3
    v_xor_b32 v129, v129, v4
    v_xor_b32 v130, v130, v248
    v_xor_b32 v131, v131, v230
    v_xor_b32 v132, v132, v3
    v_xor_b32 v133, v133, v4
    v_xor_b32 v134, v134, v248
    v_xor_b32 v135, v135, v230
    v_or3_b32 v254, v112, v113, v114
    v_or3_b32 v255, v115, v116, v117
    v_or3_b32 v254, v254, v118, v119
    v_or3_b32 v255, v255, v120, v121
    v_or3_b32 v254, v254, v122, v123
    v_or3_b32 v255, v255, v124, v125
    v_or3_b32 v254, v254, v126, v127
    v_or3_b32 v255, v255, v128, v129
    v_or3_b32 v254, v254, v130, v131
    v_or3_b32 v255, v255, v132, v133
    v_or3_b32 v254, v254, v134, v135
    v_or_b32 v254, v254, v255
    v_and_b32 v254, 0x10001, v254
    v_cmp_ne_u32 vcc, 0, v254
    s_sub_u32 s49, s49, 1
    s_nop 3
    s_cbranch_vccz L_g_xoa
    s_cmp_eq_u32 s49, 0
    s_cbranch_scc1 L_g_xoa
    buffer_load_dwordx4 v[128:131], v1, s[60:63], s14 offen offset:0 sc1
    buffer_load_dwordx4 v[132:135], v1, s[60:63], s14 offen offset:1024 sc1
    buffer_load_dwordx4 v[120:123], v1, s[60:63], s13 offen offset:0 sc1
    buffer_load_dwordx4 v[124:127], v1, s[60:63], s13 offen offset:1024 sc1
    buffer_load_dwordx4 v[112:115], v1, s[60:63], s12 offen offset:0 sc1
    buffer_load_dwordx4 v[116:119], v1, s[60:63], s12 offen offset:1024 sc1
    s_branch L_g_xpa
L_g_xoa:
    v_permlane16_swap_b32 v232, v234
    v_permlane16_swap_b32 v233, v235
    v_permlane16_swap_b32 v236, v238
    v_permlane16_swap_b32 v237, v239
    v_lshl_or_b32 v144, v112, 16, v2
    v_and_or_b32 v145, v112, s39, v2
    v_lshl_or_b32 v146, v113, 16, v2
    v_and_or_b32 v147, v113, s39, v2
    v_lshl_or_b32 v148, v114, 16, v2
    v_and_or_b32 v149, v114, s39, v2
    v_lshl_or_b32 v150, v115, 16, v2
    v_and_or_b32 v151, v115, s39, v2
    v_lshl_or_b32 v152, v116, 16, v2
    v_and_or_b32 v153, v116, s39, v2
    v_lshl_or_b32 v154, v117, 16, v2
    v_and_or_b32 v155, v117, s39, v2
    v_lshl_or_b32 v156, v118, 16, v2
    v_and_or_b32 v157, v118, s39, v2
    v_lshl_or_b32 v158, v119, 16, v2
    v_and_or_b32 v159, v119, s39, v2
    v_pk_add_f32 v[48:49], v[48:49], v[144:145]
    v_pk_add_f32 v[50:51], v[50:51], v[146:147]
    v_pk_add_f32 v[52:53], v[52:53], v[148:149]
    v_pk_add_f32 v[54:55], v[54:55], v[150:151]
    v_pk_add_f32 v[56:57], v[56:57], v[152:153]
    v_pk_add_f32 v[58:59], v[58:59], v[154:155]
    v_pk_add_f32 v[60:61], v[60:61], v[156:157]
    v_pk_add_f32 v[62:63], v[62:63], v[158:159]
    v_lshl_or_b32 v144, v120, 16, v2
    v_and_or_b32 v145, v120, s39, v2
    v_lshl_or_b32 v146, v121, 16, v2
    v_and_or_b32 v147, v121, s39, v2
    v_lshl_or_b32 v148, v122, 16, v2
    v_and_or_b32 v149, v122, s39, v2
    v_lshl_or_b32 v150, v123, 16, v2
    v_and_or_b32 v151, v123, s39, v2
    v_lshl_or_b32 v152, v124, 16, v2
    v_and_or_b32 v153, v124, s39, v2
    v_lshl_or_b32 v154, v125, 16, v2
    v_and_or_b32 v155, v125, s39, v2
    v_lshl_or_b32 v156, v126, 16, v2
    v_and_or_b32 v157, v126, s39, v2
    v_lshl_or_b32 v158, v127, 16, v2
    v_and_or_b32 v159, v127, s39, v2
    v_pk_add_f32 v[48:49], v[48:49], v[144:145]
    v_pk_add_f32 v[50:51], v[50:51], v[146:147]
    v_pk_add_f32 v[52:53], v[52:53], v[148:149]
    v_pk_add_f32 v[54:55], v[54:55], v[150:151]
    v_pk_add_f32 v[56:57], v[56:57], v[152:153]
    v_pk_add_f32 v[58:59], v[58:59], v[154:155]
    v_pk_add_f32 v[60:61], v[60:61], v[156:157]
    v_pk_add_f32 v[62:63], v[62:63], v[158:159]
    v_lshl_or_b32 v144, v128, 16, v2
    v_and_or_b32 v145, v128, s39, v2
    v_lshl_or_b32 v146, v129, 16, v2
    v_and_or_b32 v147, v129, s39, v2
    v_lshl_or_b32 v148, v130, 16, v2
    v_and_or_b32 v149, v130, s39, v2
    v_lshl_or_b32 v150, v131, 16, v2
    v_and_or_b32 v151, v131, s39, v2
    v_lshl_or_b32 v152, v132, 16, v2
    v_and_or_b32 v153, v132, s39, v2
    v_lshl_or_b32 v154, v133, 16, v2
    v_and_or_b32 v155, v133, s39, v2
    v_lshl_or_b32 v156, v134, 16, v2
    v_and_or_b32 v157, v134, s39, v2
    v_lshl_or_b32 v158, v135, 16, v2
    v_and_or_b32 v159, v135, s39, v2
    v_pk_add_f32 v[48:49], v[48:49], v[144:145]
    v_pk_add_f32 v[50:51], v[50:51], v[146:147]
    v_pk_add_f32 v[52:53], v[52:53], v[148:149]
    v_pk_add_f32 v[54:55], v[54:55], v[150:151]
    v_pk_add_f32 v[56:57], v[56:57], v[152:153]
    v_pk_add_f32 v[58:59], v[58:59], v[154:155]
    v_pk_add_f32 v[60:61], v[60:61], v[156:157]
    v_pk_add_f32 v[62:63], v[62:63], v[158:159]
    v_lshlrev_b32 v144, 16, v232
    v_and_b32 v145, s39, v232
    v_lshlrev_b32 v146, 16, v233
    v_and_b32 v147, s39, v233
    v_lshlrev_b32 v148, 16, v236
    v_and_b32 v149, s39, v236
    v_lshlrev_b32 v150, 16, v237
    v_and_b32 v151, s39, v237
    v_lshlrev_b32 v152, 16, v234
    v_and_b32 v153, s39, v234
    v_lshlrev_b32 v154, 16, v235
    v_and_b32 v155, s39, v235
    v_lshlrev_b32 v156, 16, v238
    v_and_b32 v157, s39, v238
    v_lshlrev_b32 v158, 16, v239
    v_and_b32 v159, s39, v239
    v_pk_fma_f32 v[48:49], v[48:49], v[68:69], v[144:145]
    v_pk_fma_f32 v[50:51], v[50:51], v[70:71], v[146:147]
    v_pk_fma_f32 v[52:53], v[52:53], v[68:69], v[148:149]
    v_pk_fma_f32 v[54:55], v[54:55], v[70:71], v[150:151]
    v_pk_fma_f32 v[56:57], v[56:57], v[72:73], v[152:153]
    v_pk_fma_f32 v[58:59], v[58:59], v[74:75], v[154:155]
    v_pk_fma_f32 v[60:61], v[60:61], v[72:73], v[156:157]
    v_pk_fma_f32 v[62:63], v[62:63], v[74:75], v[158:159]
    v_cvt_pk_bf16_f32 v160, v48, v49
    v_cvt_pk_bf16_f32 v161, v50, v51
    v_cvt_pk_bf16_f32 v164, v52, v53
    v_cvt_pk_bf16_f32 v165, v54, v55
    v_cvt_pk_bf16_f32 v162, v56, v57
    v_cvt_pk_bf16_f32 v163, v58, v59
    v_cvt_pk_bf16_f32 v166, v60, v61
    v_cvt_pk_bf16_f32 v167, v62, v63
    v_permlane16_swap_b32 v160, v162
    v_permlane16_swap_b32 v161, v163
    v_permlane16_swap_b32 v164, v166
    v_permlane16_swap_b32 v165, v167
    global_store_dwordx4 v246, v[160:163], s[74:75]
    global_store_dwordx4 v247, v[164:167], s[74:75]
    s_cmp_lg_u32 s56, s37
    s_nop 0
    s_cbranch_scc1 L_g_end
    s_mov_b32 s49, 400000
L_g_xpb:
    v_xor_b32 v176, v176, v3
    v_xor_b32 v177, v177, v4
    v_xor_b32 v178, v178, v248
    v_xor_b32 v179, v179, v230
    v_xor_b32 v180, v180, v3
    v_xor_b32 v181, v181, v4
    v_xor_b32 v182, v182, v248
    v_xor_b32 v183, v183, v230
    v_xor_b32 v184, v184, v3
    v_xor_b32 v185, v185, v4
    v_xor_b32 v186, v186, v248
    v_xor_b32 v187, v187, v230
    v_xor_b32 v188, v188, v3
    v_xor_b32 v189, v189, v4
    v_xor_b32 v190, v190, v248
    v_xor_b32 v191, v191, v230
    v_or3_b32 v254, v176, v177, v178
    v_or3_b32 v255, v179, v180, v181
    v_or3_b32 v254, v254, v182, v183
    v_or3_b32 v255, v255, v184, v185
    v_or3_b32 v254, v254, v186, v187
    v_or3_b32 v255, v255, v188, v189
    v_or3_b32 v254, v254, v190, v191
    v_or_b32 v254, v254, v255
    v_and_b32 v254, 0x10001, v254
    v_cmp_ne_u32 vcc, 0, v254
    s_sub_u32 s49, s49, 1
    s_nop 3
    s_cbranch_vccz L_g_xob
    s_cmp_eq_u32 s49, 0
    s_cbranch_scc1 L_g_xob
    buffer_load_dwordx4 v[176:179], v1, s[60:63], s72 offen offset:0 sc1
    buffer_load_dwordx4 v[180:183], v1, s[60:63], s72 offen offset:1024 sc1
    buffer_load_dwordx4 v[184:187], v1, s[60:63], s72 offen offset:2048 sc1
    buffer_load_dwordx4 v[188:191], v1, s[60:63], s72 offen offset:3072 sc1
    s_waitcnt vmcnt(0)
    s_branch L_g_xpb
L_g_xob:
    v_lshl_or_b32 v80, v176, 16, v2
    v_and_or_b32 v81, v176, s39, v2
    v_lshl_or_b32 v82, v177, 16, v2
    v_and_or_b32 v83, v177, s39, v2
    v_lshl_or_b32 v84, v178, 16, v2
    v_and_or_b32 v85, v178, s39, v2
    v_lshl_or_b32 v86, v179, 16, v2
    v_and_or_b32 v87, v179, s39, v2
    v_lshl_or_b32 v144, v180, 16, v2
    v_and_or_b32 v145, v180, s39, v2
    v_lshl_or_b32 v146, v181, 16, v2
    v_and_or_b32 v147, v181, s39, v2
    v_lshl_or_b32 v148, v182, 16, v2
    v_and_or_b32 v149, v182, s39, v2
    v_lshl_or_b32 v150, v183, 16, v2
    v_and_or_b32 v151, v183, s39, v2
    v_pk_add_f32 v[80:81], v[80:81], v[144:145]
    v_pk_add_f32 v[82:83], v[82:83], v[146:147]
    v_pk_add_f32 v[84:85], v[84:85], v[148:149]
    v_pk_add_f32 v[86:87], v[86:87], v[150:151]
    v_lshl_or_b32 v144, v184, 16, v2
    v_and_or_b32 v145, v184, s39, v2
    v_lshl_or_b32 v146, v185, 16, v2
    v_and_or_b32 v147, v185, s39, v2
    v_lshl_or_b32 v148, v186, 16, v2
    v_and_or_b32 v149, v186, s39, v2
    v_lshl_or_b32 v150, v187, 16, v2
    v_and_or_b32 v151, v187, s39, v2
    v_pk_add_f32 v[80:81], v[80:81], v[144:145]
    v_pk_add_f32 v[82:83], v[82:83], v[146:147]
    v_pk_add_f32 v[84:85], v[84:85], v[148:149]
    v_pk_add_f32 v[86:87], v[86:87], v[150:151]
    v_lshl_or_b32 v144, v188, 16, v2
    v_and_or_b32 v145, v188, s39, v2
    v_lshl_or_b32 v146, v189, 16, v2
    v_and_or_b32 v147, v189, s39, v2
    v_lshl_or_b32 v148, v190, 16, v2
    v_and_or_b32 v149, v190, s39, v2
    v_lshl_or_b32 v150, v191, 16, v2
    v_and_or_b32 v151, v191, s39, v2
    v_pk_add_f32 v[80:81], v[80:81], v[144:145]
    v_pk_add_f32 v[82:83], v[82:83], v[146:147]
    v_pk_add_f32 v[84:85], v[84:85], v[148:149]
    v_pk_add_f32 v[86:87], v[86:87], v[150:151]
    v_lshlrev_b32 v144, 16, v64
    v_and_b32 v145, s39, v64
    v_lshlrev_b32 v146, 16, v65
    v_and_b32 v147, s39, v65
    v_lshlrev_b32 v148, 16, v66
    v_and_b32 v149, s39, v66
    v_lshlrev_b32 v150, 16, v67
    v_and_b32 v151, s39, v67
    v_pk_fma_f32 v[80:81], v[80:81], v[76:77], v[144:145]
    v_pk_fma_f32 v[82:83], v[82:83], v[78:79], v[146:147]
    v_pk_fma_f32 v[84:85], v[84:85], v[76:77], v[148:149]
    v_pk_fma_f32 v[86:87], v[86:87], v[78:79], v[150:151]
    v_cvt_pk_bf16_f32 v88, v80, v81
    v_cvt_pk_bf16_f32 v89, v82, v83
    v_cvt_pk_bf16_f32 v90, v84, v85
    v_cvt_pk_bf16_f32 v91, v86, v87
    v_add_u32 v15, 18432, v14
    global_store_dwordx2 v14, v[88:89], s[74:75] offset:256
    global_store_dwordx2 v15, v[90:91], s[74:75] offset:256
    s_branch L_g_end
L_g_slow1:
    s_mov_b32 s49, 400000
L_g_sl1:
    s_mov_b64 exec, vcc
    s_sleep 3
    global_load_dword v15, v246, s[78:79] sc1
    s_mov_b64 exec, -1
    s_sub_u32 s49, s49, 1
    s_waitcnt vmcnt(0)
    v_cmp_ne_u32 vcc, s64, v15
    s_cmp_eq_u32 s49, 0
    s_nop 3
    s_cbranch_scc1 L_g_back1
    s_cbranch_vccnz L_g_sl1
    s_branch L_g_back1
L_g_slow2:
    s_mov_b32 s49, 400000
L_g_sl2:
    s_mov_b64 exec, vcc
    s_sleep 3
    global_load_dword v15, v253, s[78:79] sc1
    s_mov_b64 exec, -1
    s_sub_u32 s49, s49, 1
    s_waitcnt vmcnt(0)
    v_cmp_ne_u32 vcc, s64, v15
    s_cmp_eq_u32 s49, 0
    s_nop 3
    s_cbranch_scc1 L_g_back2
    s_cbranch_vccnz L_g_sl2
    s_branch L_g_back2
L_g_slow3:
    s_mov_b32 s49, 400000
L_g_sl3:
    s_mov_b64 exec, vcc
    s_sleep 3
    global_load_dword v15, v253, s[78:79] sc1
    s_mov_b64 exec, -1
    s_sub_u32 s49, s49, 1
    s_waitcnt vmcnt(0)
    v_cmp_ne_u32 vcc, s64, v15
    s_cmp_eq_u32 s49, 0
    s_nop 3
    s_cbranch_scc1 L_g_back3
    s_cbranch_vccnz L_g_sl3
    s_branch L_g_back3
L_g_slow4:
    s_mov_b32 s49, 400000
L_g_sl4:
    s_mov_b64 exec, vcc
    s_sleep 3
    global_load_dword v15, v253, s[78:79] sc1
    s_mov_b64 exec, -1
    s_sub_u32 s49, s49, 1
    s_waitcnt vmcnt(0)
    v_cmp_ne_u32 vcc, s64, v15
    s_cmp_eq_u32 s49, 0
    s_nop 3
    s_cbranch_scc1 L_g_back4
    s_cbranch_vccnz L_g_sl4
    s_branch L_g_back4
L_g_slow5:
    s_mov_b32 s49, 400000
L_g_sl5:
    s_mov_b64 exec, vcc
    s_sleep 3
    global_load_dword v15, v253, s[78:79] sc1
    s_mov_b64 exec, -1
    s_sub_u32 s49, s49, 1
    s_waitcnt vmcnt(0)
    v_cmp_ne_u32 vcc, s64, v15
    s_cmp_eq_u32 s49, 0
    s_nop 3
    s_cbranch_scc1 L_g_back5
    s_cbranch_vccnz L_g_sl5
    s_branch L_g_back5
L_g_stop:
    s_endpgm
L_g_end:
    s_endpgm
.section .rodata,"a"
.p2align 6
.amdhsa_kernel ffn_kernel
  .amdhsa_next_free_vgpr 512
  .amdhsa_next_free_sgpr 80
  .amdhsa_accum_offset 256
  .amdhsa_group_segment_fixed_size 0
  .amdhsa_kernarg_size 144
  .amdhsa_user_sgpr_count 2
  .amdhsa_user_sgpr_kernarg_segment_ptr 1
  .amdhsa_system_sgpr_workgroup_id_x 1
  .amdhsa_float_denorm_mode_32 3
.end_amdhsa_kernel
.text
L_code_end:
```
